```python
import torch

def _softmax(x, axis=-1):
    return torch.softmax(x, dim=axis)

def _gelu(x):
    return torch.nn.functional.gelu(x, approximate='tanh')

def _silu(x):
    return torch.nn.functional.silu(x)

def _sigmoid(x):
    return torch.sigmoid(x)

def _layernorm(x, axis=-1, eps=1e-05):
    m = x.mean(dim=axis, keepdim=True)
    v = x.var(dim=axis, keepdim=True, unbiased=False)
    return (x - m) / torch.sqrt(v + eps)

def _scatter_add(tgt, idx, src, axis=0):
    return tgt.clone().index_add_(axis, idx, src)

def _segment_sum(src, seg, n):
    out = torch.zeros((n,) + src.shape[1:], dtype=src.dtype)
    return out.index_add_(0, seg, src)

def _pad(x, pw):
    flat = tuple((v for pair in reversed(pw) for v in pair))
    return torch.nn.functional.pad(x, flat)
kernel_name = 'adaLN_cond__memory_aug_recurrent_mem_tr__dense_activation_gelu__prompt'

def setup_inputs():

    _w = lambda a: (lambda t: t.to(torch.bfloat16) if t.is_floating_point() else t)(torch.as_tensor(a))

    def _A_setup():
        B, S, Dm = (1, 2048, 512)
        H, Dh = (32, 128)
        M, seg = (8, 32)
        seg = min(seg, S)
        S = S // seg * seg
        return {'x': _w((lambda *s: torch.randn(*s, dtype=torch.bfloat16) * 0.05)(B, S, Dm)), 'mem0': _w((lambda *s: torch.randn(*s, dtype=torch.bfloat16) * 0.8)(B, M, Dm)), 'Wq': _w((lambda *s: torch.randn(*s, dtype=torch.bfloat16) * 1.6)(Dm, H, Dh) * Dm ** (-0.5)), 'Wk': _w((lambda *s: torch.randn(*s, dtype=torch.bfloat16) * 1.6)(Dm, H, Dh) * Dm ** (-0.5)), 'Wv': _w((lambda *s: torch.randn(*s, dtype=torch.bfloat16) * 0.8)(Dm, H, Dh) * Dm ** (-0.5)), 'Wo': _w((lambda *s: torch.randn(*s, dtype=torch.bfloat16) * 0.8)(H, Dh, Dm) * (H * Dh) ** (-0.5)), 'seg_len': seg}
    _A_in = _A_setup()

    def _B_setup():
        B, S, D, F = (1, 2048, 512, 1376)
        return {'x': _w((lambda *s: torch.randn(*s, dtype=torch.bfloat16) * 0.05)(B, S, D)), 'w1': _w((lambda *s: torch.randn(*s, dtype=torch.bfloat16) * 1.6)(D, F) * D ** (-0.5)), 'b1': _w((lambda *s: torch.randn(*s, dtype=torch.bfloat16) * 1.6)(F) * 0.01), 'w2': _w((lambda *s: torch.randn(*s, dtype=torch.bfloat16) * 0.2)(F, D) * F ** (-0.5)), 'b2': _w((lambda *s: torch.randn(*s, dtype=torch.bfloat16) * 0.2)(D) * 0.01)}
    _B_in = _B_setup()
    return {'A_x': _A_in['x'], 'A_mem0': _A_in['mem0'], 'A_Wq': _A_in['Wq'], 'A_Wk': _A_in['Wk'], 'A_Wv': _A_in['Wv'], 'A_Wo': _A_in['Wo'], 'A_seg_len': _A_in['seg_len'], 'B_x': _B_in['x'], 'B_w1': _B_in['w1'], 'B_b1': _B_in['b1'], 'B_w2': _B_in['w2'], 'B_b2': _B_in['b2'], 'c': _w((lambda *s: torch.randn(*s, dtype=torch.bfloat16) * 0.05)(1, 512) * 8.0), 'w_mod': _w((lambda *s: torch.randn(*s, dtype=torch.bfloat16) * 0.05)(512, 6 * 512) * 512 ** (-0.5) * 8.0)}

def reference(A_x, A_mem0, A_Wq, A_Wk, A_Wv, A_Wo, A_seg_len, B_x, B_w1, B_b1, B_w2, B_b2, c, w_mod):

    def _A_ref(x, mem0, Wq, Wk, Wv, Wo, seg_len):
        B, S, Dm = x.shape
        H, Dh = (Wq.shape[1], Wq.shape[2])
        M = mem0.shape[1]
        scale = Dh ** (-0.5)
        n_seg = S // seg_len
        L = M + seg_len
        idx = torch.arange(L)
        mask = (idx[:, None] < M) | (idx[:, None] >= idx[None, :])
        mem = mem0
        outs = []
        for s in range(n_seg):
            xs = x[:, s * seg_len:(s + 1) * seg_len, :].clone()
            h = torch.concatenate([mem, xs], axis=1)
            q = torch.einsum('btd,dhe->bhte', h, Wq)
            k = torch.einsum('btd,dhe->bhte', h, Wk)
            v = torch.einsum('btd,dhe->bhte', h, Wv)
            scores = torch.einsum('bhqe,bhke->bhqk', q, k) * scale
            scores = torch.where(mask[None, None], scores, -1000000000.0)
            p = _softmax(scores, axis=-1)
            o = torch.einsum('bhqk,bhke->bhqe', p, v)
            o = torch.einsum('bhte,hed->btd', o, Wo)
            mem = o[:, :M, :].clone()
            outs.append(o[:, M:, :])
        return torch.concatenate(outs, axis=1)

    def _B_ref(x, w1, b1, w2, b2):
        h = torch.einsum('bsd,df->bsf', x, w1) + b1
        h = _gelu(h)
        return torch.einsum('bsf,fd->bsd', h, w2) + b2
    x = A_x
    mod = (_silu(c) @ w_mod).reshape(c.shape[0], 6, 1, -1)
    sa, ca, ga, sb, cb, gb = (mod[:, 0].clone(), mod[:, 1].clone(), mod[:, 2].clone(), mod[:, 3].clone(), mod[:, 4].clone(), mod[:, 5].clone())
    h = _layernorm(x, axis=-1) * (1 + ca) + sa
    x = x + ga * _A_ref(h, A_mem0, A_Wq, A_Wk, A_Wv, A_Wo, A_seg_len)
    h = _layernorm(x, axis=-1) * (1 + cb) + sb
    x = x + gb * _B_ref(h, B_w1, B_b1, B_w2, B_b2)
    return x
```

```asm
; @launch grid=(256,1,1) block=(256,1,1) lds=163584
.amdgcn_target "amdgcn-amd-amdhsa--gfx950"
.text
.globl adaLN_cond__memory_aug_recurrent_mem_tr__dense_activation_gelu__prompt_kernel
.p2align 8
.type adaLN_cond__memory_aug_recurrent_mem_tr__dense_activation_gelu__prompt_kernel,@function
adaLN_cond__memory_aug_recurrent_mem_tr__dense_activation_gelu__prompt_kernel:
s_load_dwordx2 s[4:5], s[0:1], 128
s_load_dwordx2 s[6:7], s[0:1], 120
s_getreg_b32 s8, hwreg(HW_REG_XCC_ID, 0, 4)
v_lshrrev_b32 v1, 6, v0
v_and_b32 v0, 63, v0
v_readfirstlane_b32 s11, v1
s_waitcnt lgkmcnt(0)
s_cmp_lg_u32 s11, 0
s_cbranch_scc1 L_wt
s_mov_b64 exec, 1
v_mov_b32 v3, 0
v_mov_b32 v4, 1
s_cmp_lg_u32 s8, 0
s_cbranch_scc1 L_wk
global_atomic_add v5, v3, v4, s[6:7] offset:0 sc0
s_waitcnt vmcnt(0)
v_readfirstlane_b32 s12, v5
s_nop 0
s_cmp_lt_u32 s12, 32
s_cbranch_scc1 L_got
L_wk:
global_atomic_add v5, v3, v4, s[6:7] offset:4 sc0
s_waitcnt vmcnt(0)
v_readfirstlane_b32 s12, v5
v_add_u32 v5, 32, v5
s_cmp_lt_u32 s12, 224
s_cbranch_scc1 L_got
global_atomic_add v6, v3, v4, s[6:7] offset:0 sc0
s_waitcnt vmcnt(0)
v_readfirstlane_b32 s12, v6
s_nop 0
s_cmp_ge_u32 s12, 32
s_cbranch_scc1 L_got
v_mov_b32 v5, v6
L_got:
v_mov_b32 v3, 160768
ds_write_b32 v3, v5
s_waitcnt lgkmcnt(0)
s_mov_b64 exec, -1
L_wt:
s_barrier
v_mov_b32 v3, 160768
ds_read_b32 v5, v3
s_waitcnt lgkmcnt(0)
v_readfirstlane_b32 s9, v5
s_barrier
s_cmp_lt_u32 s9, 32
s_cbranch_scc1 L_chain
s_sub_u32 s12, s9, 32
s_cmp_ge_u32 s12, 224
s_cbranch_scc1 L_end
s_cmp_lg_u32 s12, 0
s_cbranch_scc1 L_noinit
s_lshl_b32 s34, s11, 10
v_lshlrev_b32 v2, 4, v0
v_add_u32 v2, s34, v2
v_mov_b32 v8, 0
v_mov_b32 v9, 0
v_mov_b32 v10, 0
v_mov_b32 v11, 0
global_store_dwordx4 v2, v[8:11], s[4:5] sc1
v_add_u32 v2, 4096, v2
global_store_dwordx4 v2, v[8:11], s[4:5] sc1
v_add_u32 v2, 4096, v2
global_store_dwordx4 v2, v[8:11], s[4:5] sc1
v_add_u32 v2, 4096, v2
global_store_dwordx4 v2, v[8:11], s[4:5] sc1
v_add_u32 v2, 4096, v2
global_store_dwordx4 v2, v[8:11], s[4:5] sc1
v_add_u32 v2, 4096, v2
global_store_dwordx4 v2, v[8:11], s[4:5] sc1
v_add_u32 v2, 4096, v2
global_store_dwordx4 v2, v[8:11], s[4:5] sc1
v_add_u32 v2, 4096, v2
global_store_dwordx4 v2, v[8:11], s[4:5] sc1
v_add_u32 v2, 4096, v2
global_store_dwordx4 v2, v[8:11], s[4:5] sc1
v_add_u32 v2, 4096, v2
global_store_dwordx4 v2, v[8:11], s[4:5] sc1
v_add_u32 v2, 4096, v2
global_store_dwordx4 v2, v[8:11], s[4:5] sc1
v_add_u32 v2, 4096, v2
global_store_dwordx4 v2, v[8:11], s[4:5] sc1
v_add_u32 v2, 4096, v2
global_store_dwordx4 v2, v[8:11], s[4:5] sc1
v_add_u32 v2, 4096, v2
global_store_dwordx4 v2, v[8:11], s[4:5] sc1
v_add_u32 v2, 4096, v2
global_store_dwordx4 v2, v[8:11], s[4:5] sc1
v_add_u32 v2, 4096, v2
global_store_dwordx4 v2, v[8:11], s[4:5] sc1
v_add_u32 v2, 4096, v2
global_store_dwordx4 v2, v[8:11], s[4:5] sc1
v_add_u32 v2, 4096, v2
global_store_dwordx4 v2, v[8:11], s[4:5] sc1
v_add_u32 v2, 4096, v2
s_waitcnt vmcnt(0)
s_barrier
s_add_u32 s44, s6, 8
s_addc_u32 s45, s7, 0
s_waitcnt vmcnt(0)
s_barrier
s_cmp_lg_u32 s11, 0
s_cbranch_scc1 SG_1
v_mov_b32 v250, 0
v_mov_b32 v251, 1
s_mov_b64 exec, 1
global_atomic_add v250, v251, s[44:45] offset:0
s_mov_b64 exec, -1
SG_1:
L_noinit:
s_cmp_lt_u32 s12, 216
s_cbranch_scc1 L_noclr
s_sub_u32 s13, s12, 216
s_lshl_b32 s34, s11, 10
v_lshlrev_b32 v2, 4, v0
v_add_u32 v2, s34, v2
v_mov_b32 v8, -1
v_mov_b32 v9, -1
v_mov_b32 v10, -1
v_mov_b32 v11, -1
s_mul_i32 s34, s13, 24576
s_add_u32 s34, s34, 87883776
s_add_u32 s44, s4, s34
s_addc_u32 s45, s5, 0
global_store_dwordx4 v2, v[8:11], s[44:45] sc1
s_add_u32 s44, s44, 4096
s_addc_u32 s45, s45, 0
global_store_dwordx4 v2, v[8:11], s[44:45] sc1
s_add_u32 s44, s44, 4096
s_addc_u32 s45, s45, 0
global_store_dwordx4 v2, v[8:11], s[44:45] sc1
s_add_u32 s44, s44, 4096
s_addc_u32 s45, s45, 0
global_store_dwordx4 v2, v[8:11], s[44:45] sc1
s_add_u32 s44, s44, 4096
s_addc_u32 s45, s45, 0
global_store_dwordx4 v2, v[8:11], s[44:45] sc1
s_add_u32 s44, s44, 4096
s_addc_u32 s45, s45, 0
global_store_dwordx4 v2, v[8:11], s[44:45] sc1
s_add_u32 s44, s44, 4096
s_addc_u32 s45, s45, 0
s_mul_i32 s34, s13, 98304
s_add_u32 s34, s34, 104071168
s_add_u32 s44, s4, s34
s_addc_u32 s45, s5, 0
global_store_dwordx4 v2, v[8:11], s[44:45] sc1
s_add_u32 s44, s44, 4096
s_addc_u32 s45, s45, 0
global_store_dwordx4 v2, v[8:11], s[44:45] sc1
s_add_u32 s44, s44, 4096
s_addc_u32 s45, s45, 0
global_store_dwordx4 v2, v[8:11], s[44:45] sc1
s_add_u32 s44, s44, 4096
s_addc_u32 s45, s45, 0
global_store_dwordx4 v2, v[8:11], s[44:45] sc1
s_add_u32 s44, s44, 4096
s_addc_u32 s45, s45, 0
global_store_dwordx4 v2, v[8:11], s[44:45] sc1
s_add_u32 s44, s44, 4096
s_addc_u32 s45, s45, 0
global_store_dwordx4 v2, v[8:11], s[44:45] sc1
s_add_u32 s44, s44, 4096
s_addc_u32 s45, s45, 0
global_store_dwordx4 v2, v[8:11], s[44:45] sc1
s_add_u32 s44, s44, 4096
s_addc_u32 s45, s45, 0
global_store_dwordx4 v2, v[8:11], s[44:45] sc1
s_add_u32 s44, s44, 4096
s_addc_u32 s45, s45, 0
global_store_dwordx4 v2, v[8:11], s[44:45] sc1
s_add_u32 s44, s44, 4096
s_addc_u32 s45, s45, 0
global_store_dwordx4 v2, v[8:11], s[44:45] sc1
s_add_u32 s44, s44, 4096
s_addc_u32 s45, s45, 0
global_store_dwordx4 v2, v[8:11], s[44:45] sc1
s_add_u32 s44, s44, 4096
s_addc_u32 s45, s45, 0
global_store_dwordx4 v2, v[8:11], s[44:45] sc1
s_add_u32 s44, s44, 4096
s_addc_u32 s45, s45, 0
global_store_dwordx4 v2, v[8:11], s[44:45] sc1
s_add_u32 s44, s44, 4096
s_addc_u32 s45, s45, 0
global_store_dwordx4 v2, v[8:11], s[44:45] sc1
s_add_u32 s44, s44, 4096
s_addc_u32 s45, s45, 0
global_store_dwordx4 v2, v[8:11], s[44:45] sc1
s_add_u32 s44, s44, 4096
s_addc_u32 s45, s45, 0
global_store_dwordx4 v2, v[8:11], s[44:45] sc1
s_add_u32 s44, s44, 4096
s_addc_u32 s45, s45, 0
global_store_dwordx4 v2, v[8:11], s[44:45] sc1
s_add_u32 s44, s44, 4096
s_addc_u32 s45, s45, 0
global_store_dwordx4 v2, v[8:11], s[44:45] sc1
s_add_u32 s44, s44, 4096
s_addc_u32 s45, s45, 0
global_store_dwordx4 v2, v[8:11], s[44:45] sc1
s_add_u32 s44, s44, 4096
s_addc_u32 s45, s45, 0
global_store_dwordx4 v2, v[8:11], s[44:45] sc1
s_add_u32 s44, s44, 4096
s_addc_u32 s45, s45, 0
global_store_dwordx4 v2, v[8:11], s[44:45] sc1
s_add_u32 s44, s44, 4096
s_addc_u32 s45, s45, 0
global_store_dwordx4 v2, v[8:11], s[44:45] sc1
s_add_u32 s44, s44, 4096
s_addc_u32 s45, s45, 0
global_store_dwordx4 v2, v[8:11], s[44:45] sc1
s_add_u32 s44, s44, 4096
s_addc_u32 s45, s45, 0
global_store_dwordx4 v2, v[8:11], s[44:45] sc1
s_add_u32 s44, s44, 4096
s_addc_u32 s45, s45, 0
s_mul_i32 s34, s13, 98304
s_add_u32 s34, s34, 120848384
s_add_u32 s44, s4, s34
s_addc_u32 s45, s5, 0
global_store_dwordx4 v2, v[8:11], s[44:45] sc1
s_add_u32 s44, s44, 4096
s_addc_u32 s45, s45, 0
global_store_dwordx4 v2, v[8:11], s[44:45] sc1
s_add_u32 s44, s44, 4096
s_addc_u32 s45, s45, 0
global_store_dwordx4 v2, v[8:11], s[44:45] sc1
s_add_u32 s44, s44, 4096
s_addc_u32 s45, s45, 0
global_store_dwordx4 v2, v[8:11], s[44:45] sc1
s_add_u32 s44, s44, 4096
s_addc_u32 s45, s45, 0
global_store_dwordx4 v2, v[8:11], s[44:45] sc1
s_add_u32 s44, s44, 4096
s_addc_u32 s45, s45, 0
global_store_dwordx4 v2, v[8:11], s[44:45] sc1
s_add_u32 s44, s44, 4096
s_addc_u32 s45, s45, 0
global_store_dwordx4 v2, v[8:11], s[44:45] sc1
s_add_u32 s44, s44, 4096
s_addc_u32 s45, s45, 0
global_store_dwordx4 v2, v[8:11], s[44:45] sc1
s_add_u32 s44, s44, 4096
s_addc_u32 s45, s45, 0
global_store_dwordx4 v2, v[8:11], s[44:45] sc1
s_add_u32 s44, s44, 4096
s_addc_u32 s45, s45, 0
global_store_dwordx4 v2, v[8:11], s[44:45] sc1
s_add_u32 s44, s44, 4096
s_addc_u32 s45, s45, 0
global_store_dwordx4 v2, v[8:11], s[44:45] sc1
s_add_u32 s44, s44, 4096
s_addc_u32 s45, s45, 0
global_store_dwordx4 v2, v[8:11], s[44:45] sc1
s_add_u32 s44, s44, 4096
s_addc_u32 s45, s45, 0
global_store_dwordx4 v2, v[8:11], s[44:45] sc1
s_add_u32 s44, s44, 4096
s_addc_u32 s45, s45, 0
global_store_dwordx4 v2, v[8:11], s[44:45] sc1
s_add_u32 s44, s44, 4096
s_addc_u32 s45, s45, 0
global_store_dwordx4 v2, v[8:11], s[44:45] sc1
s_add_u32 s44, s44, 4096
s_addc_u32 s45, s45, 0
global_store_dwordx4 v2, v[8:11], s[44:45] sc1
s_add_u32 s44, s44, 4096
s_addc_u32 s45, s45, 0
global_store_dwordx4 v2, v[8:11], s[44:45] sc1
s_add_u32 s44, s44, 4096
s_addc_u32 s45, s45, 0
global_store_dwordx4 v2, v[8:11], s[44:45] sc1
s_add_u32 s44, s44, 4096
s_addc_u32 s45, s45, 0
global_store_dwordx4 v2, v[8:11], s[44:45] sc1
s_add_u32 s44, s44, 4096
s_addc_u32 s45, s45, 0
global_store_dwordx4 v2, v[8:11], s[44:45] sc1
s_add_u32 s44, s44, 4096
s_addc_u32 s45, s45, 0
global_store_dwordx4 v2, v[8:11], s[44:45] sc1
s_add_u32 s44, s44, 4096
s_addc_u32 s45, s45, 0
global_store_dwordx4 v2, v[8:11], s[44:45] sc1
s_add_u32 s44, s44, 4096
s_addc_u32 s45, s45, 0
global_store_dwordx4 v2, v[8:11], s[44:45] sc1
s_add_u32 s44, s44, 4096
s_addc_u32 s45, s45, 0
global_store_dwordx4 v2, v[8:11], s[44:45] sc1
s_add_u32 s44, s44, 4096
s_addc_u32 s45, s45, 0
s_mul_i32 s34, s13, 12288
s_add_u32 s34, s34, 8290304
s_add_u32 s44, s4, s34
s_addc_u32 s45, s5, 0
global_store_dwordx4 v2, v[8:11], s[44:45] sc1
s_add_u32 s44, s44, 4096
s_addc_u32 s45, s45, 0
global_store_dwordx4 v2, v[8:11], s[44:45] sc1
s_add_u32 s44, s44, 4096
s_addc_u32 s45, s45, 0
global_store_dwordx4 v2, v[8:11], s[44:45] sc1
s_add_u32 s44, s44, 4096
s_addc_u32 s45, s45, 0
s_mul_i32 s34, s13, 135168
s_add_u32 s34, s34, 143622144
s_add_u32 s44, s4, s34
s_addc_u32 s45, s5, 0
global_store_dwordx4 v2, v[8:11], s[44:45] sc1
s_add_u32 s44, s44, 4096
s_addc_u32 s45, s45, 0
global_store_dwordx4 v2, v[8:11], s[44:45] sc1
s_add_u32 s44, s44, 4096
s_addc_u32 s45, s45, 0
global_store_dwordx4 v2, v[8:11], s[44:45] sc1
s_add_u32 s44, s44, 4096
s_addc_u32 s45, s45, 0
global_store_dwordx4 v2, v[8:11], s[44:45] sc1
s_add_u32 s44, s44, 4096
s_addc_u32 s45, s45, 0
global_store_dwordx4 v2, v[8:11], s[44:45] sc1
s_add_u32 s44, s44, 4096
s_addc_u32 s45, s45, 0
global_store_dwordx4 v2, v[8:11], s[44:45] sc1
s_add_u32 s44, s44, 4096
s_addc_u32 s45, s45, 0
global_store_dwordx4 v2, v[8:11], s[44:45] sc1
s_add_u32 s44, s44, 4096
s_addc_u32 s45, s45, 0
global_store_dwordx4 v2, v[8:11], s[44:45] sc1
s_add_u32 s44, s44, 4096
s_addc_u32 s45, s45, 0
global_store_dwordx4 v2, v[8:11], s[44:45] sc1
s_add_u32 s44, s44, 4096
s_addc_u32 s45, s45, 0
global_store_dwordx4 v2, v[8:11], s[44:45] sc1
s_add_u32 s44, s44, 4096
s_addc_u32 s45, s45, 0
global_store_dwordx4 v2, v[8:11], s[44:45] sc1
s_add_u32 s44, s44, 4096
s_addc_u32 s45, s45, 0
global_store_dwordx4 v2, v[8:11], s[44:45] sc1
s_add_u32 s44, s44, 4096
s_addc_u32 s45, s45, 0
global_store_dwordx4 v2, v[8:11], s[44:45] sc1
s_add_u32 s44, s44, 4096
s_addc_u32 s45, s45, 0
global_store_dwordx4 v2, v[8:11], s[44:45] sc1
s_add_u32 s44, s44, 4096
s_addc_u32 s45, s45, 0
global_store_dwordx4 v2, v[8:11], s[44:45] sc1
s_add_u32 s44, s44, 4096
s_addc_u32 s45, s45, 0
global_store_dwordx4 v2, v[8:11], s[44:45] sc1
s_add_u32 s44, s44, 4096
s_addc_u32 s45, s45, 0
global_store_dwordx4 v2, v[8:11], s[44:45] sc1
s_add_u32 s44, s44, 4096
s_addc_u32 s45, s45, 0
global_store_dwordx4 v2, v[8:11], s[44:45] sc1
s_add_u32 s44, s44, 4096
s_addc_u32 s45, s45, 0
global_store_dwordx4 v2, v[8:11], s[44:45] sc1
s_add_u32 s44, s44, 4096
s_addc_u32 s45, s45, 0
global_store_dwordx4 v2, v[8:11], s[44:45] sc1
s_add_u32 s44, s44, 4096
s_addc_u32 s45, s45, 0
global_store_dwordx4 v2, v[8:11], s[44:45] sc1
s_add_u32 s44, s44, 4096
s_addc_u32 s45, s45, 0
global_store_dwordx4 v2, v[8:11], s[44:45] sc1
s_add_u32 s44, s44, 4096
s_addc_u32 s45, s45, 0
global_store_dwordx4 v2, v[8:11], s[44:45] sc1
s_add_u32 s44, s44, 4096
s_addc_u32 s45, s45, 0
global_store_dwordx4 v2, v[8:11], s[44:45] sc1
s_add_u32 s44, s44, 4096
s_addc_u32 s45, s45, 0
global_store_dwordx4 v2, v[8:11], s[44:45] sc1
s_add_u32 s44, s44, 4096
s_addc_u32 s45, s45, 0
global_store_dwordx4 v2, v[8:11], s[44:45] sc1
s_add_u32 s44, s44, 4096
s_addc_u32 s45, s45, 0
global_store_dwordx4 v2, v[8:11], s[44:45] sc1
s_add_u32 s44, s44, 4096
s_addc_u32 s45, s45, 0
global_store_dwordx4 v2, v[8:11], s[44:45] sc1
s_add_u32 s44, s44, 4096
s_addc_u32 s45, s45, 0
global_store_dwordx4 v2, v[8:11], s[44:45] sc1
s_add_u32 s44, s44, 4096
s_addc_u32 s45, s45, 0
global_store_dwordx4 v2, v[8:11], s[44:45] sc1
s_add_u32 s44, s44, 4096
s_addc_u32 s45, s45, 0
global_store_dwordx4 v2, v[8:11], s[44:45] sc1
s_add_u32 s44, s44, 4096
s_addc_u32 s45, s45, 0
global_store_dwordx4 v2, v[8:11], s[44:45] sc1
s_add_u32 s44, s44, 4096
s_addc_u32 s45, s45, 0
global_store_dwordx4 v2, v[8:11], s[44:45] sc1
s_add_u32 s44, s44, 4096
s_addc_u32 s45, s45, 0
s_add_u32 s44, s6, 160
s_addc_u32 s45, s7, 0
s_waitcnt vmcnt(0)
s_barrier
s_cmp_lg_u32 s11, 0
s_cbranch_scc1 SG_2
v_mov_b32 v250, 0
v_mov_b32 v251, 1
s_mov_b64 exec, 1
global_atomic_add v250, v251, s[44:45] offset:0
s_mov_b64 exec, -1
SG_2:
L_noclr:
s_sub_u32 s13, s12, 64
s_cmp_ge_u32 s13, 64
s_cbranch_scc1 L_nomh
s_cmp_lt_u32 s13, 16
s_cbranch_scc1 L_nom
s_sub_u32 s19, s13, 16
s_load_dwordx2 s[40:41], s[0:1], 96
s_load_dwordx2 s[42:43], s[0:1], 104
s_lshl_b32 s34, s11, 6
v_add_u32 v1, s34, v0
v_lshrrev_b32 v2, 3, v1
v_and_b32 v3, 7, v1
v_mul_u32_u24 v4, 6144, v2
v_lshlrev_b32 v5, 4, v3
v_add_u32 v4, v4, v5
s_lshl_b32 s34, s19, 7
v_add_u32 v4, s34, v4
v_lshlrev_b32 v5, 1, v2
s_waitcnt lgkmcnt(0)
global_load_ushort v16, v5, s[40:41] offset:0
global_load_ushort v17, v5, s[40:41] offset:64
global_load_ushort v18, v5, s[40:41] offset:128
global_load_ushort v19, v5, s[40:41] offset:192
global_load_ushort v20, v5, s[40:41] offset:256
global_load_ushort v21, v5, s[40:41] offset:320
global_load_ushort v22, v5, s[40:41] offset:384
global_load_ushort v23, v5, s[40:41] offset:448
global_load_ushort v24, v5, s[40:41] offset:512
global_load_ushort v25, v5, s[40:41] offset:576
global_load_ushort v26, v5, s[40:41] offset:640
global_load_ushort v27, v5, s[40:41] offset:704
global_load_ushort v28, v5, s[40:41] offset:768
global_load_ushort v29, v5, s[40:41] offset:832
global_load_ushort v30, v5, s[40:41] offset:896
global_load_ushort v31, v5, s[40:41] offset:960
global_load_dwordx4 v[32:35], v4, s[42:43]
s_add_u32 s42, s42, 196608
s_addc_u32 s43, s43, 0
global_load_dwordx4 v[36:39], v4, s[42:43]
s_add_u32 s42, s42, 196608
s_addc_u32 s43, s43, 0
global_load_dwordx4 v[40:43], v4, s[42:43]
s_add_u32 s42, s42, 196608
s_addc_u32 s43, s43, 0
global_load_dwordx4 v[44:47], v4, s[42:43]
s_add_u32 s42, s42, 196608
s_addc_u32 s43, s43, 0
global_load_dwordx4 v[48:51], v4, s[42:43]
s_add_u32 s42, s42, 196608
s_addc_u32 s43, s43, 0
global_load_dwordx4 v[52:55], v4, s[42:43]
s_add_u32 s42, s42, 196608
s_addc_u32 s43, s43, 0
global_load_dwordx4 v[56:59], v4, s[42:43]
s_add_u32 s42, s42, 196608
s_addc_u32 s43, s43, 0
global_load_dwordx4 v[60:63], v4, s[42:43]
s_add_u32 s42, s42, 196608
s_addc_u32 s43, s43, 0
global_load_dwordx4 v[64:67], v4, s[42:43]
s_add_u32 s42, s42, 196608
s_addc_u32 s43, s43, 0
global_load_dwordx4 v[68:71], v4, s[42:43]
s_add_u32 s42, s42, 196608
s_addc_u32 s43, s43, 0
global_load_dwordx4 v[72:75], v4, s[42:43]
s_add_u32 s42, s42, 196608
s_addc_u32 s43, s43, 0
global_load_dwordx4 v[76:79], v4, s[42:43]
s_add_u32 s42, s42, 196608
s_addc_u32 s43, s43, 0
global_load_dwordx4 v[80:83], v4, s[42:43]
s_add_u32 s42, s42, 196608
s_addc_u32 s43, s43, 0
global_load_dwordx4 v[84:87], v4, s[42:43]
s_add_u32 s42, s42, 196608
s_addc_u32 s43, s43, 0
global_load_dwordx4 v[88:91], v4, s[42:43]
s_add_u32 s42, s42, 196608
s_addc_u32 s43, s43, 0
global_load_dwordx4 v[92:95], v4, s[42:43]
s_add_u32 s42, s42, 196608
s_addc_u32 s43, s43, 0
v_mov_b32 v100, 0
v_mov_b32 v101, 0
v_mov_b32 v102, 0
v_mov_b32 v103, 0
v_mov_b32 v104, 0
v_mov_b32 v105, 0
v_mov_b32 v106, 0
v_mov_b32 v107, 0
s_waitcnt vmcnt(16)
s_mov_b32 s34, 0xbfb8aa3b
v_lshlrev_b32 v16, 16, v16
v_mul_f32 v110, s34, v16
v_exp_f32 v110, v110
s_nop 0
v_add_f32 v110, 1.0, v110
v_rcp_f32 v110, v110
s_nop 0
v_mul_f32 v16, v16, v110
v_cvt_pk_bf16_f32 v16, v16, v16
v_lshlrev_b32 v16, 16, v16
v_lshlrev_b32 v17, 16, v17
v_mul_f32 v110, s34, v17
v_exp_f32 v110, v110
s_nop 0
v_add_f32 v110, 1.0, v110
v_rcp_f32 v110, v110
s_nop 0
v_mul_f32 v17, v17, v110
v_cvt_pk_bf16_f32 v17, v17, v17
v_lshlrev_b32 v17, 16, v17
v_lshlrev_b32 v18, 16, v18
v_mul_f32 v110, s34, v18
v_exp_f32 v110, v110
s_nop 0
v_add_f32 v110, 1.0, v110
v_rcp_f32 v110, v110
s_nop 0
v_mul_f32 v18, v18, v110
v_cvt_pk_bf16_f32 v18, v18, v18
v_lshlrev_b32 v18, 16, v18
v_lshlrev_b32 v19, 16, v19
v_mul_f32 v110, s34, v19
v_exp_f32 v110, v110
s_nop 0
v_add_f32 v110, 1.0, v110
v_rcp_f32 v110, v110
s_nop 0
v_mul_f32 v19, v19, v110
v_cvt_pk_bf16_f32 v19, v19, v19
v_lshlrev_b32 v19, 16, v19
v_lshlrev_b32 v20, 16, v20
v_mul_f32 v110, s34, v20
v_exp_f32 v110, v110
s_nop 0
v_add_f32 v110, 1.0, v110
v_rcp_f32 v110, v110
s_nop 0
v_mul_f32 v20, v20, v110
v_cvt_pk_bf16_f32 v20, v20, v20
v_lshlrev_b32 v20, 16, v20
v_lshlrev_b32 v21, 16, v21
v_mul_f32 v110, s34, v21
v_exp_f32 v110, v110
s_nop 0
v_add_f32 v110, 1.0, v110
v_rcp_f32 v110, v110
s_nop 0
v_mul_f32 v21, v21, v110
v_cvt_pk_bf16_f32 v21, v21, v21
v_lshlrev_b32 v21, 16, v21
v_lshlrev_b32 v22, 16, v22
v_mul_f32 v110, s34, v22
v_exp_f32 v110, v110
s_nop 0
v_add_f32 v110, 1.0, v110
v_rcp_f32 v110, v110
s_nop 0
v_mul_f32 v22, v22, v110
v_cvt_pk_bf16_f32 v22, v22, v22
v_lshlrev_b32 v22, 16, v22
v_lshlrev_b32 v23, 16, v23
v_mul_f32 v110, s34, v23
v_exp_f32 v110, v110
s_nop 0
v_add_f32 v110, 1.0, v110
v_rcp_f32 v110, v110
s_nop 0
v_mul_f32 v23, v23, v110
v_cvt_pk_bf16_f32 v23, v23, v23
v_lshlrev_b32 v23, 16, v23
v_lshlrev_b32 v24, 16, v24
v_mul_f32 v110, s34, v24
v_exp_f32 v110, v110
s_nop 0
v_add_f32 v110, 1.0, v110
v_rcp_f32 v110, v110
s_nop 0
v_mul_f32 v24, v24, v110
v_cvt_pk_bf16_f32 v24, v24, v24
v_lshlrev_b32 v24, 16, v24
v_lshlrev_b32 v25, 16, v25
v_mul_f32 v110, s34, v25
v_exp_f32 v110, v110
s_nop 0
v_add_f32 v110, 1.0, v110
v_rcp_f32 v110, v110
s_nop 0
v_mul_f32 v25, v25, v110
v_cvt_pk_bf16_f32 v25, v25, v25
v_lshlrev_b32 v25, 16, v25
v_lshlrev_b32 v26, 16, v26
v_mul_f32 v110, s34, v26
v_exp_f32 v110, v110
s_nop 0
v_add_f32 v110, 1.0, v110
v_rcp_f32 v110, v110
s_nop 0
v_mul_f32 v26, v26, v110
v_cvt_pk_bf16_f32 v26, v26, v26
v_lshlrev_b32 v26, 16, v26
v_lshlrev_b32 v27, 16, v27
v_mul_f32 v110, s34, v27
v_exp_f32 v110, v110
s_nop 0
v_add_f32 v110, 1.0, v110
v_rcp_f32 v110, v110
s_nop 0
v_mul_f32 v27, v27, v110
v_cvt_pk_bf16_f32 v27, v27, v27
v_lshlrev_b32 v27, 16, v27
v_lshlrev_b32 v28, 16, v28
v_mul_f32 v110, s34, v28
v_exp_f32 v110, v110
s_nop 0
v_add_f32 v110, 1.0, v110
v_rcp_f32 v110, v110
s_nop 0
v_mul_f32 v28, v28, v110
v_cvt_pk_bf16_f32 v28, v28, v28
v_lshlrev_b32 v28, 16, v28
v_lshlrev_b32 v29, 16, v29
v_mul_f32 v110, s34, v29
v_exp_f32 v110, v110
s_nop 0
v_add_f32 v110, 1.0, v110
v_rcp_f32 v110, v110
s_nop 0
v_mul_f32 v29, v29, v110
v_cvt_pk_bf16_f32 v29, v29, v29
v_lshlrev_b32 v29, 16, v29
v_lshlrev_b32 v30, 16, v30
v_mul_f32 v110, s34, v30
v_exp_f32 v110, v110
s_nop 0
v_add_f32 v110, 1.0, v110
v_rcp_f32 v110, v110
s_nop 0
v_mul_f32 v30, v30, v110
v_cvt_pk_bf16_f32 v30, v30, v30
v_lshlrev_b32 v30, 16, v30
v_lshlrev_b32 v31, 16, v31
v_mul_f32 v110, s34, v31
v_exp_f32 v110, v110
s_nop 0
v_add_f32 v110, 1.0, v110
v_rcp_f32 v110, v110
s_nop 0
v_mul_f32 v31, v31, v110
v_cvt_pk_bf16_f32 v31, v31, v31
v_lshlrev_b32 v31, 16, v31
s_waitcnt vmcnt(0)
v_lshlrev_b32 v110, 16, v32
v_and_b32 v111, 0xffff0000, v32
v_fmac_f32 v100, v16, v110
v_fmac_f32 v101, v16, v111
v_lshlrev_b32 v110, 16, v33
v_and_b32 v111, 0xffff0000, v33
v_fmac_f32 v102, v16, v110
v_fmac_f32 v103, v16, v111
v_lshlrev_b32 v110, 16, v34
v_and_b32 v111, 0xffff0000, v34
v_fmac_f32 v104, v16, v110
v_fmac_f32 v105, v16, v111
v_lshlrev_b32 v110, 16, v35
v_and_b32 v111, 0xffff0000, v35
v_fmac_f32 v106, v16, v110
v_fmac_f32 v107, v16, v111
v_lshlrev_b32 v110, 16, v36
v_and_b32 v111, 0xffff0000, v36
v_fmac_f32 v100, v17, v110
v_fmac_f32 v101, v17, v111
v_lshlrev_b32 v110, 16, v37
v_and_b32 v111, 0xffff0000, v37
v_fmac_f32 v102, v17, v110
v_fmac_f32 v103, v17, v111
v_lshlrev_b32 v110, 16, v38
v_and_b32 v111, 0xffff0000, v38
v_fmac_f32 v104, v17, v110
v_fmac_f32 v105, v17, v111
v_lshlrev_b32 v110, 16, v39
v_and_b32 v111, 0xffff0000, v39
v_fmac_f32 v106, v17, v110
v_fmac_f32 v107, v17, v111
v_lshlrev_b32 v110, 16, v40
v_and_b32 v111, 0xffff0000, v40
v_fmac_f32 v100, v18, v110
v_fmac_f32 v101, v18, v111
v_lshlrev_b32 v110, 16, v41
v_and_b32 v111, 0xffff0000, v41
v_fmac_f32 v102, v18, v110
v_fmac_f32 v103, v18, v111
v_lshlrev_b32 v110, 16, v42
v_and_b32 v111, 0xffff0000, v42
v_fmac_f32 v104, v18, v110
v_fmac_f32 v105, v18, v111
v_lshlrev_b32 v110, 16, v43
v_and_b32 v111, 0xffff0000, v43
v_fmac_f32 v106, v18, v110
v_fmac_f32 v107, v18, v111
v_lshlrev_b32 v110, 16, v44
v_and_b32 v111, 0xffff0000, v44
v_fmac_f32 v100, v19, v110
v_fmac_f32 v101, v19, v111
v_lshlrev_b32 v110, 16, v45
v_and_b32 v111, 0xffff0000, v45
v_fmac_f32 v102, v19, v110
v_fmac_f32 v103, v19, v111
v_lshlrev_b32 v110, 16, v46
v_and_b32 v111, 0xffff0000, v46
v_fmac_f32 v104, v19, v110
v_fmac_f32 v105, v19, v111
v_lshlrev_b32 v110, 16, v47
v_and_b32 v111, 0xffff0000, v47
v_fmac_f32 v106, v19, v110
v_fmac_f32 v107, v19, v111
v_lshlrev_b32 v110, 16, v48
v_and_b32 v111, 0xffff0000, v48
v_fmac_f32 v100, v20, v110
v_fmac_f32 v101, v20, v111
v_lshlrev_b32 v110, 16, v49
v_and_b32 v111, 0xffff0000, v49
v_fmac_f32 v102, v20, v110
v_fmac_f32 v103, v20, v111
v_lshlrev_b32 v110, 16, v50
v_and_b32 v111, 0xffff0000, v50
v_fmac_f32 v104, v20, v110
v_fmac_f32 v105, v20, v111
v_lshlrev_b32 v110, 16, v51
v_and_b32 v111, 0xffff0000, v51
v_fmac_f32 v106, v20, v110
v_fmac_f32 v107, v20, v111
v_lshlrev_b32 v110, 16, v52
v_and_b32 v111, 0xffff0000, v52
v_fmac_f32 v100, v21, v110
v_fmac_f32 v101, v21, v111
v_lshlrev_b32 v110, 16, v53
v_and_b32 v111, 0xffff0000, v53
v_fmac_f32 v102, v21, v110
v_fmac_f32 v103, v21, v111
v_lshlrev_b32 v110, 16, v54
v_and_b32 v111, 0xffff0000, v54
v_fmac_f32 v104, v21, v110
v_fmac_f32 v105, v21, v111
v_lshlrev_b32 v110, 16, v55
v_and_b32 v111, 0xffff0000, v55
v_fmac_f32 v106, v21, v110
v_fmac_f32 v107, v21, v111
v_lshlrev_b32 v110, 16, v56
v_and_b32 v111, 0xffff0000, v56
v_fmac_f32 v100, v22, v110
v_fmac_f32 v101, v22, v111
v_lshlrev_b32 v110, 16, v57
v_and_b32 v111, 0xffff0000, v57
v_fmac_f32 v102, v22, v110
v_fmac_f32 v103, v22, v111
v_lshlrev_b32 v110, 16, v58
v_and_b32 v111, 0xffff0000, v58
v_fmac_f32 v104, v22, v110
v_fmac_f32 v105, v22, v111
v_lshlrev_b32 v110, 16, v59
v_and_b32 v111, 0xffff0000, v59
v_fmac_f32 v106, v22, v110
v_fmac_f32 v107, v22, v111
v_lshlrev_b32 v110, 16, v60
v_and_b32 v111, 0xffff0000, v60
v_fmac_f32 v100, v23, v110
v_fmac_f32 v101, v23, v111
v_lshlrev_b32 v110, 16, v61
v_and_b32 v111, 0xffff0000, v61
v_fmac_f32 v102, v23, v110
v_fmac_f32 v103, v23, v111
v_lshlrev_b32 v110, 16, v62
v_and_b32 v111, 0xffff0000, v62
v_fmac_f32 v104, v23, v110
v_fmac_f32 v105, v23, v111
v_lshlrev_b32 v110, 16, v63
v_and_b32 v111, 0xffff0000, v63
v_fmac_f32 v106, v23, v110
v_fmac_f32 v107, v23, v111
v_lshlrev_b32 v110, 16, v64
v_and_b32 v111, 0xffff0000, v64
v_fmac_f32 v100, v24, v110
v_fmac_f32 v101, v24, v111
v_lshlrev_b32 v110, 16, v65
v_and_b32 v111, 0xffff0000, v65
v_fmac_f32 v102, v24, v110
v_fmac_f32 v103, v24, v111
v_lshlrev_b32 v110, 16, v66
v_and_b32 v111, 0xffff0000, v66
v_fmac_f32 v104, v24, v110
v_fmac_f32 v105, v24, v111
v_lshlrev_b32 v110, 16, v67
v_and_b32 v111, 0xffff0000, v67
v_fmac_f32 v106, v24, v110
v_fmac_f32 v107, v24, v111
v_lshlrev_b32 v110, 16, v68
v_and_b32 v111, 0xffff0000, v68
v_fmac_f32 v100, v25, v110
v_fmac_f32 v101, v25, v111
v_lshlrev_b32 v110, 16, v69
v_and_b32 v111, 0xffff0000, v69
v_fmac_f32 v102, v25, v110
v_fmac_f32 v103, v25, v111
v_lshlrev_b32 v110, 16, v70
v_and_b32 v111, 0xffff0000, v70
v_fmac_f32 v104, v25, v110
v_fmac_f32 v105, v25, v111
v_lshlrev_b32 v110, 16, v71
v_and_b32 v111, 0xffff0000, v71
v_fmac_f32 v106, v25, v110
v_fmac_f32 v107, v25, v111
v_lshlrev_b32 v110, 16, v72
v_and_b32 v111, 0xffff0000, v72
v_fmac_f32 v100, v26, v110
v_fmac_f32 v101, v26, v111
v_lshlrev_b32 v110, 16, v73
v_and_b32 v111, 0xffff0000, v73
v_fmac_f32 v102, v26, v110
v_fmac_f32 v103, v26, v111
v_lshlrev_b32 v110, 16, v74
v_and_b32 v111, 0xffff0000, v74
v_fmac_f32 v104, v26, v110
v_fmac_f32 v105, v26, v111
v_lshlrev_b32 v110, 16, v75
v_and_b32 v111, 0xffff0000, v75
v_fmac_f32 v106, v26, v110
v_fmac_f32 v107, v26, v111
v_lshlrev_b32 v110, 16, v76
v_and_b32 v111, 0xffff0000, v76
v_fmac_f32 v100, v27, v110
v_fmac_f32 v101, v27, v111
v_lshlrev_b32 v110, 16, v77
v_and_b32 v111, 0xffff0000, v77
v_fmac_f32 v102, v27, v110
v_fmac_f32 v103, v27, v111
v_lshlrev_b32 v110, 16, v78
v_and_b32 v111, 0xffff0000, v78
v_fmac_f32 v104, v27, v110
v_fmac_f32 v105, v27, v111
v_lshlrev_b32 v110, 16, v79
v_and_b32 v111, 0xffff0000, v79
v_fmac_f32 v106, v27, v110
v_fmac_f32 v107, v27, v111
v_lshlrev_b32 v110, 16, v80
v_and_b32 v111, 0xffff0000, v80
v_fmac_f32 v100, v28, v110
v_fmac_f32 v101, v28, v111
v_lshlrev_b32 v110, 16, v81
v_and_b32 v111, 0xffff0000, v81
v_fmac_f32 v102, v28, v110
v_fmac_f32 v103, v28, v111
v_lshlrev_b32 v110, 16, v82
v_and_b32 v111, 0xffff0000, v82
v_fmac_f32 v104, v28, v110
v_fmac_f32 v105, v28, v111
v_lshlrev_b32 v110, 16, v83
v_and_b32 v111, 0xffff0000, v83
v_fmac_f32 v106, v28, v110
v_fmac_f32 v107, v28, v111
v_lshlrev_b32 v110, 16, v84
v_and_b32 v111, 0xffff0000, v84
v_fmac_f32 v100, v29, v110
v_fmac_f32 v101, v29, v111
v_lshlrev_b32 v110, 16, v85
v_and_b32 v111, 0xffff0000, v85
v_fmac_f32 v102, v29, v110
v_fmac_f32 v103, v29, v111
v_lshlrev_b32 v110, 16, v86
v_and_b32 v111, 0xffff0000, v86
v_fmac_f32 v104, v29, v110
v_fmac_f32 v105, v29, v111
v_lshlrev_b32 v110, 16, v87
v_and_b32 v111, 0xffff0000, v87
v_fmac_f32 v106, v29, v110
v_fmac_f32 v107, v29, v111
v_lshlrev_b32 v110, 16, v88
v_and_b32 v111, 0xffff0000, v88
v_fmac_f32 v100, v30, v110
v_fmac_f32 v101, v30, v111
v_lshlrev_b32 v110, 16, v89
v_and_b32 v111, 0xffff0000, v89
v_fmac_f32 v102, v30, v110
v_fmac_f32 v103, v30, v111
v_lshlrev_b32 v110, 16, v90
v_and_b32 v111, 0xffff0000, v90
v_fmac_f32 v104, v30, v110
v_fmac_f32 v105, v30, v111
v_lshlrev_b32 v110, 16, v91
v_and_b32 v111, 0xffff0000, v91
v_fmac_f32 v106, v30, v110
v_fmac_f32 v107, v30, v111
v_lshlrev_b32 v110, 16, v92
v_and_b32 v111, 0xffff0000, v92
v_fmac_f32 v100, v31, v110
v_fmac_f32 v101, v31, v111
v_lshlrev_b32 v110, 16, v93
v_and_b32 v111, 0xffff0000, v93
v_fmac_f32 v102, v31, v110
v_fmac_f32 v103, v31, v111
v_lshlrev_b32 v110, 16, v94
v_and_b32 v111, 0xffff0000, v94
v_fmac_f32 v104, v31, v110
v_fmac_f32 v105, v31, v111
v_lshlrev_b32 v110, 16, v95
v_and_b32 v111, 0xffff0000, v95
v_fmac_f32 v106, v31, v110
v_fmac_f32 v107, v31, v111
v_lshlrev_b32 v6, 8, v2
v_lshlrev_b32 v7, 5, v3
v_add_u32 v6, v6, v7
ds_write_b128 v6, v[100:103]
ds_write_b128 v6, v[104:107] offset:16
s_waitcnt lgkmcnt(0)
s_barrier
s_cmp_lg_u32 s11, 0
s_cbranch_scc1 Mskip_3
v_lshlrev_b32 v6, 2, v0
ds_read_b32 v16, v6 offset:0
ds_read_b32 v17, v6 offset:256
ds_read_b32 v18, v6 offset:512
ds_read_b32 v19, v6 offset:768
ds_read_b32 v20, v6 offset:1024
ds_read_b32 v21, v6 offset:1280
ds_read_b32 v22, v6 offset:1536
ds_read_b32 v23, v6 offset:1792
ds_read_b32 v24, v6 offset:2048
ds_read_b32 v25, v6 offset:2304
ds_read_b32 v26, v6 offset:2560
ds_read_b32 v27, v6 offset:2816
ds_read_b32 v28, v6 offset:3072
ds_read_b32 v29, v6 offset:3328
ds_read_b32 v30, v6 offset:3584
ds_read_b32 v31, v6 offset:3840
ds_read_b32 v32, v6 offset:4096
ds_read_b32 v33, v6 offset:4352
ds_read_b32 v34, v6 offset:4608
ds_read_b32 v35, v6 offset:4864
ds_read_b32 v36, v6 offset:5120
ds_read_b32 v37, v6 offset:5376
ds_read_b32 v38, v6 offset:5632
ds_read_b32 v39, v6 offset:5888
ds_read_b32 v40, v6 offset:6144
ds_read_b32 v41, v6 offset:6400
ds_read_b32 v42, v6 offset:6656
ds_read_b32 v43, v6 offset:6912
ds_read_b32 v44, v6 offset:7168
ds_read_b32 v45, v6 offset:7424
ds_read_b32 v46, v6 offset:7680
ds_read_b32 v47, v6 offset:7936
s_waitcnt lgkmcnt(0)
v_add_f32 v16, v16, v32
v_add_f32 v17, v17, v33
v_add_f32 v18, v18, v34
v_add_f32 v19, v19, v35
v_add_f32 v20, v20, v36
v_add_f32 v21, v21, v37
v_add_f32 v22, v22, v38
v_add_f32 v23, v23, v39
v_add_f32 v24, v24, v40
v_add_f32 v25, v25, v41
v_add_f32 v26, v26, v42
v_add_f32 v27, v27, v43
v_add_f32 v28, v28, v44
v_add_f32 v29, v29, v45
v_add_f32 v30, v30, v46
v_add_f32 v31, v31, v47
v_add_f32 v16, v16, v24
v_add_f32 v17, v17, v25
v_add_f32 v18, v18, v26
v_add_f32 v19, v19, v27
v_add_f32 v20, v20, v28
v_add_f32 v21, v21, v29
v_add_f32 v22, v22, v30
v_add_f32 v23, v23, v31
v_add_f32 v16, v16, v20
v_add_f32 v17, v17, v21
v_add_f32 v18, v18, v22
v_add_f32 v19, v19, v23
v_add_f32 v16, v16, v18
v_add_f32 v17, v17, v19
v_add_f32 v16, v16, v17
v_cvt_pk_bf16_f32 v16, v16, v16
v_lshlrev_b32 v16, 16, v16
s_lshl_b32 s34, s19, 8
s_add_u32 s34, s34, 131072
s_add_u32 s44, s4, s34
s_addc_u32 s45, s5, 0
global_store_dword v6, v16, s[44:45] sc1
Mskip_3:
s_cmp_lt_u32 s19, 16
s_cselect_b32 s34, 0, 64
s_add_u32 s34, s34, 128
s_add_u32 s44, s6, s34
s_addc_u32 s45, s7, 0
s_waitcnt vmcnt(0)
s_barrier
s_cmp_lg_u32 s11, 0
s_cbranch_scc1 SG_4
v_mov_b32 v250, 0
v_mov_b32 v251, 1
s_mov_b64 exec, 1
global_atomic_add v250, v251, s[44:45] offset:0
s_mov_b64 exec, -1
SG_4:
s_barrier
L_nom:
s_cmp_lg_u32 s11, 0
s_cbranch_scc1 W1_5
v_mov_b32 v250, 0
s_mov_b32 s96, 0
W_6:
global_load_dword v251, v250, s[6:7] offset:8 sc1
s_waitcnt vmcnt(0)
v_readfirstlane_b32 s97, v251
s_nop 0
s_cmp_ge_u32 s97, 1
s_cbranch_scc1 WE_7
s_sleep 4
s_add_u32 s96, s96, 1
s_cmp_lt_u32 s96, 200000
s_cbranch_scc1 W_6
WE_7:
W1_5:
s_barrier
s_load_dwordx2 s[40:41], s[0:1], 0
v_lshrrev_b32 v2, 3, v0
v_and_b32 v3, 7, v0
s_lshl_b32 s34, s11, 3
v_add_u32 v2, s34, v2
v_lshlrev_b32 v4, 10, v2
v_lshlrev_b32 v5, 4, v3
v_add_u32 v4, v4, v5
s_lshl_b32 s34, s13, 15
v_add_u32 v4, s34, v4
s_waitcnt lgkmcnt(0)
global_load_dwordx4 v[16:19], v4, s[40:41] offset:0
global_load_dwordx4 v[20:23], v4, s[40:41] offset:128
global_load_dwordx4 v[24:27], v4, s[40:41] offset:256
global_load_dwordx4 v[28:31], v4, s[40:41] offset:384
global_load_dwordx4 v[32:35], v4, s[40:41] offset:512
global_load_dwordx4 v[36:39], v4, s[40:41] offset:640
global_load_dwordx4 v[40:43], v4, s[40:41] offset:768
global_load_dwordx4 v[44:47], v4, s[40:41] offset:896
s_waitcnt vmcnt(0)
v_lshlrev_b32 v64, 16, v16
v_and_b32 v65, 0xffff0000, v16
v_lshlrev_b32 v66, 16, v17
v_and_b32 v67, 0xffff0000, v17
v_lshlrev_b32 v68, 16, v18
v_and_b32 v69, 0xffff0000, v18
v_lshlrev_b32 v70, 16, v19
v_and_b32 v71, 0xffff0000, v19
v_lshlrev_b32 v72, 16, v20
v_and_b32 v73, 0xffff0000, v20
v_lshlrev_b32 v74, 16, v21
v_and_b32 v75, 0xffff0000, v21
v_lshlrev_b32 v76, 16, v22
v_and_b32 v77, 0xffff0000, v22
v_lshlrev_b32 v78, 16, v23
v_and_b32 v79, 0xffff0000, v23
v_lshlrev_b32 v80, 16, v24
v_and_b32 v81, 0xffff0000, v24
v_lshlrev_b32 v82, 16, v25
v_and_b32 v83, 0xffff0000, v25
v_lshlrev_b32 v84, 16, v26
v_and_b32 v85, 0xffff0000, v26
v_lshlrev_b32 v86, 16, v27
v_and_b32 v87, 0xffff0000, v27
v_lshlrev_b32 v88, 16, v28
v_and_b32 v89, 0xffff0000, v28
v_lshlrev_b32 v90, 16, v29
v_and_b32 v91, 0xffff0000, v29
v_lshlrev_b32 v92, 16, v30
v_and_b32 v93, 0xffff0000, v30
v_lshlrev_b32 v94, 16, v31
v_and_b32 v95, 0xffff0000, v31
v_lshlrev_b32 v96, 16, v32
v_and_b32 v97, 0xffff0000, v32
v_lshlrev_b32 v98, 16, v33
v_and_b32 v99, 0xffff0000, v33
v_lshlrev_b32 v100, 16, v34
v_and_b32 v101, 0xffff0000, v34
v_lshlrev_b32 v102, 16, v35
v_and_b32 v103, 0xffff0000, v35
v_lshlrev_b32 v104, 16, v36
v_and_b32 v105, 0xffff0000, v36
v_lshlrev_b32 v106, 16, v37
v_and_b32 v107, 0xffff0000, v37
v_lshlrev_b32 v108, 16, v38
v_and_b32 v109, 0xffff0000, v38
v_lshlrev_b32 v110, 16, v39
v_and_b32 v111, 0xffff0000, v39
v_lshlrev_b32 v112, 16, v40
v_and_b32 v113, 0xffff0000, v40
v_lshlrev_b32 v114, 16, v41
v_and_b32 v115, 0xffff0000, v41
v_lshlrev_b32 v116, 16, v42
v_and_b32 v117, 0xffff0000, v42
v_lshlrev_b32 v118, 16, v43
v_and_b32 v119, 0xffff0000, v43
v_lshlrev_b32 v120, 16, v44
v_and_b32 v121, 0xffff0000, v44
v_lshlrev_b32 v122, 16, v45
v_and_b32 v123, 0xffff0000, v45
v_lshlrev_b32 v124, 16, v46
v_and_b32 v125, 0xffff0000, v46
v_lshlrev_b32 v126, 16, v47
v_and_b32 v127, 0xffff0000, v47
s_mov_b32 s35, 0x3727c5ac
v_add_f32 v8, v64, v65
v_add_f32 v9, v66, v67
v_add_f32 v8, v8, v68
v_add_f32 v9, v9, v69
v_add_f32 v8, v8, v70
v_add_f32 v9, v9, v71
v_add_f32 v8, v8, v72
v_add_f32 v9, v9, v73
v_add_f32 v8, v8, v74
v_add_f32 v9, v9, v75
v_add_f32 v8, v8, v76
v_add_f32 v9, v9, v77
v_add_f32 v8, v8, v78
v_add_f32 v9, v9, v79
v_add_f32 v8, v8, v80
v_add_f32 v9, v9, v81
v_add_f32 v8, v8, v82
v_add_f32 v9, v9, v83
v_add_f32 v8, v8, v84
v_add_f32 v9, v9, v85
v_add_f32 v8, v8, v86
v_add_f32 v9, v9, v87
v_add_f32 v8, v8, v88
v_add_f32 v9, v9, v89
v_add_f32 v8, v8, v90
v_add_f32 v9, v9, v91
v_add_f32 v8, v8, v92
v_add_f32 v9, v9, v93
v_add_f32 v8, v8, v94
v_add_f32 v9, v9, v95
v_add_f32 v8, v8, v96
v_add_f32 v9, v9, v97
v_add_f32 v8, v8, v98
v_add_f32 v9, v9, v99
v_add_f32 v8, v8, v100
v_add_f32 v9, v9, v101
v_add_f32 v8, v8, v102
v_add_f32 v9, v9, v103
v_add_f32 v8, v8, v104
v_add_f32 v9, v9, v105
v_add_f32 v8, v8, v106
v_add_f32 v9, v9, v107
v_add_f32 v8, v8, v108
v_add_f32 v9, v9, v109
v_add_f32 v8, v8, v110
v_add_f32 v9, v9, v111
v_add_f32 v8, v8, v112
v_add_f32 v9, v9, v113
v_add_f32 v8, v8, v114
v_add_f32 v9, v9, v115
v_add_f32 v8, v8, v116
v_add_f32 v9, v9, v117
v_add_f32 v8, v8, v118
v_add_f32 v9, v9, v119
v_add_f32 v8, v8, v120
v_add_f32 v9, v9, v121
v_add_f32 v8, v8, v122
v_add_f32 v9, v9, v123
v_add_f32 v8, v8, v124
v_add_f32 v9, v9, v125
v_add_f32 v8, v8, v126
v_add_f32 v9, v9, v127
v_add_f32 v8, v8, v9
s_nop 1
v_add_f32_dpp v8, v8, v8 quad_perm:[1,0,3,2] row_mask:0xf bank_mask:0xf
s_nop 1
v_add_f32_dpp v8, v8, v8 quad_perm:[2,3,0,1] row_mask:0xf bank_mask:0xf
s_nop 1
v_add_f32_dpp v8, v8, v8 row_half_mirror row_mask:0xf bank_mask:0xf
v_mul_f32 v8, 0x3b000000, v8
v_mov_b32 v9, 0
v_mov_b32 v10, 0
v_sub_f32 v11, v64, v8
v_sub_f32 v12, v65, v8
v_fmac_f32 v9, v11, v11
v_fmac_f32 v10, v12, v12
v_sub_f32 v11, v66, v8
v_sub_f32 v12, v67, v8
v_fmac_f32 v9, v11, v11
v_fmac_f32 v10, v12, v12
v_sub_f32 v11, v68, v8
v_sub_f32 v12, v69, v8
v_fmac_f32 v9, v11, v11
v_fmac_f32 v10, v12, v12
v_sub_f32 v11, v70, v8
v_sub_f32 v12, v71, v8
v_fmac_f32 v9, v11, v11
v_fmac_f32 v10, v12, v12
v_sub_f32 v11, v72, v8
v_sub_f32 v12, v73, v8
v_fmac_f32 v9, v11, v11
v_fmac_f32 v10, v12, v12
v_sub_f32 v11, v74, v8
v_sub_f32 v12, v75, v8
v_fmac_f32 v9, v11, v11
v_fmac_f32 v10, v12, v12
v_sub_f32 v11, v76, v8
v_sub_f32 v12, v77, v8
v_fmac_f32 v9, v11, v11
v_fmac_f32 v10, v12, v12
v_sub_f32 v11, v78, v8
v_sub_f32 v12, v79, v8
v_fmac_f32 v9, v11, v11
v_fmac_f32 v10, v12, v12
v_sub_f32 v11, v80, v8
v_sub_f32 v12, v81, v8
v_fmac_f32 v9, v11, v11
v_fmac_f32 v10, v12, v12
v_sub_f32 v11, v82, v8
v_sub_f32 v12, v83, v8
v_fmac_f32 v9, v11, v11
v_fmac_f32 v10, v12, v12
v_sub_f32 v11, v84, v8
v_sub_f32 v12, v85, v8
v_fmac_f32 v9, v11, v11
v_fmac_f32 v10, v12, v12
v_sub_f32 v11, v86, v8
v_sub_f32 v12, v87, v8
v_fmac_f32 v9, v11, v11
v_fmac_f32 v10, v12, v12
v_sub_f32 v11, v88, v8
v_sub_f32 v12, v89, v8
v_fmac_f32 v9, v11, v11
v_fmac_f32 v10, v12, v12
v_sub_f32 v11, v90, v8
v_sub_f32 v12, v91, v8
v_fmac_f32 v9, v11, v11
v_fmac_f32 v10, v12, v12
v_sub_f32 v11, v92, v8
v_sub_f32 v12, v93, v8
v_fmac_f32 v9, v11, v11
v_fmac_f32 v10, v12, v12
v_sub_f32 v11, v94, v8
v_sub_f32 v12, v95, v8
v_fmac_f32 v9, v11, v11
v_fmac_f32 v10, v12, v12
v_sub_f32 v11, v96, v8
v_sub_f32 v12, v97, v8
v_fmac_f32 v9, v11, v11
v_fmac_f32 v10, v12, v12
v_sub_f32 v11, v98, v8
v_sub_f32 v12, v99, v8
v_fmac_f32 v9, v11, v11
v_fmac_f32 v10, v12, v12
v_sub_f32 v11, v100, v8
v_sub_f32 v12, v101, v8
v_fmac_f32 v9, v11, v11
v_fmac_f32 v10, v12, v12
v_sub_f32 v11, v102, v8
v_sub_f32 v12, v103, v8
v_fmac_f32 v9, v11, v11
v_fmac_f32 v10, v12, v12
v_sub_f32 v11, v104, v8
v_sub_f32 v12, v105, v8
v_fmac_f32 v9, v11, v11
v_fmac_f32 v10, v12, v12
v_sub_f32 v11, v106, v8
v_sub_f32 v12, v107, v8
v_fmac_f32 v9, v11, v11
v_fmac_f32 v10, v12, v12
v_sub_f32 v11, v108, v8
v_sub_f32 v12, v109, v8
v_fmac_f32 v9, v11, v11
v_fmac_f32 v10, v12, v12
v_sub_f32 v11, v110, v8
v_sub_f32 v12, v111, v8
v_fmac_f32 v9, v11, v11
v_fmac_f32 v10, v12, v12
v_sub_f32 v11, v112, v8
v_sub_f32 v12, v113, v8
v_fmac_f32 v9, v11, v11
v_fmac_f32 v10, v12, v12
v_sub_f32 v11, v114, v8
v_sub_f32 v12, v115, v8
v_fmac_f32 v9, v11, v11
v_fmac_f32 v10, v12, v12
v_sub_f32 v11, v116, v8
v_sub_f32 v12, v117, v8
v_fmac_f32 v9, v11, v11
v_fmac_f32 v10, v12, v12
v_sub_f32 v11, v118, v8
v_sub_f32 v12, v119, v8
v_fmac_f32 v9, v11, v11
v_fmac_f32 v10, v12, v12
v_sub_f32 v11, v120, v8
v_sub_f32 v12, v121, v8
v_fmac_f32 v9, v11, v11
v_fmac_f32 v10, v12, v12
v_sub_f32 v11, v122, v8
v_sub_f32 v12, v123, v8
v_fmac_f32 v9, v11, v11
v_fmac_f32 v10, v12, v12
v_sub_f32 v11, v124, v8
v_sub_f32 v12, v125, v8
v_fmac_f32 v9, v11, v11
v_fmac_f32 v10, v12, v12
v_sub_f32 v11, v126, v8
v_sub_f32 v12, v127, v8
v_fmac_f32 v9, v11, v11
v_fmac_f32 v10, v12, v12
v_add_f32 v9, v9, v10
s_nop 1
v_add_f32_dpp v9, v9, v9 quad_perm:[1,0,3,2] row_mask:0xf bank_mask:0xf
s_nop 1
v_add_f32_dpp v9, v9, v9 quad_perm:[2,3,0,1] row_mask:0xf bank_mask:0xf
s_nop 1
v_add_f32_dpp v9, v9, v9 row_half_mirror row_mask:0xf bank_mask:0xf
v_mul_f32 v9, 0x3b000000, v9
v_cvt_pk_bf16_f32 v10, v8, v9
v_lshlrev_b32 v8, 16, v10
v_and_b32 v9, 0xffff0000, v10
v_add_f32 v9, s35, v9
v_cvt_pk_bf16_f32 v9, v9, v9
v_lshlrev_b32 v9, 16, v9
v_sqrt_f32 v9, v9
s_nop 0
v_cvt_pk_bf16_f32 v9, v9, v9
v_lshlrev_b32 v9, 16, v9
v_rcp_f32 v9, v9
v_sub_f32 v64, v64, v8
v_sub_f32 v65, v65, v8
v_cvt_pk_bf16_f32 v10, v64, v65
v_lshlrev_b32 v64, 16, v10
v_and_b32 v65, 0xffff0000, v10
v_mul_f32 v64, v64, v9
v_mul_f32 v65, v65, v9
v_cvt_pk_bf16_f32 v10, v64, v65
v_lshlrev_b32 v64, 16, v10
v_and_b32 v65, 0xffff0000, v10
v_sub_f32 v66, v66, v8
v_sub_f32 v67, v67, v8
v_cvt_pk_bf16_f32 v10, v66, v67
v_lshlrev_b32 v66, 16, v10
v_and_b32 v67, 0xffff0000, v10
v_mul_f32 v66, v66, v9
v_mul_f32 v67, v67, v9
v_cvt_pk_bf16_f32 v10, v66, v67
v_lshlrev_b32 v66, 16, v10
v_and_b32 v67, 0xffff0000, v10
v_sub_f32 v68, v68, v8
v_sub_f32 v69, v69, v8
v_cvt_pk_bf16_f32 v10, v68, v69
v_lshlrev_b32 v68, 16, v10
v_and_b32 v69, 0xffff0000, v10
v_mul_f32 v68, v68, v9
v_mul_f32 v69, v69, v9
v_cvt_pk_bf16_f32 v10, v68, v69
v_lshlrev_b32 v68, 16, v10
v_and_b32 v69, 0xffff0000, v10
v_sub_f32 v70, v70, v8
v_sub_f32 v71, v71, v8
v_cvt_pk_bf16_f32 v10, v70, v71
v_lshlrev_b32 v70, 16, v10
v_and_b32 v71, 0xffff0000, v10
v_mul_f32 v70, v70, v9
v_mul_f32 v71, v71, v9
v_cvt_pk_bf16_f32 v10, v70, v71
v_lshlrev_b32 v70, 16, v10
v_and_b32 v71, 0xffff0000, v10
v_sub_f32 v72, v72, v8
v_sub_f32 v73, v73, v8
v_cvt_pk_bf16_f32 v10, v72, v73
v_lshlrev_b32 v72, 16, v10
v_and_b32 v73, 0xffff0000, v10
v_mul_f32 v72, v72, v9
v_mul_f32 v73, v73, v9
v_cvt_pk_bf16_f32 v10, v72, v73
v_lshlrev_b32 v72, 16, v10
v_and_b32 v73, 0xffff0000, v10
v_sub_f32 v74, v74, v8
v_sub_f32 v75, v75, v8
v_cvt_pk_bf16_f32 v10, v74, v75
v_lshlrev_b32 v74, 16, v10
v_and_b32 v75, 0xffff0000, v10
v_mul_f32 v74, v74, v9
v_mul_f32 v75, v75, v9
v_cvt_pk_bf16_f32 v10, v74, v75
v_lshlrev_b32 v74, 16, v10
v_and_b32 v75, 0xffff0000, v10
v_sub_f32 v76, v76, v8
v_sub_f32 v77, v77, v8
v_cvt_pk_bf16_f32 v10, v76, v77
v_lshlrev_b32 v76, 16, v10
v_and_b32 v77, 0xffff0000, v10
v_mul_f32 v76, v76, v9
v_mul_f32 v77, v77, v9
v_cvt_pk_bf16_f32 v10, v76, v77
v_lshlrev_b32 v76, 16, v10
v_and_b32 v77, 0xffff0000, v10
v_sub_f32 v78, v78, v8
v_sub_f32 v79, v79, v8
v_cvt_pk_bf16_f32 v10, v78, v79
v_lshlrev_b32 v78, 16, v10
v_and_b32 v79, 0xffff0000, v10
v_mul_f32 v78, v78, v9
v_mul_f32 v79, v79, v9
v_cvt_pk_bf16_f32 v10, v78, v79
v_lshlrev_b32 v78, 16, v10
v_and_b32 v79, 0xffff0000, v10
v_sub_f32 v80, v80, v8
v_sub_f32 v81, v81, v8
v_cvt_pk_bf16_f32 v10, v80, v81
v_lshlrev_b32 v80, 16, v10
v_and_b32 v81, 0xffff0000, v10
v_mul_f32 v80, v80, v9
v_mul_f32 v81, v81, v9
v_cvt_pk_bf16_f32 v10, v80, v81
v_lshlrev_b32 v80, 16, v10
v_and_b32 v81, 0xffff0000, v10
v_sub_f32 v82, v82, v8
v_sub_f32 v83, v83, v8
v_cvt_pk_bf16_f32 v10, v82, v83
v_lshlrev_b32 v82, 16, v10
v_and_b32 v83, 0xffff0000, v10
v_mul_f32 v82, v82, v9
v_mul_f32 v83, v83, v9
v_cvt_pk_bf16_f32 v10, v82, v83
v_lshlrev_b32 v82, 16, v10
v_and_b32 v83, 0xffff0000, v10
v_sub_f32 v84, v84, v8
v_sub_f32 v85, v85, v8
v_cvt_pk_bf16_f32 v10, v84, v85
v_lshlrev_b32 v84, 16, v10
v_and_b32 v85, 0xffff0000, v10
v_mul_f32 v84, v84, v9
v_mul_f32 v85, v85, v9
v_cvt_pk_bf16_f32 v10, v84, v85
v_lshlrev_b32 v84, 16, v10
v_and_b32 v85, 0xffff0000, v10
v_sub_f32 v86, v86, v8
v_sub_f32 v87, v87, v8
v_cvt_pk_bf16_f32 v10, v86, v87
v_lshlrev_b32 v86, 16, v10
v_and_b32 v87, 0xffff0000, v10
v_mul_f32 v86, v86, v9
v_mul_f32 v87, v87, v9
v_cvt_pk_bf16_f32 v10, v86, v87
v_lshlrev_b32 v86, 16, v10
v_and_b32 v87, 0xffff0000, v10
v_sub_f32 v88, v88, v8
v_sub_f32 v89, v89, v8
v_cvt_pk_bf16_f32 v10, v88, v89
v_lshlrev_b32 v88, 16, v10
v_and_b32 v89, 0xffff0000, v10
v_mul_f32 v88, v88, v9
v_mul_f32 v89, v89, v9
v_cvt_pk_bf16_f32 v10, v88, v89
v_lshlrev_b32 v88, 16, v10
v_and_b32 v89, 0xffff0000, v10
v_sub_f32 v90, v90, v8
v_sub_f32 v91, v91, v8
v_cvt_pk_bf16_f32 v10, v90, v91
v_lshlrev_b32 v90, 16, v10
v_and_b32 v91, 0xffff0000, v10
v_mul_f32 v90, v90, v9
v_mul_f32 v91, v91, v9
v_cvt_pk_bf16_f32 v10, v90, v91
v_lshlrev_b32 v90, 16, v10
v_and_b32 v91, 0xffff0000, v10
v_sub_f32 v92, v92, v8
v_sub_f32 v93, v93, v8
v_cvt_pk_bf16_f32 v10, v92, v93
v_lshlrev_b32 v92, 16, v10
v_and_b32 v93, 0xffff0000, v10
v_mul_f32 v92, v92, v9
v_mul_f32 v93, v93, v9
v_cvt_pk_bf16_f32 v10, v92, v93
v_lshlrev_b32 v92, 16, v10
v_and_b32 v93, 0xffff0000, v10
v_sub_f32 v94, v94, v8
v_sub_f32 v95, v95, v8
v_cvt_pk_bf16_f32 v10, v94, v95
v_lshlrev_b32 v94, 16, v10
v_and_b32 v95, 0xffff0000, v10
v_mul_f32 v94, v94, v9
v_mul_f32 v95, v95, v9
v_cvt_pk_bf16_f32 v10, v94, v95
v_lshlrev_b32 v94, 16, v10
v_and_b32 v95, 0xffff0000, v10
v_sub_f32 v96, v96, v8
v_sub_f32 v97, v97, v8
v_cvt_pk_bf16_f32 v10, v96, v97
v_lshlrev_b32 v96, 16, v10
v_and_b32 v97, 0xffff0000, v10
v_mul_f32 v96, v96, v9
v_mul_f32 v97, v97, v9
v_cvt_pk_bf16_f32 v10, v96, v97
v_lshlrev_b32 v96, 16, v10
v_and_b32 v97, 0xffff0000, v10
v_sub_f32 v98, v98, v8
v_sub_f32 v99, v99, v8
v_cvt_pk_bf16_f32 v10, v98, v99
v_lshlrev_b32 v98, 16, v10
v_and_b32 v99, 0xffff0000, v10
v_mul_f32 v98, v98, v9
v_mul_f32 v99, v99, v9
v_cvt_pk_bf16_f32 v10, v98, v99
v_lshlrev_b32 v98, 16, v10
v_and_b32 v99, 0xffff0000, v10
v_sub_f32 v100, v100, v8
v_sub_f32 v101, v101, v8
v_cvt_pk_bf16_f32 v10, v100, v101
v_lshlrev_b32 v100, 16, v10
v_and_b32 v101, 0xffff0000, v10
v_mul_f32 v100, v100, v9
v_mul_f32 v101, v101, v9
v_cvt_pk_bf16_f32 v10, v100, v101
v_lshlrev_b32 v100, 16, v10
v_and_b32 v101, 0xffff0000, v10
v_sub_f32 v102, v102, v8
v_sub_f32 v103, v103, v8
v_cvt_pk_bf16_f32 v10, v102, v103
v_lshlrev_b32 v102, 16, v10
v_and_b32 v103, 0xffff0000, v10
v_mul_f32 v102, v102, v9
v_mul_f32 v103, v103, v9
v_cvt_pk_bf16_f32 v10, v102, v103
v_lshlrev_b32 v102, 16, v10
v_and_b32 v103, 0xffff0000, v10
v_sub_f32 v104, v104, v8
v_sub_f32 v105, v105, v8
v_cvt_pk_bf16_f32 v10, v104, v105
v_lshlrev_b32 v104, 16, v10
v_and_b32 v105, 0xffff0000, v10
v_mul_f32 v104, v104, v9
v_mul_f32 v105, v105, v9
v_cvt_pk_bf16_f32 v10, v104, v105
v_lshlrev_b32 v104, 16, v10
v_and_b32 v105, 0xffff0000, v10
v_sub_f32 v106, v106, v8
v_sub_f32 v107, v107, v8
v_cvt_pk_bf16_f32 v10, v106, v107
v_lshlrev_b32 v106, 16, v10
v_and_b32 v107, 0xffff0000, v10
v_mul_f32 v106, v106, v9
v_mul_f32 v107, v107, v9
v_cvt_pk_bf16_f32 v10, v106, v107
v_lshlrev_b32 v106, 16, v10
v_and_b32 v107, 0xffff0000, v10
v_sub_f32 v108, v108, v8
v_sub_f32 v109, v109, v8
v_cvt_pk_bf16_f32 v10, v108, v109
v_lshlrev_b32 v108, 16, v10
v_and_b32 v109, 0xffff0000, v10
v_mul_f32 v108, v108, v9
v_mul_f32 v109, v109, v9
v_cvt_pk_bf16_f32 v10, v108, v109
v_lshlrev_b32 v108, 16, v10
v_and_b32 v109, 0xffff0000, v10
v_sub_f32 v110, v110, v8
v_sub_f32 v111, v111, v8
v_cvt_pk_bf16_f32 v10, v110, v111
v_lshlrev_b32 v110, 16, v10
v_and_b32 v111, 0xffff0000, v10
v_mul_f32 v110, v110, v9
v_mul_f32 v111, v111, v9
v_cvt_pk_bf16_f32 v10, v110, v111
v_lshlrev_b32 v110, 16, v10
v_and_b32 v111, 0xffff0000, v10
v_sub_f32 v112, v112, v8
v_sub_f32 v113, v113, v8
v_cvt_pk_bf16_f32 v10, v112, v113
v_lshlrev_b32 v112, 16, v10
v_and_b32 v113, 0xffff0000, v10
v_mul_f32 v112, v112, v9
v_mul_f32 v113, v113, v9
v_cvt_pk_bf16_f32 v10, v112, v113
v_lshlrev_b32 v112, 16, v10
v_and_b32 v113, 0xffff0000, v10
v_sub_f32 v114, v114, v8
v_sub_f32 v115, v115, v8
v_cvt_pk_bf16_f32 v10, v114, v115
v_lshlrev_b32 v114, 16, v10
v_and_b32 v115, 0xffff0000, v10
v_mul_f32 v114, v114, v9
v_mul_f32 v115, v115, v9
v_cvt_pk_bf16_f32 v10, v114, v115
v_lshlrev_b32 v114, 16, v10
v_and_b32 v115, 0xffff0000, v10
v_sub_f32 v116, v116, v8
v_sub_f32 v117, v117, v8
v_cvt_pk_bf16_f32 v10, v116, v117
v_lshlrev_b32 v116, 16, v10
v_and_b32 v117, 0xffff0000, v10
v_mul_f32 v116, v116, v9
v_mul_f32 v117, v117, v9
v_cvt_pk_bf16_f32 v10, v116, v117
v_lshlrev_b32 v116, 16, v10
v_and_b32 v117, 0xffff0000, v10
v_sub_f32 v118, v118, v8
v_sub_f32 v119, v119, v8
v_cvt_pk_bf16_f32 v10, v118, v119
v_lshlrev_b32 v118, 16, v10
v_and_b32 v119, 0xffff0000, v10
v_mul_f32 v118, v118, v9
v_mul_f32 v119, v119, v9
v_cvt_pk_bf16_f32 v10, v118, v119
v_lshlrev_b32 v118, 16, v10
v_and_b32 v119, 0xffff0000, v10
v_sub_f32 v120, v120, v8
v_sub_f32 v121, v121, v8
v_cvt_pk_bf16_f32 v10, v120, v121
v_lshlrev_b32 v120, 16, v10
v_and_b32 v121, 0xffff0000, v10
v_mul_f32 v120, v120, v9
v_mul_f32 v121, v121, v9
v_cvt_pk_bf16_f32 v10, v120, v121
v_lshlrev_b32 v120, 16, v10
v_and_b32 v121, 0xffff0000, v10
v_sub_f32 v122, v122, v8
v_sub_f32 v123, v123, v8
v_cvt_pk_bf16_f32 v10, v122, v123
v_lshlrev_b32 v122, 16, v10
v_and_b32 v123, 0xffff0000, v10
v_mul_f32 v122, v122, v9
v_mul_f32 v123, v123, v9
v_cvt_pk_bf16_f32 v10, v122, v123
v_lshlrev_b32 v122, 16, v10
v_and_b32 v123, 0xffff0000, v10
v_sub_f32 v124, v124, v8
v_sub_f32 v125, v125, v8
v_cvt_pk_bf16_f32 v10, v124, v125
v_lshlrev_b32 v124, 16, v10
v_and_b32 v125, 0xffff0000, v10
v_mul_f32 v124, v124, v9
v_mul_f32 v125, v125, v9
v_cvt_pk_bf16_f32 v10, v124, v125
v_lshlrev_b32 v124, 16, v10
v_and_b32 v125, 0xffff0000, v10
v_sub_f32 v126, v126, v8
v_sub_f32 v127, v127, v8
v_cvt_pk_bf16_f32 v10, v126, v127
v_lshlrev_b32 v126, 16, v10
v_and_b32 v127, 0xffff0000, v10
v_mul_f32 v126, v126, v9
v_mul_f32 v127, v127, v9
v_cvt_pk_bf16_f32 v10, v126, v127
v_lshlrev_b32 v126, 16, v10
v_and_b32 v127, 0xffff0000, v10
s_cmp_lg_u32 s11, 0
s_cbranch_scc1 W1_8
v_mov_b32 v250, 0
s_mov_b32 s96, 0
W_9:
global_load_dword v251, v250, s[6:7] offset:128 sc1
s_waitcnt vmcnt(0)
v_readfirstlane_b32 s97, v251
s_nop 0
s_cmp_ge_u32 s97, 16
s_cbranch_scc1 WE_10
s_sleep 2
s_add_u32 s96, s96, 1
s_cmp_lt_u32 s96, 200000
s_cbranch_scc1 W_9
WE_10:
W1_8:
s_barrier
s_add_u32 s42, s4, 131072
s_addc_u32 s43, s5, 0
v_lshlrev_b32 v6, 5, v3
v_lshrrev_b32 v7, 4, v2
v_lshlrev_b32 v7, 14, v7
v_lshrrev_b32 v8, 2, v3
v_lshlrev_b32 v8, 10, v8
v_add_u32 v7, v7, v8
v_and_b32 v8, 3, v3
v_lshlrev_b32 v8, 8, v8
v_add_u32 v7, v7, v8
v_and_b32 v8, 15, v2
v_lshlrev_b32 v8, 4, v8
v_add_u32 v7, v7, v8
s_lshl_b32 s34, s13, 15
s_add_u32 s34, s34, 4194304
s_add_u32 s44, s4, s34
s_addc_u32 s45, s5, 0
global_load_dwordx4 v[128:131], v6, s[42:43] offset:0 sc1
global_load_dwordx4 v[132:135], v6, s[42:43] offset:16 sc1
global_load_dwordx4 v[192:195], v6, s[42:43] offset:2048 sc1
global_load_dwordx4 v[196:199], v6, s[42:43] offset:2064 sc1
global_load_dwordx4 v[136:139], v6, s[42:43] offset:256 sc1
global_load_dwordx4 v[140:143], v6, s[42:43] offset:272 sc1
global_load_dwordx4 v[200:203], v6, s[42:43] offset:2304 sc1
global_load_dwordx4 v[204:207], v6, s[42:43] offset:2320 sc1
global_load_dwordx4 v[144:147], v6, s[42:43] offset:512 sc1
global_load_dwordx4 v[148:151], v6, s[42:43] offset:528 sc1
global_load_dwordx4 v[208:211], v6, s[42:43] offset:2560 sc1
global_load_dwordx4 v[212:215], v6, s[42:43] offset:2576 sc1
global_load_dwordx4 v[152:155], v6, s[42:43] offset:768 sc1
global_load_dwordx4 v[156:159], v6, s[42:43] offset:784 sc1
global_load_dwordx4 v[216:219], v6, s[42:43] offset:2816 sc1
global_load_dwordx4 v[220:223], v6, s[42:43] offset:2832 sc1
global_load_dwordx4 v[160:163], v6, s[42:43] offset:1024 sc1
global_load_dwordx4 v[164:167], v6, s[42:43] offset:1040 sc1
global_load_dwordx4 v[224:227], v6, s[42:43] offset:3072 sc1
global_load_dwordx4 v[228:231], v6, s[42:43] offset:3088 sc1
global_load_dwordx4 v[168:171], v6, s[42:43] offset:1280 sc1
global_load_dwordx4 v[172:175], v6, s[42:43] offset:1296 sc1
global_load_dwordx4 v[232:235], v6, s[42:43] offset:3328 sc1
global_load_dwordx4 v[236:239], v6, s[42:43] offset:3344 sc1
global_load_dwordx4 v[176:179], v6, s[42:43] offset:1536 sc1
global_load_dwordx4 v[180:183], v6, s[42:43] offset:1552 sc1
global_load_dwordx4 v[240:243], v6, s[42:43] offset:3584 sc1
global_load_dwordx4 v[244:247], v6, s[42:43] offset:3600 sc1
global_load_dwordx4 v[184:187], v6, s[42:43] offset:1792 sc1
global_load_dwordx4 v[188:191], v6, s[42:43] offset:1808 sc1
global_load_dwordx4 v[248:251], v6, s[42:43] offset:3840 sc1
global_load_dwordx4 v[252:255], v6, s[42:43] offset:3856 sc1
s_waitcnt vmcnt(28)
v_add_f32 v192, 1.0, v192
v_add_f32 v193, 1.0, v193
v_cvt_pk_bf16_f32 v10, v192, v193
v_lshlrev_b32 v192, 16, v10
v_and_b32 v193, 0xffff0000, v10
v_mul_f32 v64, v64, v192
v_mul_f32 v65, v65, v193
v_cvt_pk_bf16_f32 v10, v64, v65
v_lshlrev_b32 v64, 16, v10
v_and_b32 v65, 0xffff0000, v10
v_add_f32 v64, v64, v128
v_add_f32 v65, v65, v129
v_cvt_pk_bf16_f32 v32, v64, v65
v_add_f32 v194, 1.0, v194
v_add_f32 v195, 1.0, v195
v_cvt_pk_bf16_f32 v10, v194, v195
v_lshlrev_b32 v194, 16, v10
v_and_b32 v195, 0xffff0000, v10
v_mul_f32 v66, v66, v194
v_mul_f32 v67, v67, v195
v_cvt_pk_bf16_f32 v10, v66, v67
v_lshlrev_b32 v66, 16, v10
v_and_b32 v67, 0xffff0000, v10
v_add_f32 v66, v66, v130
v_add_f32 v67, v67, v131
v_cvt_pk_bf16_f32 v33, v66, v67
v_add_f32 v196, 1.0, v196
v_add_f32 v197, 1.0, v197
v_cvt_pk_bf16_f32 v10, v196, v197
v_lshlrev_b32 v196, 16, v10
v_and_b32 v197, 0xffff0000, v10
v_mul_f32 v68, v68, v196
v_mul_f32 v69, v69, v197
v_cvt_pk_bf16_f32 v10, v68, v69
v_lshlrev_b32 v68, 16, v10
v_and_b32 v69, 0xffff0000, v10
v_add_f32 v68, v68, v132
v_add_f32 v69, v69, v133
v_cvt_pk_bf16_f32 v34, v68, v69
v_add_f32 v198, 1.0, v198
v_add_f32 v199, 1.0, v199
v_cvt_pk_bf16_f32 v10, v198, v199
v_lshlrev_b32 v198, 16, v10
v_and_b32 v199, 0xffff0000, v10
v_mul_f32 v70, v70, v198
v_mul_f32 v71, v71, v199
v_cvt_pk_bf16_f32 v10, v70, v71
v_lshlrev_b32 v70, 16, v10
v_and_b32 v71, 0xffff0000, v10
v_add_f32 v70, v70, v134
v_add_f32 v71, v71, v135
v_cvt_pk_bf16_f32 v35, v70, v71
global_store_dwordx4 v7, v[32:35], s[44:45] sc1
v_add_u32 v7, 2048, v7
s_nop 0
s_waitcnt vmcnt(1)
v_add_f32 v200, 1.0, v200
v_add_f32 v201, 1.0, v201
v_cvt_pk_bf16_f32 v10, v200, v201
v_lshlrev_b32 v200, 16, v10
v_and_b32 v201, 0xffff0000, v10
v_mul_f32 v72, v72, v200
v_mul_f32 v73, v73, v201
v_cvt_pk_bf16_f32 v10, v72, v73
v_lshlrev_b32 v72, 16, v10
v_and_b32 v73, 0xffff0000, v10
v_add_f32 v72, v72, v136
v_add_f32 v73, v73, v137
v_cvt_pk_bf16_f32 v36, v72, v73
v_add_f32 v202, 1.0, v202
v_add_f32 v203, 1.0, v203
v_cvt_pk_bf16_f32 v10, v202, v203
v_lshlrev_b32 v202, 16, v10
v_and_b32 v203, 0xffff0000, v10
v_mul_f32 v74, v74, v202
v_mul_f32 v75, v75, v203
v_cvt_pk_bf16_f32 v10, v74, v75
v_lshlrev_b32 v74, 16, v10
v_and_b32 v75, 0xffff0000, v10
v_add_f32 v74, v74, v138
v_add_f32 v75, v75, v139
v_cvt_pk_bf16_f32 v37, v74, v75
v_add_f32 v204, 1.0, v204
v_add_f32 v205, 1.0, v205
v_cvt_pk_bf16_f32 v10, v204, v205
v_lshlrev_b32 v204, 16, v10
v_and_b32 v205, 0xffff0000, v10
v_mul_f32 v76, v76, v204
v_mul_f32 v77, v77, v205
v_cvt_pk_bf16_f32 v10, v76, v77
v_lshlrev_b32 v76, 16, v10
v_and_b32 v77, 0xffff0000, v10
v_add_f32 v76, v76, v140
v_add_f32 v77, v77, v141
v_cvt_pk_bf16_f32 v38, v76, v77
v_add_f32 v206, 1.0, v206
v_add_f32 v207, 1.0, v207
v_cvt_pk_bf16_f32 v10, v206, v207
v_lshlrev_b32 v206, 16, v10
v_and_b32 v207, 0xffff0000, v10
v_mul_f32 v78, v78, v206
v_mul_f32 v79, v79, v207
v_cvt_pk_bf16_f32 v10, v78, v79
v_lshlrev_b32 v78, 16, v10
v_and_b32 v79, 0xffff0000, v10
v_add_f32 v78, v78, v142
v_add_f32 v79, v79, v143
v_cvt_pk_bf16_f32 v39, v78, v79
global_store_dwordx4 v7, v[36:39], s[44:45] sc1
v_add_u32 v7, 2048, v7
s_nop 0
v_add_f32 v208, 1.0, v208
v_add_f32 v209, 1.0, v209
v_cvt_pk_bf16_f32 v10, v208, v209
v_lshlrev_b32 v208, 16, v10
v_and_b32 v209, 0xffff0000, v10
v_mul_f32 v80, v80, v208
v_mul_f32 v81, v81, v209
v_cvt_pk_bf16_f32 v10, v80, v81
v_lshlrev_b32 v80, 16, v10
v_and_b32 v81, 0xffff0000, v10
v_add_f32 v80, v80, v144
v_add_f32 v81, v81, v145
v_cvt_pk_bf16_f32 v32, v80, v81
v_add_f32 v210, 1.0, v210
v_add_f32 v211, 1.0, v211
v_cvt_pk_bf16_f32 v10, v210, v211
v_lshlrev_b32 v210, 16, v10
v_and_b32 v211, 0xffff0000, v10
v_mul_f32 v82, v82, v210
v_mul_f32 v83, v83, v211
v_cvt_pk_bf16_f32 v10, v82, v83
v_lshlrev_b32 v82, 16, v10
v_and_b32 v83, 0xffff0000, v10
v_add_f32 v82, v82, v146
v_add_f32 v83, v83, v147
v_cvt_pk_bf16_f32 v33, v82, v83
v_add_f32 v212, 1.0, v212
v_add_f32 v213, 1.0, v213
v_cvt_pk_bf16_f32 v10, v212, v213
v_lshlrev_b32 v212, 16, v10
v_and_b32 v213, 0xffff0000, v10
v_mul_f32 v84, v84, v212
v_mul_f32 v85, v85, v213
v_cvt_pk_bf16_f32 v10, v84, v85
v_lshlrev_b32 v84, 16, v10
v_and_b32 v85, 0xffff0000, v10
v_add_f32 v84, v84, v148
v_add_f32 v85, v85, v149
v_cvt_pk_bf16_f32 v34, v84, v85
v_add_f32 v214, 1.0, v214
v_add_f32 v215, 1.0, v215
v_cvt_pk_bf16_f32 v10, v214, v215
v_lshlrev_b32 v214, 16, v10
v_and_b32 v215, 0xffff0000, v10
v_mul_f32 v86, v86, v214
v_mul_f32 v87, v87, v215
v_cvt_pk_bf16_f32 v10, v86, v87
v_lshlrev_b32 v86, 16, v10
v_and_b32 v87, 0xffff0000, v10
v_add_f32 v86, v86, v150
v_add_f32 v87, v87, v151
v_cvt_pk_bf16_f32 v35, v86, v87
global_store_dwordx4 v7, v[32:35], s[44:45] sc1
v_add_u32 v7, 2048, v7
s_nop 0
v_add_f32 v216, 1.0, v216
v_add_f32 v217, 1.0, v217
v_cvt_pk_bf16_f32 v10, v216, v217
v_lshlrev_b32 v216, 16, v10
v_and_b32 v217, 0xffff0000, v10
v_mul_f32 v88, v88, v216
v_mul_f32 v89, v89, v217
v_cvt_pk_bf16_f32 v10, v88, v89
v_lshlrev_b32 v88, 16, v10
v_and_b32 v89, 0xffff0000, v10
v_add_f32 v88, v88, v152
v_add_f32 v89, v89, v153
v_cvt_pk_bf16_f32 v36, v88, v89
v_add_f32 v218, 1.0, v218
v_add_f32 v219, 1.0, v219
v_cvt_pk_bf16_f32 v10, v218, v219
v_lshlrev_b32 v218, 16, v10
v_and_b32 v219, 0xffff0000, v10
v_mul_f32 v90, v90, v218
v_mul_f32 v91, v91, v219
v_cvt_pk_bf16_f32 v10, v90, v91
v_lshlrev_b32 v90, 16, v10
v_and_b32 v91, 0xffff0000, v10
v_add_f32 v90, v90, v154
v_add_f32 v91, v91, v155
v_cvt_pk_bf16_f32 v37, v90, v91
v_add_f32 v220, 1.0, v220
v_add_f32 v221, 1.0, v221
v_cvt_pk_bf16_f32 v10, v220, v221
v_lshlrev_b32 v220, 16, v10
v_and_b32 v221, 0xffff0000, v10
v_mul_f32 v92, v92, v220
v_mul_f32 v93, v93, v221
v_cvt_pk_bf16_f32 v10, v92, v93
v_lshlrev_b32 v92, 16, v10
v_and_b32 v93, 0xffff0000, v10
v_add_f32 v92, v92, v156
v_add_f32 v93, v93, v157
v_cvt_pk_bf16_f32 v38, v92, v93
v_add_f32 v222, 1.0, v222
v_add_f32 v223, 1.0, v223
v_cvt_pk_bf16_f32 v10, v222, v223
v_lshlrev_b32 v222, 16, v10
v_and_b32 v223, 0xffff0000, v10
v_mul_f32 v94, v94, v222
v_mul_f32 v95, v95, v223
v_cvt_pk_bf16_f32 v10, v94, v95
v_lshlrev_b32 v94, 16, v10
v_and_b32 v95, 0xffff0000, v10
v_add_f32 v94, v94, v158
v_add_f32 v95, v95, v159
v_cvt_pk_bf16_f32 v39, v94, v95
global_store_dwordx4 v7, v[36:39], s[44:45] sc1
v_add_u32 v7, 2048, v7
s_nop 0
v_add_f32 v224, 1.0, v224
v_add_f32 v225, 1.0, v225
v_cvt_pk_bf16_f32 v10, v224, v225
v_lshlrev_b32 v224, 16, v10
v_and_b32 v225, 0xffff0000, v10
v_mul_f32 v96, v96, v224
v_mul_f32 v97, v97, v225
v_cvt_pk_bf16_f32 v10, v96, v97
v_lshlrev_b32 v96, 16, v10
v_and_b32 v97, 0xffff0000, v10
v_add_f32 v96, v96, v160
v_add_f32 v97, v97, v161
v_cvt_pk_bf16_f32 v32, v96, v97
v_add_f32 v226, 1.0, v226
v_add_f32 v227, 1.0, v227
v_cvt_pk_bf16_f32 v10, v226, v227
v_lshlrev_b32 v226, 16, v10
v_and_b32 v227, 0xffff0000, v10
v_mul_f32 v98, v98, v226
v_mul_f32 v99, v99, v227
v_cvt_pk_bf16_f32 v10, v98, v99
v_lshlrev_b32 v98, 16, v10
v_and_b32 v99, 0xffff0000, v10
v_add_f32 v98, v98, v162
v_add_f32 v99, v99, v163
v_cvt_pk_bf16_f32 v33, v98, v99
v_add_f32 v228, 1.0, v228
v_add_f32 v229, 1.0, v229
v_cvt_pk_bf16_f32 v10, v228, v229
v_lshlrev_b32 v228, 16, v10
v_and_b32 v229, 0xffff0000, v10
v_mul_f32 v100, v100, v228
v_mul_f32 v101, v101, v229
v_cvt_pk_bf16_f32 v10, v100, v101
v_lshlrev_b32 v100, 16, v10
v_and_b32 v101, 0xffff0000, v10
v_add_f32 v100, v100, v164
v_add_f32 v101, v101, v165
v_cvt_pk_bf16_f32 v34, v100, v101
v_add_f32 v230, 1.0, v230
v_add_f32 v231, 1.0, v231
v_cvt_pk_bf16_f32 v10, v230, v231
v_lshlrev_b32 v230, 16, v10
v_and_b32 v231, 0xffff0000, v10
v_mul_f32 v102, v102, v230
v_mul_f32 v103, v103, v231
v_cvt_pk_bf16_f32 v10, v102, v103
v_lshlrev_b32 v102, 16, v10
v_and_b32 v103, 0xffff0000, v10
v_add_f32 v102, v102, v166
v_add_f32 v103, v103, v167
v_cvt_pk_bf16_f32 v35, v102, v103
global_store_dwordx4 v7, v[32:35], s[44:45] sc1
v_add_u32 v7, 2048, v7
s_nop 0
v_add_f32 v232, 1.0, v232
v_add_f32 v233, 1.0, v233
v_cvt_pk_bf16_f32 v10, v232, v233
v_lshlrev_b32 v232, 16, v10
v_and_b32 v233, 0xffff0000, v10
v_mul_f32 v104, v104, v232
v_mul_f32 v105, v105, v233
v_cvt_pk_bf16_f32 v10, v104, v105
v_lshlrev_b32 v104, 16, v10
v_and_b32 v105, 0xffff0000, v10
v_add_f32 v104, v104, v168
v_add_f32 v105, v105, v169
v_cvt_pk_bf16_f32 v36, v104, v105
v_add_f32 v234, 1.0, v234
v_add_f32 v235, 1.0, v235
v_cvt_pk_bf16_f32 v10, v234, v235
v_lshlrev_b32 v234, 16, v10
v_and_b32 v235, 0xffff0000, v10
v_mul_f32 v106, v106, v234
v_mul_f32 v107, v107, v235
v_cvt_pk_bf16_f32 v10, v106, v107
v_lshlrev_b32 v106, 16, v10
v_and_b32 v107, 0xffff0000, v10
v_add_f32 v106, v106, v170
v_add_f32 v107, v107, v171
v_cvt_pk_bf16_f32 v37, v106, v107
v_add_f32 v236, 1.0, v236
v_add_f32 v237, 1.0, v237
v_cvt_pk_bf16_f32 v10, v236, v237
v_lshlrev_b32 v236, 16, v10
v_and_b32 v237, 0xffff0000, v10
v_mul_f32 v108, v108, v236
v_mul_f32 v109, v109, v237
v_cvt_pk_bf16_f32 v10, v108, v109
v_lshlrev_b32 v108, 16, v10
v_and_b32 v109, 0xffff0000, v10
v_add_f32 v108, v108, v172
v_add_f32 v109, v109, v173
v_cvt_pk_bf16_f32 v38, v108, v109
v_add_f32 v238, 1.0, v238
v_add_f32 v239, 1.0, v239
v_cvt_pk_bf16_f32 v10, v238, v239
v_lshlrev_b32 v238, 16, v10
v_and_b32 v239, 0xffff0000, v10
v_mul_f32 v110, v110, v238
v_mul_f32 v111, v111, v239
v_cvt_pk_bf16_f32 v10, v110, v111
v_lshlrev_b32 v110, 16, v10
v_and_b32 v111, 0xffff0000, v10
v_add_f32 v110, v110, v174
v_add_f32 v111, v111, v175
v_cvt_pk_bf16_f32 v39, v110, v111
global_store_dwordx4 v7, v[36:39], s[44:45] sc1
v_add_u32 v7, 2048, v7
s_nop 0
v_add_f32 v240, 1.0, v240
v_add_f32 v241, 1.0, v241
v_cvt_pk_bf16_f32 v10, v240, v241
v_lshlrev_b32 v240, 16, v10
v_and_b32 v241, 0xffff0000, v10
v_mul_f32 v112, v112, v240
v_mul_f32 v113, v113, v241
v_cvt_pk_bf16_f32 v10, v112, v113
v_lshlrev_b32 v112, 16, v10
v_and_b32 v113, 0xffff0000, v10
v_add_f32 v112, v112, v176
v_add_f32 v113, v113, v177
v_cvt_pk_bf16_f32 v32, v112, v113
v_add_f32 v242, 1.0, v242
v_add_f32 v243, 1.0, v243
v_cvt_pk_bf16_f32 v10, v242, v243
v_lshlrev_b32 v242, 16, v10
v_and_b32 v243, 0xffff0000, v10
v_mul_f32 v114, v114, v242
v_mul_f32 v115, v115, v243
v_cvt_pk_bf16_f32 v10, v114, v115
v_lshlrev_b32 v114, 16, v10
v_and_b32 v115, 0xffff0000, v10
v_add_f32 v114, v114, v178
v_add_f32 v115, v115, v179
v_cvt_pk_bf16_f32 v33, v114, v115
v_add_f32 v244, 1.0, v244
v_add_f32 v245, 1.0, v245
v_cvt_pk_bf16_f32 v10, v244, v245
v_lshlrev_b32 v244, 16, v10
v_and_b32 v245, 0xffff0000, v10
v_mul_f32 v116, v116, v244
v_mul_f32 v117, v117, v245
v_cvt_pk_bf16_f32 v10, v116, v117
v_lshlrev_b32 v116, 16, v10
v_and_b32 v117, 0xffff0000, v10
v_add_f32 v116, v116, v180
v_add_f32 v117, v117, v181
v_cvt_pk_bf16_f32 v34, v116, v117
v_add_f32 v246, 1.0, v246
v_add_f32 v247, 1.0, v247
v_cvt_pk_bf16_f32 v10, v246, v247
v_lshlrev_b32 v246, 16, v10
v_and_b32 v247, 0xffff0000, v10
v_mul_f32 v118, v118, v246
v_mul_f32 v119, v119, v247
v_cvt_pk_bf16_f32 v10, v118, v119
v_lshlrev_b32 v118, 16, v10
v_and_b32 v119, 0xffff0000, v10
v_add_f32 v118, v118, v182
v_add_f32 v119, v119, v183
v_cvt_pk_bf16_f32 v35, v118, v119
global_store_dwordx4 v7, v[32:35], s[44:45] sc1
v_add_u32 v7, 2048, v7
s_nop 0
v_add_f32 v248, 1.0, v248
v_add_f32 v249, 1.0, v249
v_cvt_pk_bf16_f32 v10, v248, v249
v_lshlrev_b32 v248, 16, v10
v_and_b32 v249, 0xffff0000, v10
v_mul_f32 v120, v120, v248
v_mul_f32 v121, v121, v249
v_cvt_pk_bf16_f32 v10, v120, v121
v_lshlrev_b32 v120, 16, v10
v_and_b32 v121, 0xffff0000, v10
v_add_f32 v120, v120, v184
v_add_f32 v121, v121, v185
v_cvt_pk_bf16_f32 v36, v120, v121
v_add_f32 v250, 1.0, v250
v_add_f32 v251, 1.0, v251
v_cvt_pk_bf16_f32 v10, v250, v251
v_lshlrev_b32 v250, 16, v10
v_and_b32 v251, 0xffff0000, v10
v_mul_f32 v122, v122, v250
v_mul_f32 v123, v123, v251
v_cvt_pk_bf16_f32 v10, v122, v123
v_lshlrev_b32 v122, 16, v10
v_and_b32 v123, 0xffff0000, v10
v_add_f32 v122, v122, v186
v_add_f32 v123, v123, v187
v_cvt_pk_bf16_f32 v37, v122, v123
v_add_f32 v252, 1.0, v252
v_add_f32 v253, 1.0, v253
v_cvt_pk_bf16_f32 v10, v252, v253
v_lshlrev_b32 v252, 16, v10
v_and_b32 v253, 0xffff0000, v10
v_mul_f32 v124, v124, v252
v_mul_f32 v125, v125, v253
v_cvt_pk_bf16_f32 v10, v124, v125
v_lshlrev_b32 v124, 16, v10
v_and_b32 v125, 0xffff0000, v10
v_add_f32 v124, v124, v188
v_add_f32 v125, v125, v189
v_cvt_pk_bf16_f32 v38, v124, v125
v_add_f32 v254, 1.0, v254
v_add_f32 v255, 1.0, v255
v_cvt_pk_bf16_f32 v10, v254, v255
v_lshlrev_b32 v254, 16, v10
v_and_b32 v255, 0xffff0000, v10
v_mul_f32 v126, v126, v254
v_mul_f32 v127, v127, v255
v_cvt_pk_bf16_f32 v10, v126, v127
v_lshlrev_b32 v126, 16, v10
v_and_b32 v127, 0xffff0000, v10
v_add_f32 v126, v126, v190
v_add_f32 v127, v127, v191
v_cvt_pk_bf16_f32 v39, v126, v127
global_store_dwordx4 v7, v[36:39], s[44:45] sc1
v_add_u32 v7, 2048, v7
s_lshl_b32 s34, s13, 7
s_add_u32 s34, s34, 0
s_add_u32 s44, s4, s34
s_addc_u32 s45, s5, 0
s_waitcnt vmcnt(0)
s_barrier
s_cmp_lg_u32 s11, 0
s_cbranch_scc1 SG_11
v_mov_b32 v250, 0
v_mov_b32 v251, 1
s_mov_b64 exec, 1
global_atomic_add v250, v251, s[44:45] offset:0
s_mov_b64 exec, -1
SG_11:
s_barrier
L_nomh:
s_cmp_lg_u32 s11, 0
s_cbranch_scc1 W1_12
v_mov_b32 v250, 0
s_mov_b32 s96, 0
W_13:
global_load_dword v251, v250, s[6:7] offset:8 sc1
s_waitcnt vmcnt(0)
v_readfirstlane_b32 s97, v251
s_nop 0
s_cmp_ge_u32 s97, 1
s_cbranch_scc1 WE_14
s_sleep 4
s_add_u32 s96, s96, 1
s_cmp_lt_u32 s96, 200000
s_cbranch_scc1 W_13
WE_14:
W1_12:
s_barrier
s_and_b32 s14, s12, 31
s_lshr_b32 s15, s12, 5
s_lshl_b32 s34, s15, 2
s_lshr_b32 s15, 0x4326510, s34
s_and_b32 s15, s15, 15
s_cmp_lt_u32 s15, 3
s_cbranch_scc1 L_gnd
s_add_u32 s44, s4, 0
s_addc_u32 s45, s5, 0
s_cmp_lg_u32 s11, 0
s_cbranch_scc1 W1_15
v_mov_b32 v250, 0
s_mov_b32 s96, 0
W_16:
global_load_dword v251, v250, s[44:45] offset:0 sc1
s_waitcnt vmcnt(0)
v_readfirstlane_b32 s97, v251
s_nop 0
s_cmp_ge_u32 s97, 1
s_cbranch_scc1 WE_17
s_sleep 16
s_add_u32 s96, s96, 1
s_cmp_lt_u32 s96, 200000
s_cbranch_scc1 W_16
WE_17:
W1_15:
s_barrier
L_gnd:
s_load_dwordx4 s[40:43], s[0:1], 16
s_load_dwordx2 s[44:45], s[0:1], 32
v_lshrrev_b32 v204, 4, v0
v_and_b32 v200, 15, v0
v_lshlrev_b32 v201, 1, v204
v_xor_b32 v200, v200, v201
v_lshlrev_b32 v200, 4, v200
v_xor_b32 v201, 128, v200
s_mov_b32 s34, 8192
v_mul_lo_u32 v204, v204, s34
s_mul_i32 s34, s11, 131072
v_add_u32 v204, s34, v204
v_add_u32 v200, v200, v204
v_add_u32 v201, v201, v204
v_lshrrev_b32 v204, 4, v0
v_bfe_u32 v205, v0, 2, 2
v_lshlrev_b32 v202, 3, v204
v_add_u32 v202, v202, v205
v_lshlrev_b32 v205, 1, v205
v_and_b32 v204, 1, v204
v_lshlrev_b32 v204, 3, v204
v_add_u32 v205, v205, v204
v_lshlrev_b32 v202, 8, v202
v_and_b32 v204, 3, v0
v_lshrrev_b32 v203, 1, v204
v_xor_b32 v205, v205, v203
v_lshlrev_b32 v205, 4, v205
v_add_u32 v202, v202, v205
v_and_b32 v204, 1, v204
v_lshlrev_b32 v204, 3, v204
v_add_u32 v202, v202, v204
s_lshl_b32 s34, s11, 6
v_xor_b32 v210, s34, v202
v_xor_b32 v211, 32, v210
v_add_u32 v212, 0x10000, v210
v_add_u32 v213, 0x10000, v211
s_waitcnt lgkmcnt(0)
s_lshl_b32 s34, s14, 8
s_add_u32 s40, s40, s34
s_addc_u32 s41, s41, 0
s_add_u32 s42, s42, s34
s_addc_u32 s43, s43, 0
s_add_u32 s44, s44, s34
s_addc_u32 s45, s45, 0
v_lshlrev_b32 v2, 4, v0
s_lshl_b32 s34, s11, 13
v_add_u32 v3, s34, v2
s_add_u32 s36, s42, 0
s_addc_u32 s37, s43, 0
s_lshl_b32 s34, s11, 12
s_add_u32 m0, s34, 0
s_nop 0
global_load_lds_dwordx4 v200, s[36:37]
s_add_u32 s36, s42, 32768
s_addc_u32 s37, s43, 0
s_lshl_b32 s34, s11, 12
s_add_u32 m0, s34, 1024
s_nop 0
global_load_lds_dwordx4 v200, s[36:37]
s_add_u32 s36, s42, 65536
s_addc_u32 s37, s43, 0
s_lshl_b32 s34, s11, 12
s_add_u32 m0, s34, 2048
s_nop 0
global_load_lds_dwordx4 v201, s[36:37]
s_add_u32 s36, s42, 98304
s_addc_u32 s37, s43, 0
s_lshl_b32 s34, s11, 12
s_add_u32 m0, s34, 3072
s_nop 0
global_load_lds_dwordx4 v201, s[36:37]
s_add_u32 s36, s42, 524288
s_addc_u32 s37, s43, 0
s_lshl_b32 s34, s11, 12
s_add_u32 m0, s34, 16384
s_nop 0
global_load_lds_dwordx4 v200, s[36:37]
s_add_u32 s36, s42, 557056
s_addc_u32 s37, s43, 0
s_lshl_b32 s34, s11, 12
s_add_u32 m0, s34, 17408
s_nop 0
global_load_lds_dwordx4 v200, s[36:37]
s_add_u32 s36, s42, 589824
s_addc_u32 s37, s43, 0
s_lshl_b32 s34, s11, 12
s_add_u32 m0, s34, 18432
s_nop 0
global_load_lds_dwordx4 v201, s[36:37]
s_add_u32 s36, s42, 622592
s_addc_u32 s37, s43, 0
s_lshl_b32 s34, s11, 12
s_add_u32 m0, s34, 19456
s_nop 0
global_load_lds_dwordx4 v201, s[36:37]
s_add_u32 s36, s42, 1048576
s_addc_u32 s37, s43, 0
s_lshl_b32 s34, s11, 12
s_add_u32 m0, s34, 32768
s_nop 0
global_load_lds_dwordx4 v200, s[36:37]
s_add_u32 s36, s42, 1081344
s_addc_u32 s37, s43, 0
s_lshl_b32 s34, s11, 12
s_add_u32 m0, s34, 33792
s_nop 0
global_load_lds_dwordx4 v200, s[36:37]
s_add_u32 s36, s42, 1114112
s_addc_u32 s37, s43, 0
s_lshl_b32 s34, s11, 12
s_add_u32 m0, s34, 34816
s_nop 0
global_load_lds_dwordx4 v201, s[36:37]
s_add_u32 s36, s42, 1146880
s_addc_u32 s37, s43, 0
s_lshl_b32 s34, s11, 12
s_add_u32 m0, s34, 35840
s_nop 0
global_load_lds_dwordx4 v201, s[36:37]
s_add_u32 s36, s42, 1572864
s_addc_u32 s37, s43, 0
s_lshl_b32 s34, s11, 12
s_add_u32 m0, s34, 49152
s_nop 0
global_load_lds_dwordx4 v200, s[36:37]
s_add_u32 s36, s42, 1605632
s_addc_u32 s37, s43, 0
s_lshl_b32 s34, s11, 12
s_add_u32 m0, s34, 50176
s_nop 0
global_load_lds_dwordx4 v200, s[36:37]
s_add_u32 s36, s42, 1638400
s_addc_u32 s37, s43, 0
s_lshl_b32 s34, s11, 12
s_add_u32 m0, s34, 51200
s_nop 0
global_load_lds_dwordx4 v201, s[36:37]
s_add_u32 s36, s42, 1671168
s_addc_u32 s37, s43, 0
s_lshl_b32 s34, s11, 12
s_add_u32 m0, s34, 52224
s_nop 0
global_load_lds_dwordx4 v201, s[36:37]
s_add_u32 s36, s42, 2097152
s_addc_u32 s37, s43, 0
s_lshl_b32 s34, s11, 12
s_add_u32 m0, s34, 65536
s_nop 0
global_load_lds_dwordx4 v200, s[36:37]
s_add_u32 s36, s42, 2129920
s_addc_u32 s37, s43, 0
s_lshl_b32 s34, s11, 12
s_add_u32 m0, s34, 66560
s_nop 0
global_load_lds_dwordx4 v200, s[36:37]
s_add_u32 s36, s42, 2162688
s_addc_u32 s37, s43, 0
s_lshl_b32 s34, s11, 12
s_add_u32 m0, s34, 67584
s_nop 0
global_load_lds_dwordx4 v201, s[36:37]
s_add_u32 s36, s42, 2195456
s_addc_u32 s37, s43, 0
s_lshl_b32 s34, s11, 12
s_add_u32 m0, s34, 68608
s_nop 0
global_load_lds_dwordx4 v201, s[36:37]
s_add_u32 s36, s42, 2621440
s_addc_u32 s37, s43, 0
s_lshl_b32 s34, s11, 12
s_add_u32 m0, s34, 81920
s_nop 0
global_load_lds_dwordx4 v200, s[36:37]
s_add_u32 s36, s42, 2654208
s_addc_u32 s37, s43, 0
s_lshl_b32 s34, s11, 12
s_add_u32 m0, s34, 82944
s_nop 0
global_load_lds_dwordx4 v200, s[36:37]
s_add_u32 s36, s42, 2686976
s_addc_u32 s37, s43, 0
s_lshl_b32 s34, s11, 12
s_add_u32 m0, s34, 83968
s_nop 0
global_load_lds_dwordx4 v201, s[36:37]
s_add_u32 s36, s42, 2719744
s_addc_u32 s37, s43, 0
s_lshl_b32 s34, s11, 12
s_add_u32 m0, s34, 84992
s_nop 0
global_load_lds_dwordx4 v201, s[36:37]
s_add_u32 s36, s42, 3145728
s_addc_u32 s37, s43, 0
s_lshl_b32 s34, s11, 12
s_add_u32 m0, s34, 98304
s_nop 0
global_load_lds_dwordx4 v200, s[36:37]
s_add_u32 s36, s42, 3178496
s_addc_u32 s37, s43, 0
s_lshl_b32 s34, s11, 12
s_add_u32 m0, s34, 99328
s_nop 0
global_load_lds_dwordx4 v200, s[36:37]
s_add_u32 s36, s42, 3211264
s_addc_u32 s37, s43, 0
s_lshl_b32 s34, s11, 12
s_add_u32 m0, s34, 100352
s_nop 0
global_load_lds_dwordx4 v201, s[36:37]
s_add_u32 s36, s42, 3244032
s_addc_u32 s37, s43, 0
s_lshl_b32 s34, s11, 12
s_add_u32 m0, s34, 101376
s_nop 0
global_load_lds_dwordx4 v201, s[36:37]
s_add_u32 s36, s42, 3670016
s_addc_u32 s37, s43, 0
s_lshl_b32 s34, s11, 12
s_add_u32 m0, s34, 114688
s_nop 0
global_load_lds_dwordx4 v200, s[36:37]
s_add_u32 s36, s42, 3702784
s_addc_u32 s37, s43, 0
s_lshl_b32 s34, s11, 12
s_add_u32 m0, s34, 115712
s_nop 0
global_load_lds_dwordx4 v200, s[36:37]
s_add_u32 s36, s42, 3735552
s_addc_u32 s37, s43, 0
s_lshl_b32 s34, s11, 12
s_add_u32 m0, s34, 116736
s_nop 0
global_load_lds_dwordx4 v201, s[36:37]
s_add_u32 s36, s42, 3768320
s_addc_u32 s37, s43, 0
s_lshl_b32 s34, s11, 12
s_add_u32 m0, s34, 117760
s_nop 0
global_load_lds_dwordx4 v201, s[36:37]
s_waitcnt vmcnt(28)
s_barrier
ds_read_b64_tr_b16 a[0:1], v210 offset:0
ds_read_b64_tr_b16 a[2:3], v210 offset:1024
ds_read_b64_tr_b16 a[4:5], v210 offset:8192
ds_read_b64_tr_b16 a[6:7], v210 offset:9216
ds_read_b64_tr_b16 a[64:65], v211 offset:0
ds_read_b64_tr_b16 a[66:67], v211 offset:1024
ds_read_b64_tr_b16 a[68:69], v211 offset:8192
ds_read_b64_tr_b16 a[70:71], v211 offset:9216
s_waitcnt lgkmcnt(0)
s_barrier
s_add_u32 s36, s44, 0
s_addc_u32 s37, s45, 0
s_lshl_b32 s34, s11, 12
s_add_u32 m0, s34, 0
s_nop 0
global_load_lds_dwordx4 v200, s[36:37]
s_add_u32 s36, s44, 32768
s_addc_u32 s37, s45, 0
s_lshl_b32 s34, s11, 12
s_add_u32 m0, s34, 1024
s_nop 0
global_load_lds_dwordx4 v200, s[36:37]
s_add_u32 s36, s44, 65536
s_addc_u32 s37, s45, 0
s_lshl_b32 s34, s11, 12
s_add_u32 m0, s34, 2048
s_nop 0
global_load_lds_dwordx4 v201, s[36:37]
s_add_u32 s36, s44, 98304
s_addc_u32 s37, s45, 0
s_lshl_b32 s34, s11, 12
s_add_u32 m0, s34, 3072
s_nop 0
global_load_lds_dwordx4 v201, s[36:37]
s_waitcnt vmcnt(28)
s_barrier
ds_read_b64_tr_b16 a[8:9], v210 offset:16384
ds_read_b64_tr_b16 a[10:11], v210 offset:17408
ds_read_b64_tr_b16 a[12:13], v210 offset:24576
ds_read_b64_tr_b16 a[14:15], v210 offset:25600
ds_read_b64_tr_b16 a[72:73], v211 offset:16384
ds_read_b64_tr_b16 a[74:75], v211 offset:17408
ds_read_b64_tr_b16 a[76:77], v211 offset:24576
ds_read_b64_tr_b16 a[78:79], v211 offset:25600
s_waitcnt lgkmcnt(0)
s_barrier
s_add_u32 s36, s44, 524288
s_addc_u32 s37, s45, 0
s_lshl_b32 s34, s11, 12
s_add_u32 m0, s34, 16384
s_nop 0
global_load_lds_dwordx4 v200, s[36:37]
s_add_u32 s36, s44, 557056
s_addc_u32 s37, s45, 0
s_lshl_b32 s34, s11, 12
s_add_u32 m0, s34, 17408
s_nop 0
global_load_lds_dwordx4 v200, s[36:37]
s_add_u32 s36, s44, 589824
s_addc_u32 s37, s45, 0
s_lshl_b32 s34, s11, 12
s_add_u32 m0, s34, 18432
s_nop 0
global_load_lds_dwordx4 v201, s[36:37]
s_add_u32 s36, s44, 622592
s_addc_u32 s37, s45, 0
s_lshl_b32 s34, s11, 12
s_add_u32 m0, s34, 19456
s_nop 0
global_load_lds_dwordx4 v201, s[36:37]
s_waitcnt vmcnt(28)
s_barrier
ds_read_b64_tr_b16 a[16:17], v210 offset:32768
ds_read_b64_tr_b16 a[18:19], v210 offset:33792
ds_read_b64_tr_b16 a[20:21], v210 offset:40960
ds_read_b64_tr_b16 a[22:23], v210 offset:41984
ds_read_b64_tr_b16 a[80:81], v211 offset:32768
ds_read_b64_tr_b16 a[82:83], v211 offset:33792
ds_read_b64_tr_b16 a[84:85], v211 offset:40960
ds_read_b64_tr_b16 a[86:87], v211 offset:41984
s_waitcnt lgkmcnt(0)
s_barrier
s_add_u32 s36, s44, 1048576
s_addc_u32 s37, s45, 0
s_lshl_b32 s34, s11, 12
s_add_u32 m0, s34, 32768
s_nop 0
global_load_lds_dwordx4 v200, s[36:37]
s_add_u32 s36, s44, 1081344
s_addc_u32 s37, s45, 0
s_lshl_b32 s34, s11, 12
s_add_u32 m0, s34, 33792
s_nop 0
global_load_lds_dwordx4 v200, s[36:37]
s_add_u32 s36, s44, 1114112
s_addc_u32 s37, s45, 0
s_lshl_b32 s34, s11, 12
s_add_u32 m0, s34, 34816
s_nop 0
global_load_lds_dwordx4 v201, s[36:37]
s_add_u32 s36, s44, 1146880
s_addc_u32 s37, s45, 0
s_lshl_b32 s34, s11, 12
s_add_u32 m0, s34, 35840
s_nop 0
global_load_lds_dwordx4 v201, s[36:37]
s_waitcnt vmcnt(28)
s_barrier
ds_read_b64_tr_b16 a[24:25], v210 offset:49152
ds_read_b64_tr_b16 a[26:27], v210 offset:50176
ds_read_b64_tr_b16 a[28:29], v210 offset:57344
ds_read_b64_tr_b16 a[30:31], v210 offset:58368
ds_read_b64_tr_b16 a[88:89], v211 offset:49152
ds_read_b64_tr_b16 a[90:91], v211 offset:50176
ds_read_b64_tr_b16 a[92:93], v211 offset:57344
ds_read_b64_tr_b16 a[94:95], v211 offset:58368
s_waitcnt lgkmcnt(0)
s_barrier
s_add_u32 s36, s44, 1572864
s_addc_u32 s37, s45, 0
s_lshl_b32 s34, s11, 12
s_add_u32 m0, s34, 49152
s_nop 0
global_load_lds_dwordx4 v200, s[36:37]
s_add_u32 s36, s44, 1605632
s_addc_u32 s37, s45, 0
s_lshl_b32 s34, s11, 12
s_add_u32 m0, s34, 50176
s_nop 0
global_load_lds_dwordx4 v200, s[36:37]
s_add_u32 s36, s44, 1638400
s_addc_u32 s37, s45, 0
s_lshl_b32 s34, s11, 12
s_add_u32 m0, s34, 51200
s_nop 0
global_load_lds_dwordx4 v201, s[36:37]
s_add_u32 s36, s44, 1671168
s_addc_u32 s37, s45, 0
s_lshl_b32 s34, s11, 12
s_add_u32 m0, s34, 52224
s_nop 0
global_load_lds_dwordx4 v201, s[36:37]
s_waitcnt vmcnt(28)
s_barrier
ds_read_b64_tr_b16 a[32:33], v212 offset:0
ds_read_b64_tr_b16 a[34:35], v212 offset:1024
ds_read_b64_tr_b16 a[36:37], v212 offset:8192
ds_read_b64_tr_b16 a[38:39], v212 offset:9216
ds_read_b64_tr_b16 a[96:97], v213 offset:0
ds_read_b64_tr_b16 a[98:99], v213 offset:1024
ds_read_b64_tr_b16 a[100:101], v213 offset:8192
ds_read_b64_tr_b16 a[102:103], v213 offset:9216
s_waitcnt lgkmcnt(0)
s_barrier
s_add_u32 s36, s44, 2097152
s_addc_u32 s37, s45, 0
s_lshl_b32 s34, s11, 12
s_add_u32 m0, s34, 65536
s_nop 0
global_load_lds_dwordx4 v200, s[36:37]
s_add_u32 s36, s44, 2129920
s_addc_u32 s37, s45, 0
s_lshl_b32 s34, s11, 12
s_add_u32 m0, s34, 66560
s_nop 0
global_load_lds_dwordx4 v200, s[36:37]
s_add_u32 s36, s44, 2162688
s_addc_u32 s37, s45, 0
s_lshl_b32 s34, s11, 12
s_add_u32 m0, s34, 67584
s_nop 0
global_load_lds_dwordx4 v201, s[36:37]
s_add_u32 s36, s44, 2195456
s_addc_u32 s37, s45, 0
s_lshl_b32 s34, s11, 12
s_add_u32 m0, s34, 68608
s_nop 0
global_load_lds_dwordx4 v201, s[36:37]
s_waitcnt vmcnt(28)
s_barrier
ds_read_b64_tr_b16 a[40:41], v212 offset:16384
ds_read_b64_tr_b16 a[42:43], v212 offset:17408
ds_read_b64_tr_b16 a[44:45], v212 offset:24576
ds_read_b64_tr_b16 a[46:47], v212 offset:25600
ds_read_b64_tr_b16 a[104:105], v213 offset:16384
ds_read_b64_tr_b16 a[106:107], v213 offset:17408
ds_read_b64_tr_b16 a[108:109], v213 offset:24576
ds_read_b64_tr_b16 a[110:111], v213 offset:25600
s_waitcnt lgkmcnt(0)
s_barrier
s_add_u32 s36, s44, 2621440
s_addc_u32 s37, s45, 0
s_lshl_b32 s34, s11, 12
s_add_u32 m0, s34, 81920
s_nop 0
global_load_lds_dwordx4 v200, s[36:37]
s_add_u32 s36, s44, 2654208
s_addc_u32 s37, s45, 0
s_lshl_b32 s34, s11, 12
s_add_u32 m0, s34, 82944
s_nop 0
global_load_lds_dwordx4 v200, s[36:37]
s_add_u32 s36, s44, 2686976
s_addc_u32 s37, s45, 0
s_lshl_b32 s34, s11, 12
s_add_u32 m0, s34, 83968
s_nop 0
global_load_lds_dwordx4 v201, s[36:37]
s_add_u32 s36, s44, 2719744
s_addc_u32 s37, s45, 0
s_lshl_b32 s34, s11, 12
s_add_u32 m0, s34, 84992
s_nop 0
global_load_lds_dwordx4 v201, s[36:37]
s_waitcnt vmcnt(28)
s_barrier
ds_read_b64_tr_b16 a[48:49], v212 offset:32768
ds_read_b64_tr_b16 a[50:51], v212 offset:33792
ds_read_b64_tr_b16 a[52:53], v212 offset:40960
ds_read_b64_tr_b16 a[54:55], v212 offset:41984
ds_read_b64_tr_b16 a[112:113], v213 offset:32768
ds_read_b64_tr_b16 a[114:115], v213 offset:33792
ds_read_b64_tr_b16 a[116:117], v213 offset:40960
ds_read_b64_tr_b16 a[118:119], v213 offset:41984
s_waitcnt lgkmcnt(0)
s_barrier
s_add_u32 s36, s44, 3145728
s_addc_u32 s37, s45, 0
s_lshl_b32 s34, s11, 12
s_add_u32 m0, s34, 98304
s_nop 0
global_load_lds_dwordx4 v200, s[36:37]
s_add_u32 s36, s44, 3178496
s_addc_u32 s37, s45, 0
s_lshl_b32 s34, s11, 12
s_add_u32 m0, s34, 99328
s_nop 0
global_load_lds_dwordx4 v200, s[36:37]
s_add_u32 s36, s44, 3211264
s_addc_u32 s37, s45, 0
s_lshl_b32 s34, s11, 12
s_add_u32 m0, s34, 100352
s_nop 0
global_load_lds_dwordx4 v201, s[36:37]
s_add_u32 s36, s44, 3244032
s_addc_u32 s37, s45, 0
s_lshl_b32 s34, s11, 12
s_add_u32 m0, s34, 101376
s_nop 0
global_load_lds_dwordx4 v201, s[36:37]
s_waitcnt vmcnt(28)
s_barrier
ds_read_b64_tr_b16 a[56:57], v212 offset:49152
ds_read_b64_tr_b16 a[58:59], v212 offset:50176
ds_read_b64_tr_b16 a[60:61], v212 offset:57344
ds_read_b64_tr_b16 a[62:63], v212 offset:58368
ds_read_b64_tr_b16 a[120:121], v213 offset:49152
ds_read_b64_tr_b16 a[122:123], v213 offset:50176
ds_read_b64_tr_b16 a[124:125], v213 offset:57344
ds_read_b64_tr_b16 a[126:127], v213 offset:58368
s_waitcnt lgkmcnt(0)
s_barrier
s_add_u32 s36, s44, 3670016
s_addc_u32 s37, s45, 0
s_lshl_b32 s34, s11, 12
s_add_u32 m0, s34, 114688
s_nop 0
global_load_lds_dwordx4 v200, s[36:37]
s_add_u32 s36, s44, 3702784
s_addc_u32 s37, s45, 0
s_lshl_b32 s34, s11, 12
s_add_u32 m0, s34, 115712
s_nop 0
global_load_lds_dwordx4 v200, s[36:37]
s_add_u32 s36, s44, 3735552
s_addc_u32 s37, s45, 0
s_lshl_b32 s34, s11, 12
s_add_u32 m0, s34, 116736
s_nop 0
global_load_lds_dwordx4 v201, s[36:37]
s_add_u32 s36, s44, 3768320
s_addc_u32 s37, s45, 0
s_lshl_b32 s34, s11, 12
s_add_u32 m0, s34, 117760
s_nop 0
global_load_lds_dwordx4 v201, s[36:37]
s_waitcnt vmcnt(28)
s_barrier
ds_read_b64_tr_b16 a[128:129], v210 offset:0
ds_read_b64_tr_b16 a[130:131], v210 offset:1024
ds_read_b64_tr_b16 a[132:133], v210 offset:8192
ds_read_b64_tr_b16 a[134:135], v210 offset:9216
ds_read_b64_tr_b16 a[192:193], v211 offset:0
ds_read_b64_tr_b16 a[194:195], v211 offset:1024
ds_read_b64_tr_b16 a[196:197], v211 offset:8192
ds_read_b64_tr_b16 a[198:199], v211 offset:9216
s_waitcnt lgkmcnt(0)
s_barrier
s_waitcnt vmcnt(24)
s_barrier
ds_read_b64_tr_b16 a[136:137], v210 offset:16384
ds_read_b64_tr_b16 a[138:139], v210 offset:17408
ds_read_b64_tr_b16 a[140:141], v210 offset:24576
ds_read_b64_tr_b16 a[142:143], v210 offset:25600
ds_read_b64_tr_b16 a[200:201], v211 offset:16384
ds_read_b64_tr_b16 a[202:203], v211 offset:17408
ds_read_b64_tr_b16 a[204:205], v211 offset:24576
ds_read_b64_tr_b16 a[206:207], v211 offset:25600
s_waitcnt lgkmcnt(0)
s_barrier
s_waitcnt vmcnt(20)
s_barrier
ds_read_b64_tr_b16 a[144:145], v210 offset:32768
ds_read_b64_tr_b16 a[146:147], v210 offset:33792
ds_read_b64_tr_b16 a[148:149], v210 offset:40960
ds_read_b64_tr_b16 a[150:151], v210 offset:41984
ds_read_b64_tr_b16 a[208:209], v211 offset:32768
ds_read_b64_tr_b16 a[210:211], v211 offset:33792
ds_read_b64_tr_b16 a[212:213], v211 offset:40960
ds_read_b64_tr_b16 a[214:215], v211 offset:41984
s_waitcnt lgkmcnt(0)
s_barrier
s_waitcnt vmcnt(16)
s_barrier
ds_read_b64_tr_b16 a[152:153], v210 offset:49152
ds_read_b64_tr_b16 a[154:155], v210 offset:50176
ds_read_b64_tr_b16 a[156:157], v210 offset:57344
ds_read_b64_tr_b16 a[158:159], v210 offset:58368
ds_read_b64_tr_b16 a[216:217], v211 offset:49152
ds_read_b64_tr_b16 a[218:219], v211 offset:50176
ds_read_b64_tr_b16 a[220:221], v211 offset:57344
ds_read_b64_tr_b16 a[222:223], v211 offset:58368
s_waitcnt lgkmcnt(0)
s_barrier
s_waitcnt vmcnt(12)
s_barrier
ds_read_b64_tr_b16 a[160:161], v212 offset:0
ds_read_b64_tr_b16 a[162:163], v212 offset:1024
ds_read_b64_tr_b16 a[164:165], v212 offset:8192
ds_read_b64_tr_b16 a[166:167], v212 offset:9216
ds_read_b64_tr_b16 a[224:225], v213 offset:0
ds_read_b64_tr_b16 a[226:227], v213 offset:1024
ds_read_b64_tr_b16 a[228:229], v213 offset:8192
ds_read_b64_tr_b16 a[230:231], v213 offset:9216
s_waitcnt lgkmcnt(0)
s_barrier
s_waitcnt vmcnt(8)
s_barrier
ds_read_b64_tr_b16 a[168:169], v212 offset:16384
ds_read_b64_tr_b16 a[170:171], v212 offset:17408
ds_read_b64_tr_b16 a[172:173], v212 offset:24576
ds_read_b64_tr_b16 a[174:175], v212 offset:25600
ds_read_b64_tr_b16 a[232:233], v213 offset:16384
ds_read_b64_tr_b16 a[234:235], v213 offset:17408
ds_read_b64_tr_b16 a[236:237], v213 offset:24576
ds_read_b64_tr_b16 a[238:239], v213 offset:25600
s_waitcnt lgkmcnt(0)
s_barrier
s_waitcnt vmcnt(4)
s_barrier
ds_read_b64_tr_b16 a[176:177], v212 offset:32768
ds_read_b64_tr_b16 a[178:179], v212 offset:33792
ds_read_b64_tr_b16 a[180:181], v212 offset:40960
ds_read_b64_tr_b16 a[182:183], v212 offset:41984
ds_read_b64_tr_b16 a[240:241], v213 offset:32768
ds_read_b64_tr_b16 a[242:243], v213 offset:33792
ds_read_b64_tr_b16 a[244:245], v213 offset:40960
ds_read_b64_tr_b16 a[246:247], v213 offset:41984
s_waitcnt lgkmcnt(0)
s_barrier
s_waitcnt vmcnt(0)
s_barrier
ds_read_b64_tr_b16 a[184:185], v212 offset:49152
ds_read_b64_tr_b16 a[186:187], v212 offset:50176
ds_read_b64_tr_b16 a[188:189], v212 offset:57344
ds_read_b64_tr_b16 a[190:191], v212 offset:58368
ds_read_b64_tr_b16 a[248:249], v213 offset:49152
ds_read_b64_tr_b16 a[250:251], v213 offset:50176
ds_read_b64_tr_b16 a[252:253], v213 offset:57344
ds_read_b64_tr_b16 a[254:255], v213 offset:58368
s_waitcnt lgkmcnt(0)
s_barrier
s_mov_b32 s46, s15
s_mov_b32 s48, 0
s_lshl_b32 s34, s46, 7
s_add_u32 s34, s34, 0
s_add_u32 s50, s4, s34
s_addc_u32 s51, s5, 0
s_cmp_lg_u32 s11, 0
s_cbranch_scc1 W1_18
v_mov_b32 v250, 0
s_mov_b32 s96, 0
W_19:
global_load_dword v251, v250, s[50:51] offset:0 sc1
s_waitcnt vmcnt(0)
v_readfirstlane_b32 s97, v251
s_nop 0
s_cmp_ge_u32 s97, 1
s_cbranch_scc1 WE_20
s_sleep 2
s_add_u32 s96, s96, 1
s_cmp_lt_u32 s96, 200000
s_cbranch_scc1 W_19
WE_20:
W1_18:
s_barrier
s_lshl_b32 s34, s46, 15
s_add_u32 s34, s34, 4194304
s_add_u32 s50, s4, s34
s_addc_u32 s51, s5, 0
s_lshl_b32 s34, s11, 13
s_add_u32 s34, s34, s48
s_add_u32 m0, s34, 0
s_nop 0
global_load_lds_dwordx4 v3, s[50:51] offset:0 sc1
global_load_lds_dwordx4 v3, s[50:51] offset:1024 sc1
global_load_lds_dwordx4 v3, s[50:51] offset:2048 sc1
global_load_lds_dwordx4 v3, s[50:51] offset:3072 sc1
s_lshl_b32 s34, s11, 13
s_add_u32 s34, s34, s48
s_add_u32 m0, s34, 4096
s_add_u32 s50, s50, 4096
s_addc_u32 s51, s51, 0
global_load_lds_dwordx4 v3, s[50:51] offset:0 sc1
global_load_lds_dwordx4 v3, s[50:51] offset:1024 sc1
global_load_lds_dwordx4 v3, s[50:51] offset:2048 sc1
global_load_lds_dwordx4 v3, s[50:51] offset:3072 sc1
Gkv_loop:
s_add_u32 s47, s46, 7
s_waitcnt vmcnt(0)
s_barrier
s_xor_b32 s49, s48, 32768
s_cmp_ge_u32 s47, 64
s_cbranch_scc1 Gn_21
s_lshl_b32 s34, s47, 7
s_add_u32 s34, s34, 0
s_add_u32 s50, s4, s34
s_addc_u32 s51, s5, 0
s_cmp_lg_u32 s11, 0
s_cbranch_scc1 W1_22
v_mov_b32 v250, 0
s_mov_b32 s96, 0
W_23:
global_load_dword v251, v250, s[50:51] offset:0 sc1
s_waitcnt vmcnt(0)
v_readfirstlane_b32 s97, v251
s_nop 0
s_cmp_ge_u32 s97, 1
s_cbranch_scc1 WE_24
s_sleep 2
s_add_u32 s96, s96, 1
s_cmp_lt_u32 s96, 200000
s_cbranch_scc1 W_23
WE_24:
W1_22:
s_barrier
s_lshl_b32 s34, s47, 15
s_add_u32 s34, s34, 4194304
s_add_u32 s50, s4, s34
s_addc_u32 s51, s5, 0
s_lshl_b32 s34, s11, 13
s_add_u32 s34, s34, s49
s_add_u32 m0, s34, 0
s_nop 0
global_load_lds_dwordx4 v3, s[50:51] offset:0 sc1
global_load_lds_dwordx4 v3, s[50:51] offset:1024 sc1
global_load_lds_dwordx4 v3, s[50:51] offset:2048 sc1
global_load_lds_dwordx4 v3, s[50:51] offset:3072 sc1
s_lshl_b32 s34, s11, 13
s_add_u32 s34, s34, s49
s_add_u32 m0, s34, 4096
s_add_u32 s50, s50, 4096
s_addc_u32 s51, s51, 0
global_load_lds_dwordx4 v3, s[50:51] offset:0 sc1
global_load_lds_dwordx4 v3, s[50:51] offset:1024 sc1
global_load_lds_dwordx4 v3, s[50:51] offset:2048 sc1
global_load_lds_dwordx4 v3, s[50:51] offset:3072 sc1
Gn_21:
v_add_u32 v4, s48, v2
v_mov_b64 v[16:17], 0
v_mov_b64 v[18:19], 0
v_mov_b64 v[20:21], 0
v_mov_b64 v[22:23], 0
v_mov_b64 v[24:25], 0
v_mov_b64 v[26:27], 0
v_mov_b64 v[28:29], 0
v_mov_b64 v[30:31], 0
v_mov_b64 v[32:33], 0
v_mov_b64 v[34:35], 0
v_mov_b64 v[36:37], 0
v_mov_b64 v[38:39], 0
v_mov_b64 v[40:41], 0
v_mov_b64 v[42:43], 0
v_mov_b64 v[44:45], 0
v_mov_b64 v[46:47], 0
ds_read_b128 v[64:67], v4 offset:0
ds_read_b128 v[68:71], v4 offset:1024
ds_read_b128 v[72:75], v4 offset:2048
ds_read_b128 v[76:79], v4 offset:3072
ds_read_b128 v[80:83], v4 offset:4096
s_waitcnt lgkmcnt(4)
v_mfma_f32_16x16x32_bf16 v[16:19], a[0:3], v[64:67], v[16:19]
v_mfma_f32_16x16x32_bf16 v[20:23], a[64:67], v[64:67], v[20:23]
v_mfma_f32_16x16x32_bf16 v[32:35], v[64:67], a[128:131], v[32:35]
v_mfma_f32_16x16x32_bf16 v[36:39], v[64:67], a[192:195], v[36:39]
ds_read_b128 v[84:87], v4 offset:5120
s_waitcnt lgkmcnt(4)
v_mfma_f32_16x16x32_bf16 v[16:19], a[4:7], v[68:71], v[16:19]
v_mfma_f32_16x16x32_bf16 v[20:23], a[68:71], v[68:71], v[20:23]
v_mfma_f32_16x16x32_bf16 v[32:35], v[68:71], a[132:135], v[32:35]
v_mfma_f32_16x16x32_bf16 v[36:39], v[68:71], a[196:199], v[36:39]
ds_read_b128 v[88:91], v4 offset:6144
s_waitcnt lgkmcnt(4)
v_mfma_f32_16x16x32_bf16 v[16:19], a[8:11], v[72:75], v[16:19]
v_mfma_f32_16x16x32_bf16 v[20:23], a[72:75], v[72:75], v[20:23]
v_mfma_f32_16x16x32_bf16 v[32:35], v[72:75], a[136:139], v[32:35]
v_mfma_f32_16x16x32_bf16 v[36:39], v[72:75], a[200:203], v[36:39]
ds_read_b128 v[92:95], v4 offset:7168
s_waitcnt lgkmcnt(4)
v_mfma_f32_16x16x32_bf16 v[16:19], a[12:15], v[76:79], v[16:19]
v_mfma_f32_16x16x32_bf16 v[20:23], a[76:79], v[76:79], v[20:23]
v_mfma_f32_16x16x32_bf16 v[32:35], v[76:79], a[140:143], v[32:35]
v_mfma_f32_16x16x32_bf16 v[36:39], v[76:79], a[204:207], v[36:39]
ds_read_b128 v[64:67], v4 offset:8192
s_waitcnt lgkmcnt(4)
v_mfma_f32_16x16x32_bf16 v[16:19], a[16:19], v[80:83], v[16:19]
v_mfma_f32_16x16x32_bf16 v[20:23], a[80:83], v[80:83], v[20:23]
v_mfma_f32_16x16x32_bf16 v[32:35], v[80:83], a[144:147], v[32:35]
v_mfma_f32_16x16x32_bf16 v[36:39], v[80:83], a[208:211], v[36:39]
ds_read_b128 v[68:71], v4 offset:9216
s_waitcnt lgkmcnt(4)
v_mfma_f32_16x16x32_bf16 v[16:19], a[20:23], v[84:87], v[16:19]
v_mfma_f32_16x16x32_bf16 v[20:23], a[84:87], v[84:87], v[20:23]
v_mfma_f32_16x16x32_bf16 v[32:35], v[84:87], a[148:151], v[32:35]
v_mfma_f32_16x16x32_bf16 v[36:39], v[84:87], a[212:215], v[36:39]
ds_read_b128 v[72:75], v4 offset:10240
s_waitcnt lgkmcnt(4)
v_mfma_f32_16x16x32_bf16 v[16:19], a[24:27], v[88:91], v[16:19]
v_mfma_f32_16x16x32_bf16 v[20:23], a[88:91], v[88:91], v[20:23]
v_mfma_f32_16x16x32_bf16 v[32:35], v[88:91], a[152:155], v[32:35]
v_mfma_f32_16x16x32_bf16 v[36:39], v[88:91], a[216:219], v[36:39]
ds_read_b128 v[76:79], v4 offset:11264
s_waitcnt lgkmcnt(4)
v_mfma_f32_16x16x32_bf16 v[16:19], a[28:31], v[92:95], v[16:19]
v_mfma_f32_16x16x32_bf16 v[20:23], a[92:95], v[92:95], v[20:23]
v_mfma_f32_16x16x32_bf16 v[32:35], v[92:95], a[156:159], v[32:35]
v_mfma_f32_16x16x32_bf16 v[36:39], v[92:95], a[220:223], v[36:39]
ds_read_b128 v[80:83], v4 offset:12288
s_waitcnt lgkmcnt(4)
v_mfma_f32_16x16x32_bf16 v[16:19], a[32:35], v[64:67], v[16:19]
v_mfma_f32_16x16x32_bf16 v[20:23], a[96:99], v[64:67], v[20:23]
v_mfma_f32_16x16x32_bf16 v[32:35], v[64:67], a[160:163], v[32:35]
v_mfma_f32_16x16x32_bf16 v[36:39], v[64:67], a[224:227], v[36:39]
ds_read_b128 v[84:87], v4 offset:13312
s_waitcnt lgkmcnt(4)
v_mfma_f32_16x16x32_bf16 v[16:19], a[36:39], v[68:71], v[16:19]
v_mfma_f32_16x16x32_bf16 v[20:23], a[100:103], v[68:71], v[20:23]
v_mfma_f32_16x16x32_bf16 v[32:35], v[68:71], a[164:167], v[32:35]
v_mfma_f32_16x16x32_bf16 v[36:39], v[68:71], a[228:231], v[36:39]
ds_read_b128 v[88:91], v4 offset:14336
s_waitcnt lgkmcnt(4)
v_mfma_f32_16x16x32_bf16 v[16:19], a[40:43], v[72:75], v[16:19]
v_mfma_f32_16x16x32_bf16 v[20:23], a[104:107], v[72:75], v[20:23]
v_mfma_f32_16x16x32_bf16 v[32:35], v[72:75], a[168:171], v[32:35]
v_mfma_f32_16x16x32_bf16 v[36:39], v[72:75], a[232:235], v[36:39]
ds_read_b128 v[92:95], v4 offset:15360
s_waitcnt lgkmcnt(4)
v_mfma_f32_16x16x32_bf16 v[16:19], a[44:47], v[76:79], v[16:19]
v_mfma_f32_16x16x32_bf16 v[20:23], a[108:111], v[76:79], v[20:23]
v_mfma_f32_16x16x32_bf16 v[32:35], v[76:79], a[172:175], v[32:35]
v_mfma_f32_16x16x32_bf16 v[36:39], v[76:79], a[236:239], v[36:39]
ds_read_b128 v[64:67], v4 offset:16384
s_waitcnt lgkmcnt(4)
v_mfma_f32_16x16x32_bf16 v[16:19], a[48:51], v[80:83], v[16:19]
v_mfma_f32_16x16x32_bf16 v[20:23], a[112:115], v[80:83], v[20:23]
v_mfma_f32_16x16x32_bf16 v[32:35], v[80:83], a[176:179], v[32:35]
v_mfma_f32_16x16x32_bf16 v[36:39], v[80:83], a[240:243], v[36:39]
ds_read_b128 v[68:71], v4 offset:17408
s_waitcnt lgkmcnt(4)
v_mfma_f32_16x16x32_bf16 v[16:19], a[52:55], v[84:87], v[16:19]
v_mfma_f32_16x16x32_bf16 v[20:23], a[116:119], v[84:87], v[20:23]
v_mfma_f32_16x16x32_bf16 v[32:35], v[84:87], a[180:183], v[32:35]
v_mfma_f32_16x16x32_bf16 v[36:39], v[84:87], a[244:247], v[36:39]
ds_read_b128 v[72:75], v4 offset:18432
s_waitcnt lgkmcnt(4)
v_mfma_f32_16x16x32_bf16 v[16:19], a[56:59], v[88:91], v[16:19]
v_mfma_f32_16x16x32_bf16 v[20:23], a[120:123], v[88:91], v[20:23]
v_mfma_f32_16x16x32_bf16 v[32:35], v[88:91], a[184:187], v[32:35]
v_mfma_f32_16x16x32_bf16 v[36:39], v[88:91], a[248:251], v[36:39]
ds_read_b128 v[76:79], v4 offset:19456
s_waitcnt lgkmcnt(4)
v_mfma_f32_16x16x32_bf16 v[16:19], a[60:63], v[92:95], v[16:19]
v_mfma_f32_16x16x32_bf16 v[20:23], a[124:127], v[92:95], v[20:23]
v_mfma_f32_16x16x32_bf16 v[32:35], v[92:95], a[188:191], v[32:35]
v_mfma_f32_16x16x32_bf16 v[36:39], v[92:95], a[252:255], v[36:39]
ds_read_b128 v[80:83], v4 offset:20480
s_waitcnt lgkmcnt(4)
v_mfma_f32_16x16x32_bf16 v[24:27], a[0:3], v[64:67], v[24:27]
v_mfma_f32_16x16x32_bf16 v[28:31], a[64:67], v[64:67], v[28:31]
v_mfma_f32_16x16x32_bf16 v[40:43], v[64:67], a[128:131], v[40:43]
v_mfma_f32_16x16x32_bf16 v[44:47], v[64:67], a[192:195], v[44:47]
ds_read_b128 v[84:87], v4 offset:21504
s_waitcnt lgkmcnt(4)
v_mfma_f32_16x16x32_bf16 v[24:27], a[4:7], v[68:71], v[24:27]
v_mfma_f32_16x16x32_bf16 v[28:31], a[68:71], v[68:71], v[28:31]
v_mfma_f32_16x16x32_bf16 v[40:43], v[68:71], a[132:135], v[40:43]
v_mfma_f32_16x16x32_bf16 v[44:47], v[68:71], a[196:199], v[44:47]
ds_read_b128 v[88:91], v4 offset:22528
s_waitcnt lgkmcnt(4)
v_mfma_f32_16x16x32_bf16 v[24:27], a[8:11], v[72:75], v[24:27]
v_mfma_f32_16x16x32_bf16 v[28:31], a[72:75], v[72:75], v[28:31]
v_mfma_f32_16x16x32_bf16 v[40:43], v[72:75], a[136:139], v[40:43]
v_mfma_f32_16x16x32_bf16 v[44:47], v[72:75], a[200:203], v[44:47]
ds_read_b128 v[92:95], v4 offset:23552
s_waitcnt lgkmcnt(4)
v_mfma_f32_16x16x32_bf16 v[24:27], a[12:15], v[76:79], v[24:27]
v_mfma_f32_16x16x32_bf16 v[28:31], a[76:79], v[76:79], v[28:31]
v_mfma_f32_16x16x32_bf16 v[40:43], v[76:79], a[140:143], v[40:43]
v_mfma_f32_16x16x32_bf16 v[44:47], v[76:79], a[204:207], v[44:47]
ds_read_b128 v[64:67], v4 offset:24576
s_waitcnt lgkmcnt(4)
v_mfma_f32_16x16x32_bf16 v[24:27], a[16:19], v[80:83], v[24:27]
v_mfma_f32_16x16x32_bf16 v[28:31], a[80:83], v[80:83], v[28:31]
v_mfma_f32_16x16x32_bf16 v[40:43], v[80:83], a[144:147], v[40:43]
v_mfma_f32_16x16x32_bf16 v[44:47], v[80:83], a[208:211], v[44:47]
ds_read_b128 v[68:71], v4 offset:25600
s_waitcnt lgkmcnt(4)
v_mfma_f32_16x16x32_bf16 v[24:27], a[20:23], v[84:87], v[24:27]
v_mfma_f32_16x16x32_bf16 v[28:31], a[84:87], v[84:87], v[28:31]
v_mfma_f32_16x16x32_bf16 v[40:43], v[84:87], a[148:151], v[40:43]
v_mfma_f32_16x16x32_bf16 v[44:47], v[84:87], a[212:215], v[44:47]
ds_read_b128 v[72:75], v4 offset:26624
s_waitcnt lgkmcnt(4)
v_mfma_f32_16x16x32_bf16 v[24:27], a[24:27], v[88:91], v[24:27]
v_mfma_f32_16x16x32_bf16 v[28:31], a[88:91], v[88:91], v[28:31]
v_mfma_f32_16x16x32_bf16 v[40:43], v[88:91], a[152:155], v[40:43]
v_mfma_f32_16x16x32_bf16 v[44:47], v[88:91], a[216:219], v[44:47]
ds_read_b128 v[76:79], v4 offset:27648
s_waitcnt lgkmcnt(4)
v_mfma_f32_16x16x32_bf16 v[24:27], a[28:31], v[92:95], v[24:27]
v_mfma_f32_16x16x32_bf16 v[28:31], a[92:95], v[92:95], v[28:31]
v_mfma_f32_16x16x32_bf16 v[40:43], v[92:95], a[156:159], v[40:43]
v_mfma_f32_16x16x32_bf16 v[44:47], v[92:95], a[220:223], v[44:47]
ds_read_b128 v[80:83], v4 offset:28672
s_waitcnt lgkmcnt(4)
v_mfma_f32_16x16x32_bf16 v[24:27], a[32:35], v[64:67], v[24:27]
v_mfma_f32_16x16x32_bf16 v[28:31], a[96:99], v[64:67], v[28:31]
v_mfma_f32_16x16x32_bf16 v[40:43], v[64:67], a[160:163], v[40:43]
v_mfma_f32_16x16x32_bf16 v[44:47], v[64:67], a[224:227], v[44:47]
ds_read_b128 v[84:87], v4 offset:29696
s_waitcnt lgkmcnt(4)
v_mfma_f32_16x16x32_bf16 v[24:27], a[36:39], v[68:71], v[24:27]
v_mfma_f32_16x16x32_bf16 v[28:31], a[100:103], v[68:71], v[28:31]
v_mfma_f32_16x16x32_bf16 v[40:43], v[68:71], a[164:167], v[40:43]
v_mfma_f32_16x16x32_bf16 v[44:47], v[68:71], a[228:231], v[44:47]
ds_read_b128 v[88:91], v4 offset:30720
s_waitcnt lgkmcnt(4)
v_mfma_f32_16x16x32_bf16 v[24:27], a[40:43], v[72:75], v[24:27]
v_mfma_f32_16x16x32_bf16 v[28:31], a[104:107], v[72:75], v[28:31]
v_mfma_f32_16x16x32_bf16 v[40:43], v[72:75], a[168:171], v[40:43]
v_mfma_f32_16x16x32_bf16 v[44:47], v[72:75], a[232:235], v[44:47]
ds_read_b128 v[92:95], v4 offset:31744
s_waitcnt lgkmcnt(4)
v_mfma_f32_16x16x32_bf16 v[24:27], a[44:47], v[76:79], v[24:27]
v_mfma_f32_16x16x32_bf16 v[28:31], a[108:111], v[76:79], v[28:31]
v_mfma_f32_16x16x32_bf16 v[40:43], v[76:79], a[172:175], v[40:43]
v_mfma_f32_16x16x32_bf16 v[44:47], v[76:79], a[236:239], v[44:47]
s_waitcnt lgkmcnt(3)
v_mfma_f32_16x16x32_bf16 v[24:27], a[48:51], v[80:83], v[24:27]
v_mfma_f32_16x16x32_bf16 v[28:31], a[112:115], v[80:83], v[28:31]
v_mfma_f32_16x16x32_bf16 v[40:43], v[80:83], a[176:179], v[40:43]
v_mfma_f32_16x16x32_bf16 v[44:47], v[80:83], a[240:243], v[44:47]
s_waitcnt lgkmcnt(2)
v_mfma_f32_16x16x32_bf16 v[24:27], a[52:55], v[84:87], v[24:27]
v_mfma_f32_16x16x32_bf16 v[28:31], a[116:119], v[84:87], v[28:31]
v_mfma_f32_16x16x32_bf16 v[40:43], v[84:87], a[180:183], v[40:43]
v_mfma_f32_16x16x32_bf16 v[44:47], v[84:87], a[244:247], v[44:47]
s_waitcnt lgkmcnt(1)
v_mfma_f32_16x16x32_bf16 v[24:27], a[56:59], v[88:91], v[24:27]
v_mfma_f32_16x16x32_bf16 v[28:31], a[120:123], v[88:91], v[28:31]
v_mfma_f32_16x16x32_bf16 v[40:43], v[88:91], a[184:187], v[40:43]
v_mfma_f32_16x16x32_bf16 v[44:47], v[88:91], a[248:251], v[44:47]
s_waitcnt lgkmcnt(0)
v_mfma_f32_16x16x32_bf16 v[24:27], a[60:63], v[92:95], v[24:27]
v_mfma_f32_16x16x32_bf16 v[28:31], a[124:127], v[92:95], v[28:31]
v_mfma_f32_16x16x32_bf16 v[40:43], v[92:95], a[188:191], v[40:43]
v_mfma_f32_16x16x32_bf16 v[44:47], v[92:95], a[252:255], v[44:47]
s_lshl_b32 s34, s46, 18
s_lshl_b32 s35, s14, 13
s_add_u32 s34, s34, s35
s_add_u32 s35, s34, 33554432
s_add_u32 s52, s4, s35
s_addc_u32 s53, s5, 0
s_lshl_b32 s35, s11, 10
v_add_u32 v5, s35, v2
v_cvt_pk_bf16_f32 v100, v16, v17
v_cvt_pk_bf16_f32 v101, v18, v19
v_cvt_pk_bf16_f32 v102, v20, v21
v_cvt_pk_bf16_f32 v103, v22, v23
v_cvt_pk_bf16_f32 v104, v24, v25
v_cvt_pk_bf16_f32 v105, v26, v27
v_cvt_pk_bf16_f32 v106, v28, v29
v_cvt_pk_bf16_f32 v107, v30, v31
global_store_dwordx4 v5, v[100:103], s[52:53] sc1
v_add_u32 v6, 4096, v5
global_store_dwordx4 v6, v[104:107], s[52:53] sc1
s_add_u32 s35, s34, 50331648
s_add_u32 s52, s4, s35
s_addc_u32 s53, s5, 0
s_lshl_b32 s35, s11, 11
v_add_u32 v5, s35, v2
v_cvt_pk_bf16_f32 v108, v32, v33
v_cvt_pk_bf16_f32 v109, v34, v35
v_cvt_pk_bf16_f32 v110, v40, v41
v_cvt_pk_bf16_f32 v111, v42, v43
global_store_dwordx4 v5, v[108:111], s[52:53] offset:0 sc1
v_cvt_pk_bf16_f32 v112, v36, v37
v_cvt_pk_bf16_f32 v113, v38, v39
v_cvt_pk_bf16_f32 v114, v44, v45
v_cvt_pk_bf16_f32 v115, v46, v47
global_store_dwordx4 v5, v[112:115], s[52:53] offset:1024 sc1
s_lshl_b32 s34, s46, 7
s_add_u32 s34, s34, 8192
s_add_u32 s52, s4, s34
s_addc_u32 s53, s5, 0
s_waitcnt vmcnt(0)
s_barrier
s_cmp_lg_u32 s11, 0
s_cbranch_scc1 SG_25
v_mov_b32 v250, 0
v_mov_b32 v251, 1
s_mov_b64 exec, 1
global_atomic_add v250, v251, s[52:53] offset:0
s_mov_b64 exec, -1
SG_25:
s_mov_b32 s46, s47
s_mov_b32 s48, s49
s_cmp_lt_u32 s46, 64
s_cbranch_scc1 Gkv_loop
s_barrier
s_add_u32 s36, s40, 0
s_addc_u32 s37, s41, 0
s_lshl_b32 s34, s11, 12
s_add_u32 m0, s34, 0
s_nop 0
global_load_lds_dwordx4 v200, s[36:37]
s_add_u32 s36, s40, 32768
s_addc_u32 s37, s41, 0
s_lshl_b32 s34, s11, 12
s_add_u32 m0, s34, 1024
s_nop 0
global_load_lds_dwordx4 v200, s[36:37]
s_add_u32 s36, s40, 65536
s_addc_u32 s37, s41, 0
s_lshl_b32 s34, s11, 12
s_add_u32 m0, s34, 2048
s_nop 0
global_load_lds_dwordx4 v201, s[36:37]
s_add_u32 s36, s40, 98304
s_addc_u32 s37, s41, 0
s_lshl_b32 s34, s11, 12
s_add_u32 m0, s34, 3072
s_nop 0
global_load_lds_dwordx4 v201, s[36:37]
s_add_u32 s36, s40, 524288
s_addc_u32 s37, s41, 0
s_lshl_b32 s34, s11, 12
s_add_u32 m0, s34, 16384
s_nop 0
global_load_lds_dwordx4 v200, s[36:37]
s_add_u32 s36, s40, 557056
s_addc_u32 s37, s41, 0
s_lshl_b32 s34, s11, 12
s_add_u32 m0, s34, 17408
s_nop 0
global_load_lds_dwordx4 v200, s[36:37]
s_add_u32 s36, s40, 589824
s_addc_u32 s37, s41, 0
s_lshl_b32 s34, s11, 12
s_add_u32 m0, s34, 18432
s_nop 0
global_load_lds_dwordx4 v201, s[36:37]
s_add_u32 s36, s40, 622592
s_addc_u32 s37, s41, 0
s_lshl_b32 s34, s11, 12
s_add_u32 m0, s34, 19456
s_nop 0
global_load_lds_dwordx4 v201, s[36:37]
s_add_u32 s36, s40, 1048576
s_addc_u32 s37, s41, 0
s_lshl_b32 s34, s11, 12
s_add_u32 m0, s34, 32768
s_nop 0
global_load_lds_dwordx4 v200, s[36:37]
s_add_u32 s36, s40, 1081344
s_addc_u32 s37, s41, 0
s_lshl_b32 s34, s11, 12
s_add_u32 m0, s34, 33792
s_nop 0
global_load_lds_dwordx4 v200, s[36:37]
s_add_u32 s36, s40, 1114112
s_addc_u32 s37, s41, 0
s_lshl_b32 s34, s11, 12
s_add_u32 m0, s34, 34816
s_nop 0
global_load_lds_dwordx4 v201, s[36:37]
s_add_u32 s36, s40, 1146880
s_addc_u32 s37, s41, 0
s_lshl_b32 s34, s11, 12
s_add_u32 m0, s34, 35840
s_nop 0
global_load_lds_dwordx4 v201, s[36:37]
s_add_u32 s36, s40, 1572864
s_addc_u32 s37, s41, 0
s_lshl_b32 s34, s11, 12
s_add_u32 m0, s34, 49152
s_nop 0
global_load_lds_dwordx4 v200, s[36:37]
s_add_u32 s36, s40, 1605632
s_addc_u32 s37, s41, 0
s_lshl_b32 s34, s11, 12
s_add_u32 m0, s34, 50176
s_nop 0
global_load_lds_dwordx4 v200, s[36:37]
s_add_u32 s36, s40, 1638400
s_addc_u32 s37, s41, 0
s_lshl_b32 s34, s11, 12
s_add_u32 m0, s34, 51200
s_nop 0
global_load_lds_dwordx4 v201, s[36:37]
s_add_u32 s36, s40, 1671168
s_addc_u32 s37, s41, 0
s_lshl_b32 s34, s11, 12
s_add_u32 m0, s34, 52224
s_nop 0
global_load_lds_dwordx4 v201, s[36:37]
s_add_u32 s36, s40, 2097152
s_addc_u32 s37, s41, 0
s_lshl_b32 s34, s11, 12
s_add_u32 m0, s34, 65536
s_nop 0
global_load_lds_dwordx4 v200, s[36:37]
s_add_u32 s36, s40, 2129920
s_addc_u32 s37, s41, 0
s_lshl_b32 s34, s11, 12
s_add_u32 m0, s34, 66560
s_nop 0
global_load_lds_dwordx4 v200, s[36:37]
s_add_u32 s36, s40, 2162688
s_addc_u32 s37, s41, 0
s_lshl_b32 s34, s11, 12
s_add_u32 m0, s34, 67584
s_nop 0
global_load_lds_dwordx4 v201, s[36:37]
s_add_u32 s36, s40, 2195456
s_addc_u32 s37, s41, 0
s_lshl_b32 s34, s11, 12
s_add_u32 m0, s34, 68608
s_nop 0
global_load_lds_dwordx4 v201, s[36:37]
s_add_u32 s36, s40, 2621440
s_addc_u32 s37, s41, 0
s_lshl_b32 s34, s11, 12
s_add_u32 m0, s34, 81920
s_nop 0
global_load_lds_dwordx4 v200, s[36:37]
s_add_u32 s36, s40, 2654208
s_addc_u32 s37, s41, 0
s_lshl_b32 s34, s11, 12
s_add_u32 m0, s34, 82944
s_nop 0
global_load_lds_dwordx4 v200, s[36:37]
s_add_u32 s36, s40, 2686976
s_addc_u32 s37, s41, 0
s_lshl_b32 s34, s11, 12
s_add_u32 m0, s34, 83968
s_nop 0
global_load_lds_dwordx4 v201, s[36:37]
s_add_u32 s36, s40, 2719744
s_addc_u32 s37, s41, 0
s_lshl_b32 s34, s11, 12
s_add_u32 m0, s34, 84992
s_nop 0
global_load_lds_dwordx4 v201, s[36:37]
s_add_u32 s36, s40, 3145728
s_addc_u32 s37, s41, 0
s_lshl_b32 s34, s11, 12
s_add_u32 m0, s34, 98304
s_nop 0
global_load_lds_dwordx4 v200, s[36:37]
s_add_u32 s36, s40, 3178496
s_addc_u32 s37, s41, 0
s_lshl_b32 s34, s11, 12
s_add_u32 m0, s34, 99328
s_nop 0
global_load_lds_dwordx4 v200, s[36:37]
s_add_u32 s36, s40, 3211264
s_addc_u32 s37, s41, 0
s_lshl_b32 s34, s11, 12
s_add_u32 m0, s34, 100352
s_nop 0
global_load_lds_dwordx4 v201, s[36:37]
s_add_u32 s36, s40, 3244032
s_addc_u32 s37, s41, 0
s_lshl_b32 s34, s11, 12
s_add_u32 m0, s34, 101376
s_nop 0
global_load_lds_dwordx4 v201, s[36:37]
s_add_u32 s36, s40, 3670016
s_addc_u32 s37, s41, 0
s_lshl_b32 s34, s11, 12
s_add_u32 m0, s34, 114688
s_nop 0
global_load_lds_dwordx4 v200, s[36:37]
s_add_u32 s36, s40, 3702784
s_addc_u32 s37, s41, 0
s_lshl_b32 s34, s11, 12
s_add_u32 m0, s34, 115712
s_nop 0
global_load_lds_dwordx4 v200, s[36:37]
s_add_u32 s36, s40, 3735552
s_addc_u32 s37, s41, 0
s_lshl_b32 s34, s11, 12
s_add_u32 m0, s34, 116736
s_nop 0
global_load_lds_dwordx4 v201, s[36:37]
s_add_u32 s36, s40, 3768320
s_addc_u32 s37, s41, 0
s_lshl_b32 s34, s11, 12
s_add_u32 m0, s34, 117760
s_nop 0
global_load_lds_dwordx4 v201, s[36:37]
s_waitcnt vmcnt(28)
s_barrier
ds_read_b64_tr_b16 a[0:1], v210 offset:0
ds_read_b64_tr_b16 a[2:3], v210 offset:1024
ds_read_b64_tr_b16 a[4:5], v210 offset:8192
ds_read_b64_tr_b16 a[6:7], v210 offset:9216
ds_read_b64_tr_b16 a[64:65], v211 offset:0
ds_read_b64_tr_b16 a[66:67], v211 offset:1024
ds_read_b64_tr_b16 a[68:69], v211 offset:8192
ds_read_b64_tr_b16 a[70:71], v211 offset:9216
s_waitcnt lgkmcnt(0)
s_barrier
s_waitcnt vmcnt(24)
s_barrier
ds_read_b64_tr_b16 a[8:9], v210 offset:16384
ds_read_b64_tr_b16 a[10:11], v210 offset:17408
ds_read_b64_tr_b16 a[12:13], v210 offset:24576
ds_read_b64_tr_b16 a[14:15], v210 offset:25600
ds_read_b64_tr_b16 a[72:73], v211 offset:16384
ds_read_b64_tr_b16 a[74:75], v211 offset:17408
ds_read_b64_tr_b16 a[76:77], v211 offset:24576
ds_read_b64_tr_b16 a[78:79], v211 offset:25600
s_waitcnt lgkmcnt(0)
s_barrier
s_waitcnt vmcnt(20)
s_barrier
ds_read_b64_tr_b16 a[16:17], v210 offset:32768
ds_read_b64_tr_b16 a[18:19], v210 offset:33792
ds_read_b64_tr_b16 a[20:21], v210 offset:40960
ds_read_b64_tr_b16 a[22:23], v210 offset:41984
ds_read_b64_tr_b16 a[80:81], v211 offset:32768
ds_read_b64_tr_b16 a[82:83], v211 offset:33792
ds_read_b64_tr_b16 a[84:85], v211 offset:40960
ds_read_b64_tr_b16 a[86:87], v211 offset:41984
s_waitcnt lgkmcnt(0)
s_barrier
s_waitcnt vmcnt(16)
s_barrier
ds_read_b64_tr_b16 a[24:25], v210 offset:49152
ds_read_b64_tr_b16 a[26:27], v210 offset:50176
ds_read_b64_tr_b16 a[28:29], v210 offset:57344
ds_read_b64_tr_b16 a[30:31], v210 offset:58368
ds_read_b64_tr_b16 a[88:89], v211 offset:49152
ds_read_b64_tr_b16 a[90:91], v211 offset:50176
ds_read_b64_tr_b16 a[92:93], v211 offset:57344
ds_read_b64_tr_b16 a[94:95], v211 offset:58368
s_waitcnt lgkmcnt(0)
s_barrier
s_waitcnt vmcnt(12)
s_barrier
ds_read_b64_tr_b16 a[32:33], v212 offset:0
ds_read_b64_tr_b16 a[34:35], v212 offset:1024
ds_read_b64_tr_b16 a[36:37], v212 offset:8192
ds_read_b64_tr_b16 a[38:39], v212 offset:9216
ds_read_b64_tr_b16 a[96:97], v213 offset:0
ds_read_b64_tr_b16 a[98:99], v213 offset:1024
ds_read_b64_tr_b16 a[100:101], v213 offset:8192
ds_read_b64_tr_b16 a[102:103], v213 offset:9216
s_waitcnt lgkmcnt(0)
s_barrier
s_waitcnt vmcnt(8)
s_barrier
ds_read_b64_tr_b16 a[40:41], v212 offset:16384
ds_read_b64_tr_b16 a[42:43], v212 offset:17408
ds_read_b64_tr_b16 a[44:45], v212 offset:24576
ds_read_b64_tr_b16 a[46:47], v212 offset:25600
ds_read_b64_tr_b16 a[104:105], v213 offset:16384
ds_read_b64_tr_b16 a[106:107], v213 offset:17408
ds_read_b64_tr_b16 a[108:109], v213 offset:24576
ds_read_b64_tr_b16 a[110:111], v213 offset:25600
s_waitcnt lgkmcnt(0)
s_barrier
s_waitcnt vmcnt(4)
s_barrier
ds_read_b64_tr_b16 a[48:49], v212 offset:32768
ds_read_b64_tr_b16 a[50:51], v212 offset:33792
ds_read_b64_tr_b16 a[52:53], v212 offset:40960
ds_read_b64_tr_b16 a[54:55], v212 offset:41984
ds_read_b64_tr_b16 a[112:113], v213 offset:32768
ds_read_b64_tr_b16 a[114:115], v213 offset:33792
ds_read_b64_tr_b16 a[116:117], v213 offset:40960
ds_read_b64_tr_b16 a[118:119], v213 offset:41984
s_waitcnt lgkmcnt(0)
s_barrier
s_waitcnt vmcnt(0)
s_barrier
ds_read_b64_tr_b16 a[56:57], v212 offset:49152
ds_read_b64_tr_b16 a[58:59], v212 offset:50176
ds_read_b64_tr_b16 a[60:61], v212 offset:57344
ds_read_b64_tr_b16 a[62:63], v212 offset:58368
ds_read_b64_tr_b16 a[120:121], v213 offset:49152
ds_read_b64_tr_b16 a[122:123], v213 offset:50176
ds_read_b64_tr_b16 a[124:125], v213 offset:57344
ds_read_b64_tr_b16 a[126:127], v213 offset:58368
s_waitcnt lgkmcnt(0)
s_barrier
s_mov_b32 s46, s15
s_mov_b32 s48, 0
s_lshl_b32 s34, s46, 7
s_add_u32 s34, s34, 0
s_add_u32 s50, s4, s34
s_addc_u32 s51, s5, 0
s_cmp_lg_u32 s11, 0
s_cbranch_scc1 W1_26
v_mov_b32 v250, 0
s_mov_b32 s96, 0
W_27:
global_load_dword v251, v250, s[50:51] offset:0 sc1
s_waitcnt vmcnt(0)
v_readfirstlane_b32 s97, v251
s_nop 0
s_cmp_ge_u32 s97, 1
s_cbranch_scc1 WE_28
s_sleep 2
s_add_u32 s96, s96, 1
s_cmp_lt_u32 s96, 200000
s_cbranch_scc1 W_27
WE_28:
W1_26:
s_barrier
s_lshl_b32 s34, s46, 15
s_add_u32 s34, s34, 4194304
s_add_u32 s50, s4, s34
s_addc_u32 s51, s5, 0
s_lshl_b32 s34, s11, 13
s_add_u32 s34, s34, s48
s_add_u32 m0, s34, 0
s_nop 0
global_load_lds_dwordx4 v3, s[50:51] offset:0 sc1
global_load_lds_dwordx4 v3, s[50:51] offset:1024 sc1
global_load_lds_dwordx4 v3, s[50:51] offset:2048 sc1
global_load_lds_dwordx4 v3, s[50:51] offset:3072 sc1
s_lshl_b32 s34, s11, 13
s_add_u32 s34, s34, s48
s_add_u32 m0, s34, 4096
s_add_u32 s50, s50, 4096
s_addc_u32 s51, s51, 0
global_load_lds_dwordx4 v3, s[50:51] offset:0 sc1
global_load_lds_dwordx4 v3, s[50:51] offset:1024 sc1
global_load_lds_dwordx4 v3, s[50:51] offset:2048 sc1
global_load_lds_dwordx4 v3, s[50:51] offset:3072 sc1
Gq_loop:
s_add_u32 s47, s46, 7
s_waitcnt vmcnt(0)
s_barrier
s_xor_b32 s49, s48, 32768
s_cmp_ge_u32 s47, 64
s_cbranch_scc1 Gn_29
s_lshl_b32 s34, s47, 7
s_add_u32 s34, s34, 0
s_add_u32 s50, s4, s34
s_addc_u32 s51, s5, 0
s_cmp_lg_u32 s11, 0
s_cbranch_scc1 W1_30
v_mov_b32 v250, 0
s_mov_b32 s96, 0
W_31:
global_load_dword v251, v250, s[50:51] offset:0 sc1
s_waitcnt vmcnt(0)
v_readfirstlane_b32 s97, v251
s_nop 0
s_cmp_ge_u32 s97, 1
s_cbranch_scc1 WE_32
s_sleep 2
s_add_u32 s96, s96, 1
s_cmp_lt_u32 s96, 200000
s_cbranch_scc1 W_31
WE_32:
W1_30:
s_barrier
s_lshl_b32 s34, s47, 15
s_add_u32 s34, s34, 4194304
s_add_u32 s50, s4, s34
s_addc_u32 s51, s5, 0
s_lshl_b32 s34, s11, 13
s_add_u32 s34, s34, s49
s_add_u32 m0, s34, 0
s_nop 0
global_load_lds_dwordx4 v3, s[50:51] offset:0 sc1
global_load_lds_dwordx4 v3, s[50:51] offset:1024 sc1
global_load_lds_dwordx4 v3, s[50:51] offset:2048 sc1
global_load_lds_dwordx4 v3, s[50:51] offset:3072 sc1
s_lshl_b32 s34, s11, 13
s_add_u32 s34, s34, s49
s_add_u32 m0, s34, 4096
s_add_u32 s50, s50, 4096
s_addc_u32 s51, s51, 0
global_load_lds_dwordx4 v3, s[50:51] offset:0 sc1
global_load_lds_dwordx4 v3, s[50:51] offset:1024 sc1
global_load_lds_dwordx4 v3, s[50:51] offset:2048 sc1
global_load_lds_dwordx4 v3, s[50:51] offset:3072 sc1
Gn_29:
v_add_u32 v4, s48, v2
v_mov_b64 v[16:17], 0
v_mov_b64 v[18:19], 0
v_mov_b64 v[20:21], 0
v_mov_b64 v[22:23], 0
v_mov_b64 v[24:25], 0
v_mov_b64 v[26:27], 0
v_mov_b64 v[28:29], 0
v_mov_b64 v[30:31], 0
ds_read_b128 v[64:67], v4 offset:0
ds_read_b128 v[68:71], v4 offset:1024
ds_read_b128 v[72:75], v4 offset:2048
ds_read_b128 v[76:79], v4 offset:3072
ds_read_b128 v[80:83], v4 offset:4096
s_waitcnt lgkmcnt(4)
v_mfma_f32_16x16x32_bf16 v[16:19], a[0:3], v[64:67], v[16:19]
v_mfma_f32_16x16x32_bf16 v[20:23], a[64:67], v[64:67], v[20:23]
ds_read_b128 v[84:87], v4 offset:5120
s_waitcnt lgkmcnt(4)
v_mfma_f32_16x16x32_bf16 v[16:19], a[4:7], v[68:71], v[16:19]
v_mfma_f32_16x16x32_bf16 v[20:23], a[68:71], v[68:71], v[20:23]
ds_read_b128 v[88:91], v4 offset:6144
s_waitcnt lgkmcnt(4)
v_mfma_f32_16x16x32_bf16 v[16:19], a[8:11], v[72:75], v[16:19]
v_mfma_f32_16x16x32_bf16 v[20:23], a[72:75], v[72:75], v[20:23]
ds_read_b128 v[92:95], v4 offset:7168
s_waitcnt lgkmcnt(4)
v_mfma_f32_16x16x32_bf16 v[16:19], a[12:15], v[76:79], v[16:19]
v_mfma_f32_16x16x32_bf16 v[20:23], a[76:79], v[76:79], v[20:23]
ds_read_b128 v[64:67], v4 offset:8192
s_waitcnt lgkmcnt(4)
v_mfma_f32_16x16x32_bf16 v[16:19], a[16:19], v[80:83], v[16:19]
v_mfma_f32_16x16x32_bf16 v[20:23], a[80:83], v[80:83], v[20:23]
ds_read_b128 v[68:71], v4 offset:9216
s_waitcnt lgkmcnt(4)
v_mfma_f32_16x16x32_bf16 v[16:19], a[20:23], v[84:87], v[16:19]
v_mfma_f32_16x16x32_bf16 v[20:23], a[84:87], v[84:87], v[20:23]
ds_read_b128 v[72:75], v4 offset:10240
s_waitcnt lgkmcnt(4)
v_mfma_f32_16x16x32_bf16 v[16:19], a[24:27], v[88:91], v[16:19]
v_mfma_f32_16x16x32_bf16 v[20:23], a[88:91], v[88:91], v[20:23]
ds_read_b128 v[76:79], v4 offset:11264
s_waitcnt lgkmcnt(4)
v_mfma_f32_16x16x32_bf16 v[16:19], a[28:31], v[92:95], v[16:19]
v_mfma_f32_16x16x32_bf16 v[20:23], a[92:95], v[92:95], v[20:23]
ds_read_b128 v[80:83], v4 offset:12288
s_waitcnt lgkmcnt(4)
v_mfma_f32_16x16x32_bf16 v[16:19], a[32:35], v[64:67], v[16:19]
v_mfma_f32_16x16x32_bf16 v[20:23], a[96:99], v[64:67], v[20:23]
ds_read_b128 v[84:87], v4 offset:13312
s_waitcnt lgkmcnt(4)
v_mfma_f32_16x16x32_bf16 v[16:19], a[36:39], v[68:71], v[16:19]
v_mfma_f32_16x16x32_bf16 v[20:23], a[100:103], v[68:71], v[20:23]
ds_read_b128 v[88:91], v4 offset:14336
s_waitcnt lgkmcnt(4)
v_mfma_f32_16x16x32_bf16 v[16:19], a[40:43], v[72:75], v[16:19]
v_mfma_f32_16x16x32_bf16 v[20:23], a[104:107], v[72:75], v[20:23]
ds_read_b128 v[92:95], v4 offset:15360
s_waitcnt lgkmcnt(4)
v_mfma_f32_16x16x32_bf16 v[16:19], a[44:47], v[76:79], v[16:19]
v_mfma_f32_16x16x32_bf16 v[20:23], a[108:111], v[76:79], v[20:23]
ds_read_b128 v[64:67], v4 offset:16384
s_waitcnt lgkmcnt(4)
v_mfma_f32_16x16x32_bf16 v[16:19], a[48:51], v[80:83], v[16:19]
v_mfma_f32_16x16x32_bf16 v[20:23], a[112:115], v[80:83], v[20:23]
ds_read_b128 v[68:71], v4 offset:17408
s_waitcnt lgkmcnt(4)
v_mfma_f32_16x16x32_bf16 v[16:19], a[52:55], v[84:87], v[16:19]
v_mfma_f32_16x16x32_bf16 v[20:23], a[116:119], v[84:87], v[20:23]
ds_read_b128 v[72:75], v4 offset:18432
s_waitcnt lgkmcnt(4)
v_mfma_f32_16x16x32_bf16 v[16:19], a[56:59], v[88:91], v[16:19]
v_mfma_f32_16x16x32_bf16 v[20:23], a[120:123], v[88:91], v[20:23]
ds_read_b128 v[76:79], v4 offset:19456
s_waitcnt lgkmcnt(4)
v_mfma_f32_16x16x32_bf16 v[16:19], a[60:63], v[92:95], v[16:19]
v_mfma_f32_16x16x32_bf16 v[20:23], a[124:127], v[92:95], v[20:23]
ds_read_b128 v[80:83], v4 offset:20480
s_waitcnt lgkmcnt(4)
v_mfma_f32_16x16x32_bf16 v[24:27], a[0:3], v[64:67], v[24:27]
v_mfma_f32_16x16x32_bf16 v[28:31], a[64:67], v[64:67], v[28:31]
ds_read_b128 v[84:87], v4 offset:21504
s_waitcnt lgkmcnt(4)
v_mfma_f32_16x16x32_bf16 v[24:27], a[4:7], v[68:71], v[24:27]
v_mfma_f32_16x16x32_bf16 v[28:31], a[68:71], v[68:71], v[28:31]
ds_read_b128 v[88:91], v4 offset:22528
s_waitcnt lgkmcnt(4)
v_mfma_f32_16x16x32_bf16 v[24:27], a[8:11], v[72:75], v[24:27]
v_mfma_f32_16x16x32_bf16 v[28:31], a[72:75], v[72:75], v[28:31]
ds_read_b128 v[92:95], v4 offset:23552
s_waitcnt lgkmcnt(4)
v_mfma_f32_16x16x32_bf16 v[24:27], a[12:15], v[76:79], v[24:27]
v_mfma_f32_16x16x32_bf16 v[28:31], a[76:79], v[76:79], v[28:31]
ds_read_b128 v[64:67], v4 offset:24576
s_waitcnt lgkmcnt(4)
v_mfma_f32_16x16x32_bf16 v[24:27], a[16:19], v[80:83], v[24:27]
v_mfma_f32_16x16x32_bf16 v[28:31], a[80:83], v[80:83], v[28:31]
ds_read_b128 v[68:71], v4 offset:25600
s_waitcnt lgkmcnt(4)
v_mfma_f32_16x16x32_bf16 v[24:27], a[20:23], v[84:87], v[24:27]
v_mfma_f32_16x16x32_bf16 v[28:31], a[84:87], v[84:87], v[28:31]
ds_read_b128 v[72:75], v4 offset:26624
s_waitcnt lgkmcnt(4)
v_mfma_f32_16x16x32_bf16 v[24:27], a[24:27], v[88:91], v[24:27]
v_mfma_f32_16x16x32_bf16 v[28:31], a[88:91], v[88:91], v[28:31]
ds_read_b128 v[76:79], v4 offset:27648
s_waitcnt lgkmcnt(4)
v_mfma_f32_16x16x32_bf16 v[24:27], a[28:31], v[92:95], v[24:27]
v_mfma_f32_16x16x32_bf16 v[28:31], a[92:95], v[92:95], v[28:31]
ds_read_b128 v[80:83], v4 offset:28672
s_waitcnt lgkmcnt(4)
v_mfma_f32_16x16x32_bf16 v[24:27], a[32:35], v[64:67], v[24:27]
v_mfma_f32_16x16x32_bf16 v[28:31], a[96:99], v[64:67], v[28:31]
ds_read_b128 v[84:87], v4 offset:29696
s_waitcnt lgkmcnt(4)
v_mfma_f32_16x16x32_bf16 v[24:27], a[36:39], v[68:71], v[24:27]
v_mfma_f32_16x16x32_bf16 v[28:31], a[100:103], v[68:71], v[28:31]
ds_read_b128 v[88:91], v4 offset:30720
s_waitcnt lgkmcnt(4)
v_mfma_f32_16x16x32_bf16 v[24:27], a[40:43], v[72:75], v[24:27]
v_mfma_f32_16x16x32_bf16 v[28:31], a[104:107], v[72:75], v[28:31]
ds_read_b128 v[92:95], v4 offset:31744
s_waitcnt lgkmcnt(4)
v_mfma_f32_16x16x32_bf16 v[24:27], a[44:47], v[76:79], v[24:27]
v_mfma_f32_16x16x32_bf16 v[28:31], a[108:111], v[76:79], v[28:31]
s_waitcnt lgkmcnt(3)
v_mfma_f32_16x16x32_bf16 v[24:27], a[48:51], v[80:83], v[24:27]
v_mfma_f32_16x16x32_bf16 v[28:31], a[112:115], v[80:83], v[28:31]
s_waitcnt lgkmcnt(2)
v_mfma_f32_16x16x32_bf16 v[24:27], a[52:55], v[84:87], v[24:27]
v_mfma_f32_16x16x32_bf16 v[28:31], a[116:119], v[84:87], v[28:31]
s_waitcnt lgkmcnt(1)
v_mfma_f32_16x16x32_bf16 v[24:27], a[56:59], v[88:91], v[24:27]
v_mfma_f32_16x16x32_bf16 v[28:31], a[120:123], v[88:91], v[28:31]
s_waitcnt lgkmcnt(0)
v_mfma_f32_16x16x32_bf16 v[24:27], a[60:63], v[92:95], v[24:27]
v_mfma_f32_16x16x32_bf16 v[28:31], a[124:127], v[92:95], v[28:31]
s_lshl_b32 s34, s46, 18
s_lshl_b32 s35, s14, 13
s_add_u32 s34, s34, s35
s_add_u32 s35, s34, 67108864
s_add_u32 s52, s4, s35
s_addc_u32 s53, s5, 0
s_lshl_b32 s35, s11, 10
v_add_u32 v5, s35, v2
v_cvt_pk_bf16_f32 v100, v16, v17
v_cvt_pk_bf16_f32 v101, v18, v19
v_cvt_pk_bf16_f32 v102, v20, v21
v_cvt_pk_bf16_f32 v103, v22, v23
v_cvt_pk_bf16_f32 v104, v24, v25
v_cvt_pk_bf16_f32 v105, v26, v27
v_cvt_pk_bf16_f32 v106, v28, v29
v_cvt_pk_bf16_f32 v107, v30, v31
global_store_dwordx4 v5, v[100:103], s[52:53] sc1
v_add_u32 v6, 4096, v5
global_store_dwordx4 v6, v[104:107], s[52:53] sc1
s_lshl_b32 s34, s46, 7
s_add_u32 s34, s34, 16384
s_add_u32 s52, s4, s34
s_addc_u32 s53, s5, 0
s_waitcnt vmcnt(0)
s_barrier
s_cmp_lg_u32 s11, 0
s_cbranch_scc1 SG_33
v_mov_b32 v250, 0
v_mov_b32 v251, 1
s_mov_b64 exec, 1
global_atomic_add v250, v251, s[52:53] offset:0
s_mov_b64 exec, -1
SG_33:
s_mov_b32 s46, s47
s_mov_b32 s48, s49
s_cmp_lt_u32 s46, 64
s_cbranch_scc1 Gq_loop
s_barrier
s_cmp_lg_u32 s11, 0
s_cbranch_scc1 W1_34
v_mov_b32 v250, 0
s_mov_b32 s96, 0
W_35:
global_load_dword v251, v250, s[6:7] offset:160 sc1
s_waitcnt vmcnt(0)
v_readfirstlane_b32 s97, v251
s_nop 0
s_cmp_ge_u32 s97, 8
s_cbranch_scc1 WE_36
s_sleep 4
s_add_u32 s96, s96, 1
s_cmp_lt_u32 s96, 200000
s_cbranch_scc1 W_35
WE_36:
W1_34:
s_barrier
s_cmp_ge_u32 s12, 64
s_cbranch_scc1 L_notA
s_and_b32 s14, s12, 7
s_bfe_u32 s15, s12, 0x10003
s_lshr_b32 s16, s12, 4
s_lshl_b32 s18, s14, 2
s_add_u32 s18, s18, s11
s_load_dwordx2 s[40:41], s[0:1], 40
v_lshrrev_b32 v204, 4, v0
v_and_b32 v200, 15, v0
v_lshlrev_b32 v201, 1, v204
v_xor_b32 v200, v200, v201
v_lshlrev_b32 v200, 4, v200
v_xor_b32 v201, 128, v200
s_mov_b32 s34, 1024
v_mul_lo_u32 v204, v204, s34
s_mul_i32 s34, s11, 16384
v_add_u32 v204, s34, v204
v_add_u32 v200, v200, v204
v_add_u32 v201, v201, v204
v_lshrrev_b32 v204, 4, v0
v_bfe_u32 v205, v0, 2, 2
v_lshlrev_b32 v202, 2, v204
v_add_u32 v202, v202, v205
v_lshlrev_b32 v205, 1, v205
v_lshrrev_b32 v204, 1, v204
v_lshlrev_b32 v204, 3, v204
v_add_u32 v205, v205, v204
v_lshlrev_b32 v202, 8, v202
v_and_b32 v204, 3, v0
v_xor_b32 v205, v205, v204
v_lshlrev_b32 v205, 4, v205
v_add_u32 v202, v202, v205
s_and_b32 s34, s11, 1
s_lshl_b32 s34, s34, 7
v_xor_b32 v210, s34, v202
v_xor_b32 v211, 64, v210
s_lshr_b32 s34, s11, 1
s_lshl_b32 s34, s34, 14
v_add_u32 v210, s34, v210
v_add_u32 v211, s34, v211
v_add_u32 v212, 0x10000, v210
v_add_u32 v213, 0x10000, v211
s_waitcnt lgkmcnt(0)
s_lshl_b32 s34, s14, 19
s_lshl_b32 s35, s15, 9
s_add_u32 s34, s34, s35
s_add_u32 s40, s40, s34
s_addc_u32 s41, s41, 0
s_add_u32 s42, s40, 256
s_addc_u32 s43, s41, 0
s_add_u32 s36, s40, 0
s_addc_u32 s37, s41, 0
s_lshl_b32 s34, s11, 12
s_add_u32 m0, s34, 0
s_nop 0
global_load_lds_dwordx4 v200, s[36:37]
s_add_u32 s36, s40, 4096
s_addc_u32 s37, s41, 0
s_lshl_b32 s34, s11, 12
s_add_u32 m0, s34, 1024
s_nop 0
global_load_lds_dwordx4 v200, s[36:37]
s_add_u32 s36, s40, 8192
s_addc_u32 s37, s41, 0
s_lshl_b32 s34, s11, 12
s_add_u32 m0, s34, 2048
s_nop 0
global_load_lds_dwordx4 v201, s[36:37]
s_add_u32 s36, s40, 12288
s_addc_u32 s37, s41, 0
s_lshl_b32 s34, s11, 12
s_add_u32 m0, s34, 3072
s_nop 0
global_load_lds_dwordx4 v201, s[36:37]
s_add_u32 s36, s42, 0
s_addc_u32 s37, s43, 0
s_lshl_b32 s34, s11, 12
s_add_u32 m0, s34, 16384
s_nop 0
global_load_lds_dwordx4 v200, s[36:37]
s_add_u32 s36, s42, 4096
s_addc_u32 s37, s43, 0
s_lshl_b32 s34, s11, 12
s_add_u32 m0, s34, 17408
s_nop 0
global_load_lds_dwordx4 v200, s[36:37]
s_add_u32 s36, s42, 8192
s_addc_u32 s37, s43, 0
s_lshl_b32 s34, s11, 12
s_add_u32 m0, s34, 18432
s_nop 0
global_load_lds_dwordx4 v201, s[36:37]
s_add_u32 s36, s42, 12288
s_addc_u32 s37, s43, 0
s_lshl_b32 s34, s11, 12
s_add_u32 m0, s34, 19456
s_nop 0
global_load_lds_dwordx4 v201, s[36:37]
s_add_u32 s36, s40, 65536
s_addc_u32 s37, s41, 0
s_lshl_b32 s34, s11, 12
s_add_u32 m0, s34, 32768
s_nop 0
global_load_lds_dwordx4 v200, s[36:37]
s_add_u32 s36, s40, 69632
s_addc_u32 s37, s41, 0
s_lshl_b32 s34, s11, 12
s_add_u32 m0, s34, 33792
s_nop 0
global_load_lds_dwordx4 v200, s[36:37]
s_add_u32 s36, s40, 73728
s_addc_u32 s37, s41, 0
s_lshl_b32 s34, s11, 12
s_add_u32 m0, s34, 34816
s_nop 0
global_load_lds_dwordx4 v201, s[36:37]
s_add_u32 s36, s40, 77824
s_addc_u32 s37, s41, 0
s_lshl_b32 s34, s11, 12
s_add_u32 m0, s34, 35840
s_nop 0
global_load_lds_dwordx4 v201, s[36:37]
s_add_u32 s36, s42, 65536
s_addc_u32 s37, s43, 0
s_lshl_b32 s34, s11, 12
s_add_u32 m0, s34, 49152
s_nop 0
global_load_lds_dwordx4 v200, s[36:37]
s_add_u32 s36, s42, 69632
s_addc_u32 s37, s43, 0
s_lshl_b32 s34, s11, 12
s_add_u32 m0, s34, 50176
s_nop 0
global_load_lds_dwordx4 v200, s[36:37]
s_add_u32 s36, s42, 73728
s_addc_u32 s37, s43, 0
s_lshl_b32 s34, s11, 12
s_add_u32 m0, s34, 51200
s_nop 0
global_load_lds_dwordx4 v201, s[36:37]
s_add_u32 s36, s42, 77824
s_addc_u32 s37, s43, 0
s_lshl_b32 s34, s11, 12
s_add_u32 m0, s34, 52224
s_nop 0
global_load_lds_dwordx4 v201, s[36:37]
s_add_u32 s36, s40, 131072
s_addc_u32 s37, s41, 0
s_lshl_b32 s34, s11, 12
s_add_u32 m0, s34, 65536
s_nop 0
global_load_lds_dwordx4 v200, s[36:37]
s_add_u32 s36, s40, 135168
s_addc_u32 s37, s41, 0
s_lshl_b32 s34, s11, 12
s_add_u32 m0, s34, 66560
s_nop 0
global_load_lds_dwordx4 v200, s[36:37]
s_add_u32 s36, s40, 139264
s_addc_u32 s37, s41, 0
s_lshl_b32 s34, s11, 12
s_add_u32 m0, s34, 67584
s_nop 0
global_load_lds_dwordx4 v201, s[36:37]
s_add_u32 s36, s40, 143360
s_addc_u32 s37, s41, 0
s_lshl_b32 s34, s11, 12
s_add_u32 m0, s34, 68608
s_nop 0
global_load_lds_dwordx4 v201, s[36:37]
s_add_u32 s36, s42, 131072
s_addc_u32 s37, s43, 0
s_lshl_b32 s34, s11, 12
s_add_u32 m0, s34, 81920
s_nop 0
global_load_lds_dwordx4 v200, s[36:37]
s_add_u32 s36, s42, 135168
s_addc_u32 s37, s43, 0
s_lshl_b32 s34, s11, 12
s_add_u32 m0, s34, 82944
s_nop 0
global_load_lds_dwordx4 v200, s[36:37]
s_add_u32 s36, s42, 139264
s_addc_u32 s37, s43, 0
s_lshl_b32 s34, s11, 12
s_add_u32 m0, s34, 83968
s_nop 0
global_load_lds_dwordx4 v201, s[36:37]
s_add_u32 s36, s42, 143360
s_addc_u32 s37, s43, 0
s_lshl_b32 s34, s11, 12
s_add_u32 m0, s34, 84992
s_nop 0
global_load_lds_dwordx4 v201, s[36:37]
s_add_u32 s36, s40, 196608
s_addc_u32 s37, s41, 0
s_lshl_b32 s34, s11, 12
s_add_u32 m0, s34, 98304
s_nop 0
global_load_lds_dwordx4 v200, s[36:37]
s_add_u32 s36, s40, 200704
s_addc_u32 s37, s41, 0
s_lshl_b32 s34, s11, 12
s_add_u32 m0, s34, 99328
s_nop 0
global_load_lds_dwordx4 v200, s[36:37]
s_add_u32 s36, s40, 204800
s_addc_u32 s37, s41, 0
s_lshl_b32 s34, s11, 12
s_add_u32 m0, s34, 100352
s_nop 0
global_load_lds_dwordx4 v201, s[36:37]
s_add_u32 s36, s40, 208896
s_addc_u32 s37, s41, 0
s_lshl_b32 s34, s11, 12
s_add_u32 m0, s34, 101376
s_nop 0
global_load_lds_dwordx4 v201, s[36:37]
s_add_u32 s36, s42, 196608
s_addc_u32 s37, s43, 0
s_lshl_b32 s34, s11, 12
s_add_u32 m0, s34, 114688
s_nop 0
global_load_lds_dwordx4 v200, s[36:37]
s_add_u32 s36, s42, 200704
s_addc_u32 s37, s43, 0
s_lshl_b32 s34, s11, 12
s_add_u32 m0, s34, 115712
s_nop 0
global_load_lds_dwordx4 v200, s[36:37]
s_add_u32 s36, s42, 204800
s_addc_u32 s37, s43, 0
s_lshl_b32 s34, s11, 12
s_add_u32 m0, s34, 116736
s_nop 0
global_load_lds_dwordx4 v201, s[36:37]
s_add_u32 s36, s42, 208896
s_addc_u32 s37, s43, 0
s_lshl_b32 s34, s11, 12
s_add_u32 m0, s34, 117760
s_nop 0
global_load_lds_dwordx4 v201, s[36:37]
s_waitcnt vmcnt(24)
s_barrier
ds_read_b64_tr_b16 a[0:1], v210 offset:0
ds_read_b64_tr_b16 a[2:3], v210 offset:4096
ds_read_b64_tr_b16 a[4:5], v210 offset:8
ds_read_b64_tr_b16 a[6:7], v210 offset:4104
ds_read_b64_tr_b16 a[8:9], v211 offset:0
ds_read_b64_tr_b16 a[10:11], v211 offset:4096
ds_read_b64_tr_b16 a[12:13], v211 offset:8
ds_read_b64_tr_b16 a[14:15], v211 offset:4104
ds_read_b64_tr_b16 a[16:17], v210 offset:8192
ds_read_b64_tr_b16 a[18:19], v210 offset:12288
ds_read_b64_tr_b16 a[20:21], v210 offset:8200
ds_read_b64_tr_b16 a[22:23], v210 offset:12296
ds_read_b64_tr_b16 a[24:25], v211 offset:8192
ds_read_b64_tr_b16 a[26:27], v211 offset:12288
ds_read_b64_tr_b16 a[28:29], v211 offset:8200
ds_read_b64_tr_b16 a[30:31], v211 offset:12296
s_waitcnt lgkmcnt(0)
s_barrier
s_add_u32 s36, s40, 262144
s_addc_u32 s37, s41, 0
s_lshl_b32 s34, s11, 12
s_add_u32 m0, s34, 0
s_nop 0
global_load_lds_dwordx4 v200, s[36:37]
s_add_u32 s36, s40, 266240
s_addc_u32 s37, s41, 0
s_lshl_b32 s34, s11, 12
s_add_u32 m0, s34, 1024
s_nop 0
global_load_lds_dwordx4 v200, s[36:37]
s_add_u32 s36, s40, 270336
s_addc_u32 s37, s41, 0
s_lshl_b32 s34, s11, 12
s_add_u32 m0, s34, 2048
s_nop 0
global_load_lds_dwordx4 v201, s[36:37]
s_add_u32 s36, s40, 274432
s_addc_u32 s37, s41, 0
s_lshl_b32 s34, s11, 12
s_add_u32 m0, s34, 3072
s_nop 0
global_load_lds_dwordx4 v201, s[36:37]
s_add_u32 s36, s42, 262144
s_addc_u32 s37, s43, 0
s_lshl_b32 s34, s11, 12
s_add_u32 m0, s34, 16384
s_nop 0
global_load_lds_dwordx4 v200, s[36:37]
s_add_u32 s36, s42, 266240
s_addc_u32 s37, s43, 0
s_lshl_b32 s34, s11, 12
s_add_u32 m0, s34, 17408
s_nop 0
global_load_lds_dwordx4 v200, s[36:37]
s_add_u32 s36, s42, 270336
s_addc_u32 s37, s43, 0
s_lshl_b32 s34, s11, 12
s_add_u32 m0, s34, 18432
s_nop 0
global_load_lds_dwordx4 v201, s[36:37]
s_add_u32 s36, s42, 274432
s_addc_u32 s37, s43, 0
s_lshl_b32 s34, s11, 12
s_add_u32 m0, s34, 19456
s_nop 0
global_load_lds_dwordx4 v201, s[36:37]
s_waitcnt vmcnt(24)
s_barrier
ds_read_b64_tr_b16 a[32:33], v210 offset:32768
ds_read_b64_tr_b16 a[34:35], v210 offset:36864
ds_read_b64_tr_b16 a[36:37], v210 offset:32776
ds_read_b64_tr_b16 a[38:39], v210 offset:36872
ds_read_b64_tr_b16 a[40:41], v211 offset:32768
ds_read_b64_tr_b16 a[42:43], v211 offset:36864
ds_read_b64_tr_b16 a[44:45], v211 offset:32776
ds_read_b64_tr_b16 a[46:47], v211 offset:36872
ds_read_b64_tr_b16 a[48:49], v210 offset:40960
ds_read_b64_tr_b16 a[50:51], v210 offset:45056
ds_read_b64_tr_b16 a[52:53], v210 offset:40968
ds_read_b64_tr_b16 a[54:55], v210 offset:45064
ds_read_b64_tr_b16 a[56:57], v211 offset:40960
ds_read_b64_tr_b16 a[58:59], v211 offset:45056
ds_read_b64_tr_b16 a[60:61], v211 offset:40968
ds_read_b64_tr_b16 a[62:63], v211 offset:45064
s_waitcnt lgkmcnt(0)
s_barrier
s_add_u32 s36, s40, 327680
s_addc_u32 s37, s41, 0
s_lshl_b32 s34, s11, 12
s_add_u32 m0, s34, 32768
s_nop 0
global_load_lds_dwordx4 v200, s[36:37]
s_add_u32 s36, s40, 331776
s_addc_u32 s37, s41, 0
s_lshl_b32 s34, s11, 12
s_add_u32 m0, s34, 33792
s_nop 0
global_load_lds_dwordx4 v200, s[36:37]
s_add_u32 s36, s40, 335872
s_addc_u32 s37, s41, 0
s_lshl_b32 s34, s11, 12
s_add_u32 m0, s34, 34816
s_nop 0
global_load_lds_dwordx4 v201, s[36:37]
s_add_u32 s36, s40, 339968
s_addc_u32 s37, s41, 0
s_lshl_b32 s34, s11, 12
s_add_u32 m0, s34, 35840
s_nop 0
global_load_lds_dwordx4 v201, s[36:37]
s_add_u32 s36, s42, 327680
s_addc_u32 s37, s43, 0
s_lshl_b32 s34, s11, 12
s_add_u32 m0, s34, 49152
s_nop 0
global_load_lds_dwordx4 v200, s[36:37]
s_add_u32 s36, s42, 331776
s_addc_u32 s37, s43, 0
s_lshl_b32 s34, s11, 12
s_add_u32 m0, s34, 50176
s_nop 0
global_load_lds_dwordx4 v200, s[36:37]
s_add_u32 s36, s42, 335872
s_addc_u32 s37, s43, 0
s_lshl_b32 s34, s11, 12
s_add_u32 m0, s34, 51200
s_nop 0
global_load_lds_dwordx4 v201, s[36:37]
s_add_u32 s36, s42, 339968
s_addc_u32 s37, s43, 0
s_lshl_b32 s34, s11, 12
s_add_u32 m0, s34, 52224
s_nop 0
global_load_lds_dwordx4 v201, s[36:37]
s_waitcnt vmcnt(24)
s_barrier
ds_read_b64_tr_b16 a[64:65], v212 offset:0
ds_read_b64_tr_b16 a[66:67], v212 offset:4096
ds_read_b64_tr_b16 a[68:69], v212 offset:8
ds_read_b64_tr_b16 a[70:71], v212 offset:4104
ds_read_b64_tr_b16 a[72:73], v213 offset:0
ds_read_b64_tr_b16 a[74:75], v213 offset:4096
ds_read_b64_tr_b16 a[76:77], v213 offset:8
ds_read_b64_tr_b16 a[78:79], v213 offset:4104
ds_read_b64_tr_b16 a[80:81], v212 offset:8192
ds_read_b64_tr_b16 a[82:83], v212 offset:12288
ds_read_b64_tr_b16 a[84:85], v212 offset:8200
ds_read_b64_tr_b16 a[86:87], v212 offset:12296
ds_read_b64_tr_b16 a[88:89], v213 offset:8192
ds_read_b64_tr_b16 a[90:91], v213 offset:12288
ds_read_b64_tr_b16 a[92:93], v213 offset:8200
ds_read_b64_tr_b16 a[94:95], v213 offset:12296
s_waitcnt lgkmcnt(0)
s_barrier
s_add_u32 s36, s40, 393216
s_addc_u32 s37, s41, 0
s_lshl_b32 s34, s11, 12
s_add_u32 m0, s34, 65536
s_nop 0
global_load_lds_dwordx4 v200, s[36:37]
s_add_u32 s36, s40, 397312
s_addc_u32 s37, s41, 0
s_lshl_b32 s34, s11, 12
s_add_u32 m0, s34, 66560
s_nop 0
global_load_lds_dwordx4 v200, s[36:37]
s_add_u32 s36, s40, 401408
s_addc_u32 s37, s41, 0
s_lshl_b32 s34, s11, 12
s_add_u32 m0, s34, 67584
s_nop 0
global_load_lds_dwordx4 v201, s[36:37]
s_add_u32 s36, s40, 405504
s_addc_u32 s37, s41, 0
s_lshl_b32 s34, s11, 12
s_add_u32 m0, s34, 68608
s_nop 0
global_load_lds_dwordx4 v201, s[36:37]
s_add_u32 s36, s42, 393216
s_addc_u32 s37, s43, 0
s_lshl_b32 s34, s11, 12
s_add_u32 m0, s34, 81920
s_nop 0
global_load_lds_dwordx4 v200, s[36:37]
s_add_u32 s36, s42, 397312
s_addc_u32 s37, s43, 0
s_lshl_b32 s34, s11, 12
s_add_u32 m0, s34, 82944
s_nop 0
global_load_lds_dwordx4 v200, s[36:37]
s_add_u32 s36, s42, 401408
s_addc_u32 s37, s43, 0
s_lshl_b32 s34, s11, 12
s_add_u32 m0, s34, 83968
s_nop 0
global_load_lds_dwordx4 v201, s[36:37]
s_add_u32 s36, s42, 405504
s_addc_u32 s37, s43, 0
s_lshl_b32 s34, s11, 12
s_add_u32 m0, s34, 84992
s_nop 0
global_load_lds_dwordx4 v201, s[36:37]
s_waitcnt vmcnt(24)
s_barrier
ds_read_b64_tr_b16 a[96:97], v212 offset:32768
ds_read_b64_tr_b16 a[98:99], v212 offset:36864
ds_read_b64_tr_b16 a[100:101], v212 offset:32776
ds_read_b64_tr_b16 a[102:103], v212 offset:36872
ds_read_b64_tr_b16 a[104:105], v213 offset:32768
ds_read_b64_tr_b16 a[106:107], v213 offset:36864
ds_read_b64_tr_b16 a[108:109], v213 offset:32776
ds_read_b64_tr_b16 a[110:111], v213 offset:36872
ds_read_b64_tr_b16 a[112:113], v212 offset:40960
ds_read_b64_tr_b16 a[114:115], v212 offset:45056
ds_read_b64_tr_b16 a[116:117], v212 offset:40968
ds_read_b64_tr_b16 a[118:119], v212 offset:45064
ds_read_b64_tr_b16 a[120:121], v213 offset:40960
ds_read_b64_tr_b16 a[122:123], v213 offset:45056
ds_read_b64_tr_b16 a[124:125], v213 offset:40968
ds_read_b64_tr_b16 a[126:127], v213 offset:45064
s_waitcnt lgkmcnt(0)
s_barrier
s_add_u32 s36, s40, 458752
s_addc_u32 s37, s41, 0
s_lshl_b32 s34, s11, 12
s_add_u32 m0, s34, 98304
s_nop 0
global_load_lds_dwordx4 v200, s[36:37]
s_add_u32 s36, s40, 462848
s_addc_u32 s37, s41, 0
s_lshl_b32 s34, s11, 12
s_add_u32 m0, s34, 99328
s_nop 0
global_load_lds_dwordx4 v200, s[36:37]
s_add_u32 s36, s40, 466944
s_addc_u32 s37, s41, 0
s_lshl_b32 s34, s11, 12
s_add_u32 m0, s34, 100352
s_nop 0
global_load_lds_dwordx4 v201, s[36:37]
s_add_u32 s36, s40, 471040
s_addc_u32 s37, s41, 0
s_lshl_b32 s34, s11, 12
s_add_u32 m0, s34, 101376
s_nop 0
global_load_lds_dwordx4 v201, s[36:37]
s_add_u32 s36, s42, 458752
s_addc_u32 s37, s43, 0
s_lshl_b32 s34, s11, 12
s_add_u32 m0, s34, 114688
s_nop 0
global_load_lds_dwordx4 v200, s[36:37]
s_add_u32 s36, s42, 462848
s_addc_u32 s37, s43, 0
s_lshl_b32 s34, s11, 12
s_add_u32 m0, s34, 115712
s_nop 0
global_load_lds_dwordx4 v200, s[36:37]
s_add_u32 s36, s42, 466944
s_addc_u32 s37, s43, 0
s_lshl_b32 s34, s11, 12
s_add_u32 m0, s34, 116736
s_nop 0
global_load_lds_dwordx4 v201, s[36:37]
s_add_u32 s36, s42, 471040
s_addc_u32 s37, s43, 0
s_lshl_b32 s34, s11, 12
s_add_u32 m0, s34, 117760
s_nop 0
global_load_lds_dwordx4 v201, s[36:37]
s_waitcnt vmcnt(24)
s_barrier
ds_read_b64_tr_b16 a[128:129], v210 offset:0
ds_read_b64_tr_b16 a[130:131], v210 offset:4096
ds_read_b64_tr_b16 a[132:133], v210 offset:8
ds_read_b64_tr_b16 a[134:135], v210 offset:4104
ds_read_b64_tr_b16 a[136:137], v211 offset:0
ds_read_b64_tr_b16 a[138:139], v211 offset:4096
ds_read_b64_tr_b16 a[140:141], v211 offset:8
ds_read_b64_tr_b16 a[142:143], v211 offset:4104
ds_read_b64_tr_b16 a[144:145], v210 offset:8192
ds_read_b64_tr_b16 a[146:147], v210 offset:12288
ds_read_b64_tr_b16 a[148:149], v210 offset:8200
ds_read_b64_tr_b16 a[150:151], v210 offset:12296
ds_read_b64_tr_b16 a[152:153], v211 offset:8192
ds_read_b64_tr_b16 a[154:155], v211 offset:12288
ds_read_b64_tr_b16 a[156:157], v211 offset:8200
ds_read_b64_tr_b16 a[158:159], v211 offset:12296
s_waitcnt lgkmcnt(0)
s_barrier
s_waitcnt vmcnt(16)
s_barrier
ds_read_b64_tr_b16 a[160:161], v210 offset:32768
ds_read_b64_tr_b16 a[162:163], v210 offset:36864
ds_read_b64_tr_b16 a[164:165], v210 offset:32776
ds_read_b64_tr_b16 a[166:167], v210 offset:36872
ds_read_b64_tr_b16 a[168:169], v211 offset:32768
ds_read_b64_tr_b16 a[170:171], v211 offset:36864
ds_read_b64_tr_b16 a[172:173], v211 offset:32776
ds_read_b64_tr_b16 a[174:175], v211 offset:36872
ds_read_b64_tr_b16 a[176:177], v210 offset:40960
ds_read_b64_tr_b16 a[178:179], v210 offset:45056
ds_read_b64_tr_b16 a[180:181], v210 offset:40968
ds_read_b64_tr_b16 a[182:183], v210 offset:45064
ds_read_b64_tr_b16 a[184:185], v211 offset:40960
ds_read_b64_tr_b16 a[186:187], v211 offset:45056
ds_read_b64_tr_b16 a[188:189], v211 offset:40968
ds_read_b64_tr_b16 a[190:191], v211 offset:45064
s_waitcnt lgkmcnt(0)
s_barrier
s_waitcnt vmcnt(8)
s_barrier
ds_read_b64_tr_b16 a[192:193], v212 offset:0
ds_read_b64_tr_b16 a[194:195], v212 offset:4096
ds_read_b64_tr_b16 a[196:197], v212 offset:8
ds_read_b64_tr_b16 a[198:199], v212 offset:4104
ds_read_b64_tr_b16 a[200:201], v213 offset:0
ds_read_b64_tr_b16 a[202:203], v213 offset:4096
ds_read_b64_tr_b16 a[204:205], v213 offset:8
ds_read_b64_tr_b16 a[206:207], v213 offset:4104
ds_read_b64_tr_b16 a[208:209], v212 offset:8192
ds_read_b64_tr_b16 a[210:211], v212 offset:12288
ds_read_b64_tr_b16 a[212:213], v212 offset:8200
ds_read_b64_tr_b16 a[214:215], v212 offset:12296
ds_read_b64_tr_b16 a[216:217], v213 offset:8192
ds_read_b64_tr_b16 a[218:219], v213 offset:12288
ds_read_b64_tr_b16 a[220:221], v213 offset:8200
ds_read_b64_tr_b16 a[222:223], v213 offset:12296
s_waitcnt lgkmcnt(0)
s_barrier
s_waitcnt vmcnt(0)
s_barrier
ds_read_b64_tr_b16 a[224:225], v212 offset:32768
ds_read_b64_tr_b16 a[226:227], v212 offset:36864
ds_read_b64_tr_b16 a[228:229], v212 offset:32776
ds_read_b64_tr_b16 a[230:231], v212 offset:36872
ds_read_b64_tr_b16 a[232:233], v213 offset:32768
ds_read_b64_tr_b16 a[234:235], v213 offset:36864
ds_read_b64_tr_b16 a[236:237], v213 offset:32776
ds_read_b64_tr_b16 a[238:239], v213 offset:36872
ds_read_b64_tr_b16 a[240:241], v212 offset:40960
ds_read_b64_tr_b16 a[242:243], v212 offset:45056
ds_read_b64_tr_b16 a[244:245], v212 offset:40968
ds_read_b64_tr_b16 a[246:247], v212 offset:45064
ds_read_b64_tr_b16 a[248:249], v213 offset:40960
ds_read_b64_tr_b16 a[250:251], v213 offset:45056
ds_read_b64_tr_b16 a[252:253], v213 offset:40968
ds_read_b64_tr_b16 a[254:255], v213 offset:45064
s_waitcnt lgkmcnt(0)
s_barrier
v_lshlrev_b32 v2, 4, v0
v_mov_b32 v8, 0x3f803f80
v_mov_b32 v9, 0x3f803f80
v_mov_b32 v10, 0x3f803f80
v_mov_b32 v11, 0x3f803f80
v_lshrrev_b32 v3, 4, v0
v_and_b32 v4, 15, v0
v_cmp_gt_u32 vcc, 2, v3
s_nop 1
v_cndmask_b32 v12, 0, v8, vcc
v_mov_b32 v13, v12
v_lshlrev_b32 v5, 2, v3
v_add_u32 v5, 0, v5
v_cmp_gt_u32 s[20:21], v5, v4
v_lshlrev_b32 v5, 2, v3
v_add_u32 v5, 1, v5
v_cmp_gt_u32 s[22:23], v5, v4
v_lshlrev_b32 v5, 2, v3
v_add_u32 v5, 2, v5
v_cmp_gt_u32 s[24:25], v5, v4
v_lshlrev_b32 v5, 2, v3
v_add_u32 v5, 3, v5
v_cmp_gt_u32 s[26:27], v5, v4
s_mov_b32 s28, 0x3e0293ee
s_mov_b32 s29, 0xf149f2ca
v_lshrrev_b32 v5, 2, v0
v_lshlrev_b32 v5, 4, v5
v_and_b32 v6, 1, v0
v_lshlrev_b32 v6, 3, v6
v_add_u32 v5, v5, v6
s_lshl_b32 s34, s11, 11
s_add_u32 s30, s34, 40960
v_add_u32 v5, s30, v5
s_lshl_b32 s34, s11, 12
v_add_u32 v6, s34, v2
v_lshlrev_b32 v7, 10, v4
v_lshlrev_b32 v14, 4, v3
v_add_u32 v7, v7, v14
s_lshl_b32 s34, s11, 7
s_lshl_b32 s35, s15, 9
s_add_u32 s34, s34, s35
v_add_u32 v7, s34, v7
s_mov_b32 s17, s16
A_loop:
s_lshl_b32 s34, s17, 7
s_add_u32 s34, s34, 16384
s_add_u32 s42, s4, s34
s_addc_u32 s43, s5, 0
s_cmp_lg_u32 s11, 0
s_cbranch_scc1 W1_37
v_mov_b32 v250, 0
s_mov_b32 s96, 0
W_38:
global_load_dword v251, v250, s[42:43] offset:0 sc1
s_waitcnt vmcnt(0)
v_readfirstlane_b32 s97, v251
s_nop 0
s_cmp_ge_u32 s97, 32
s_cbranch_scc1 WE_39
s_sleep 16
s_add_u32 s96, s96, 1
s_cmp_lt_u32 s96, 200000
s_cbranch_scc1 W_38
WE_39:
W1_37:
s_barrier
s_lshl_b32 s34, s17, 7
s_add_u32 s34, s34, 8192
s_add_u32 s42, s4, s34
s_addc_u32 s43, s5, 0
s_cmp_lg_u32 s11, 0
s_cbranch_scc1 W1_40
v_mov_b32 v250, 0
s_mov_b32 s96, 0
W_41:
global_load_dword v251, v250, s[42:43] offset:0 sc1
s_waitcnt vmcnt(0)
v_readfirstlane_b32 s97, v251
s_nop 0
s_cmp_ge_u32 s97, 32
s_cbranch_scc1 WE_42
s_sleep 4
s_add_u32 s96, s96, 1
s_cmp_lt_u32 s96, 200000
s_cbranch_scc1 W_41
WE_42:
W1_40:
s_barrier
s_lshl_b32 s34, s17, 5
s_add_u32 s31, s34, s18
s_lshl_b32 s34, s31, 13
s_add_u32 s35, s34, 67108864
s_add_u32 s44, s4, s35
s_addc_u32 s45, s5, 0
global_load_dwordx4 v[16:19], v2, s[44:45] offset:0 sc1
global_load_dwordx4 v[20:23], v2, s[44:45] offset:1024 sc1
global_load_dwordx4 v[24:27], v2, s[44:45] offset:2048 sc1
global_load_dwordx4 v[28:31], v2, s[44:45] offset:3072 sc1
s_add_u32 s44, s44, 4096
s_addc_u32 s45, s45, 0
global_load_dwordx4 v[32:35], v2, s[44:45] offset:0 sc1
global_load_dwordx4 v[36:39], v2, s[44:45] offset:1024 sc1
global_load_dwordx4 v[40:43], v2, s[44:45] offset:2048 sc1
global_load_dwordx4 v[44:47], v2, s[44:45] offset:3072 sc1
s_add_u32 s35, s34, 33554432
s_add_u32 s44, s4, s35
s_addc_u32 s45, s5, 0
global_load_dwordx4 v[48:51], v2, s[44:45] offset:0 sc1
global_load_dwordx4 v[52:55], v2, s[44:45] offset:1024 sc1
global_load_dwordx4 v[56:59], v2, s[44:45] offset:2048 sc1
global_load_dwordx4 v[60:63], v2, s[44:45] offset:3072 sc1
s_add_u32 s44, s44, 4096
s_addc_u32 s45, s45, 0
global_load_dwordx4 v[64:67], v2, s[44:45] offset:0 sc1
global_load_dwordx4 v[68:71], v2, s[44:45] offset:1024 sc1
global_load_dwordx4 v[72:75], v2, s[44:45] offset:2048 sc1
global_load_dwordx4 v[76:79], v2, s[44:45] offset:3072 sc1
s_add_u32 s35, s34, 50331648
s_add_u32 s44, s4, s35
s_addc_u32 s45, s5, 0
global_load_dwordx4 v[80:83], v2, s[44:45] offset:0 sc1
global_load_dwordx4 v[84:87], v2, s[44:45] offset:1024 sc1
global_load_dwordx4 v[88:91], v2, s[44:45] offset:2048 sc1
global_load_dwordx4 v[92:95], v2, s[44:45] offset:3072 sc1
s_add_u32 s44, s44, 4096
s_addc_u32 s45, s45, 0
global_load_dwordx4 v[96:99], v2, s[44:45] offset:0 sc1
global_load_dwordx4 v[100:103], v2, s[44:45] offset:1024 sc1
global_load_dwordx4 v[104:107], v2, s[44:45] offset:2048 sc1
global_load_dwordx4 v[108:111], v2, s[44:45] offset:3072 sc1
s_waitcnt vmcnt(8)
v_mfma_f32_16x16x32_bf16 v[144:147], v[48:51], v[16:19], 0
v_mfma_f32_16x16x32_bf16 v[148:151], v[48:51], v[32:35], 0
v_mfma_f32_16x16x32_bf16 v[152:155], v[64:67], v[32:35], 0
v_mfma_f32_16x16x32_bf16 v[144:147], v[52:55], v[20:23], v[144:147]
v_mfma_f32_16x16x32_bf16 v[148:151], v[52:55], v[36:39], v[148:151]
v_mfma_f32_16x16x32_bf16 v[152:155], v[68:71], v[36:39], v[152:155]
v_mfma_f32_16x16x32_bf16 v[144:147], v[56:59], v[24:27], v[144:147]
v_mfma_f32_16x16x32_bf16 v[148:151], v[56:59], v[40:43], v[148:151]
v_mfma_f32_16x16x32_bf16 v[152:155], v[72:75], v[40:43], v[152:155]
v_mfma_f32_16x16x32_bf16 v[144:147], v[60:63], v[28:31], v[144:147]
v_mfma_f32_16x16x32_bf16 v[148:151], v[60:63], v[44:47], v[148:151]
v_mfma_f32_16x16x32_bf16 v[152:155], v[76:79], v[44:47], v[152:155]
s_cmp_ge_u32 s17, 61
s_cbranch_scc1 GE_43
s_lshl_b32 s34, s17, 7
s_add_u32 s34, s34, 24576
s_mov_b32 s33, 559232
s_branch GJ_44
GE_43:
s_lshl_b32 s34, s17, 7
s_add_u32 s34, s34, 24448
s_mov_b32 s33, 559232
GJ_44:
s_add_u32 s42, s4, s34
s_addc_u32 s43, s5, 0
s_cmp_lg_u32 s11, 0
s_cbranch_scc1 W1_45
v_mov_b32 v250, 0
s_mov_b32 s96, 0
W_46:
global_load_dword v251, v250, s[42:43] offset:0 sc1
s_waitcnt vmcnt(0)
v_readfirstlane_b32 s97, v251
s_nop 0
s_cmp_ge_u32 s97, s33
s_cbranch_scc1 WE_47
s_sleep 16
s_add_u32 s96, s96, 1
s_cmp_lt_u32 s96, 200000
s_cbranch_scc1 W_46
WE_47:
W1_45:
s_barrier
s_cmp_lt_u32 s17, 61
s_cbranch_scc1 GS_48
s_sleep 34
GS_48:
s_lshl_b32 s34, s31, 11
s_add_u32 s34, s34, 83886080
s_add_u32 s44, s4, s34
s_addc_u32 s45, s5, 0
s_lshl_b32 s34, s31, 13
s_add_u32 s34, s34, 88080384
s_add_u32 s46, s4, s34
s_addc_u32 s47, s5, 0
s_add_u32 s48, s46, 4096
s_addc_u32 s49, s47, 0
s_mov_b32 s96, 0
LV_49:
global_load_dwordx4 v[112:115], v2, s[44:45] sc1
global_load_dwordx4 v[116:119], v2, s[44:45] offset:1024 sc1
global_load_dwordx4 v[128:131], v2, s[46:47] offset:0 sc1
global_load_dwordx4 v[132:135], v2, s[46:47] offset:2048 sc1
global_load_dwordx4 v[136:139], v2, s[48:49] offset:0 sc1
global_load_dwordx4 v[140:143], v2, s[48:49] offset:2048 sc1
s_waitcnt vmcnt(0)
v_max3_u32 v14, v112, v113, v114
v_max3_u32 v14, v14, v115, v116
v_max3_u32 v14, v14, v117, v118
v_max3_u32 v14, v14, v119, v128
v_max3_u32 v14, v14, v129, v130
v_max3_u32 v14, v14, v131, v132
v_max3_u32 v14, v14, v133, v134
v_max3_u32 v14, v14, v135, v136
v_max3_u32 v14, v14, v137, v138
v_max3_u32 v14, v14, v139, v140
v_max3_u32 v14, v14, v141, v142
v_max_u32 v14, v14, v143
v_cmp_eq_u32 vcc, -1, v14
s_cbranch_vccz LVE_50
s_sleep 4
s_add_u32 s96, s96, 1
s_cmp_lt_u32 s96, 20000
s_cbranch_scc1 LV_49
LVE_50:
v_add_u32 v14, s30, v2
ds_write_b128 v14, v[112:115]
ds_write_b128 v14, v[116:119] offset:1024
s_waitcnt lgkmcnt(0)
ds_read_b64_tr_b16 v[112:113], v5 offset:0
ds_read_b64_tr_b16 v[114:115], v5 offset:256
ds_read_b64_tr_b16 v[116:117], v5 offset:512
ds_read_b64_tr_b16 v[118:119], v5 offset:768
ds_read_b64_tr_b16 v[120:121], v5 offset:1024
ds_read_b64_tr_b16 v[122:123], v5 offset:1280
ds_read_b64_tr_b16 v[124:125], v5 offset:1536
ds_read_b64_tr_b16 v[126:127], v5 offset:1792
s_waitcnt lgkmcnt(0)
v_mfma_f32_16x16x32_bf16 v[156:159], v[112:115], v[16:19], 0
v_mfma_f32_16x16x32_bf16 v[160:163], v[112:115], v[32:35], 0
v_mfma_f32_16x16x32_bf16 v[156:159], v[116:119], v[20:23], v[156:159]
v_mfma_f32_16x16x32_bf16 v[160:163], v[116:119], v[36:39], v[160:163]
v_mfma_f32_16x16x32_bf16 v[156:159], v[120:123], v[24:27], v[156:159]
v_mfma_f32_16x16x32_bf16 v[160:163], v[120:123], v[40:43], v[160:163]
v_mfma_f32_16x16x32_bf16 v[156:159], v[124:127], v[28:31], v[156:159]
v_mfma_f32_16x16x32_bf16 v[160:163], v[124:127], v[44:47], v[160:163]
v_mov_b32 v15, s29
v_cndmask_b32 v144, v144, v15, s[20:21]
v_cndmask_b32 v145, v145, v15, s[22:23]
v_cndmask_b32 v146, v146, v15, s[24:25]
v_cndmask_b32 v147, v147, v15, s[26:27]
v_cndmask_b32 v152, v152, v15, s[20:21]
v_cndmask_b32 v153, v153, v15, s[22:23]
v_cndmask_b32 v154, v154, v15, s[24:25]
v_cndmask_b32 v155, v155, v15, s[26:27]
v_max3_f32 v14, v144, v145, v146
v_max3_f32 v14, v14, v147, v156
v_max3_f32 v14, v14, v157, v158
v_max_f32 v14, v14, v159
v_mov_b32 v15, v14
s_nop 1
v_permlane16_swap_b32 v14, v15
v_max_f32 v14, v14, v15
v_mov_b32 v15, v14
s_nop 1
v_permlane32_swap_b32 v14, v15
v_max_f32 v14, v14, v15
v_mul_f32 v14, s28, v14
v_fma_f32 v144, v144, s28, -v14
v_fma_f32 v145, v145, s28, -v14
v_fma_f32 v146, v146, s28, -v14
v_fma_f32 v147, v147, s28, -v14
v_fma_f32 v156, v156, s28, -v14
v_fma_f32 v157, v157, s28, -v14
v_fma_f32 v158, v158, s28, -v14
v_fma_f32 v159, v159, s28, -v14
v_exp_f32 v144, v144
v_exp_f32 v145, v145
v_exp_f32 v146, v146
v_exp_f32 v147, v147
v_exp_f32 v156, v156
v_exp_f32 v157, v157
v_exp_f32 v158, v158
v_exp_f32 v159, v159
v_cvt_pk_bf16_f32 v228, v144, v145
v_cvt_pk_bf16_f32 v229, v146, v147
v_mov_b32 v230, 0
v_mov_b32 v231, 0
v_cvt_pk_bf16_f32 v236, v156, v157
v_cvt_pk_bf16_f32 v237, v158, v159
v_max3_f32 v14, v148, v149, v150
v_max3_f32 v14, v14, v151, v152
v_max3_f32 v14, v14, v153, v154
v_max3_f32 v14, v14, v155, v160
v_max3_f32 v14, v14, v161, v162
v_max_f32 v14, v14, v163
v_mov_b32 v15, v14
s_nop 1
v_permlane16_swap_b32 v14, v15
v_max_f32 v14, v14, v15
v_mov_b32 v15, v14
s_nop 1
v_permlane32_swap_b32 v14, v15
v_max_f32 v14, v14, v15
v_mul_f32 v14, s28, v14
v_fma_f32 v148, v148, s28, -v14
v_fma_f32 v149, v149, s28, -v14
v_fma_f32 v150, v150, s28, -v14
v_fma_f32 v151, v151, s28, -v14
v_fma_f32 v152, v152, s28, -v14
v_fma_f32 v153, v153, s28, -v14
v_fma_f32 v154, v154, s28, -v14
v_fma_f32 v155, v155, s28, -v14
v_fma_f32 v160, v160, s28, -v14
v_fma_f32 v161, v161, s28, -v14
v_fma_f32 v162, v162, s28, -v14
v_fma_f32 v163, v163, s28, -v14
v_exp_f32 v148, v148
v_exp_f32 v149, v149
v_exp_f32 v150, v150
v_exp_f32 v151, v151
v_exp_f32 v152, v152
v_exp_f32 v153, v153
v_exp_f32 v154, v154
v_exp_f32 v155, v155
v_exp_f32 v160, v160
v_exp_f32 v161, v161
v_exp_f32 v162, v162
v_exp_f32 v163, v163
v_cvt_pk_bf16_f32 v232, v148, v149
v_cvt_pk_bf16_f32 v233, v150, v151
v_cvt_pk_bf16_f32 v234, v152, v153
v_cvt_pk_bf16_f32 v235, v154, v155
v_cvt_pk_bf16_f32 v238, v160, v161
v_cvt_pk_bf16_f32 v239, v162, v163
v_mfma_f32_16x16x32_bf16 v[240:243], v[8:11], v[228:231], 0
v_mfma_f32_16x16x32_bf16 v[164:167], v[80:83], v[228:231], 0
v_mfma_f32_16x16x32_bf16 v[172:175], v[84:87], v[228:231], 0
v_mfma_f32_16x16x32_bf16 v[180:183], v[88:91], v[228:231], 0
v_mfma_f32_16x16x32_bf16 v[188:191], v[92:95], v[228:231], 0
v_mfma_f32_16x16x32_bf16 v[196:199], v[96:99], v[228:231], 0
v_mfma_f32_16x16x32_bf16 v[204:207], v[100:103], v[228:231], 0
v_mfma_f32_16x16x32_bf16 v[212:215], v[104:107], v[228:231], 0
v_mfma_f32_16x16x32_bf16 v[220:223], v[108:111], v[228:231], 0
v_mfma_f32_16x16x32_bf16 v[244:247], v[8:11], v[232:235], 0
v_mfma_f32_16x16x32_bf16 v[168:171], v[80:83], v[232:235], 0
v_mfma_f32_16x16x32_bf16 v[176:179], v[84:87], v[232:235], 0
v_mfma_f32_16x16x32_bf16 v[184:187], v[88:91], v[232:235], 0
v_mfma_f32_16x16x32_bf16 v[192:195], v[92:95], v[232:235], 0
v_mfma_f32_16x16x32_bf16 v[200:203], v[96:99], v[232:235], 0
v_mfma_f32_16x16x32_bf16 v[208:211], v[100:103], v[232:235], 0
v_mfma_f32_16x16x32_bf16 v[216:219], v[104:107], v[232:235], 0
v_mfma_f32_16x16x32_bf16 v[224:227], v[108:111], v[232:235], 0
v_mfma_f32_16x16x16_bf16 v[240:243], v[12:13], v[236:237], v[240:243]
v_mfma_f32_16x16x16_bf16 v[164:167], v[128:129], v[236:237], v[164:167]
v_mfma_f32_16x16x16_bf16 v[172:175], v[130:131], v[236:237], v[172:175]
v_mfma_f32_16x16x16_bf16 v[180:183], v[132:133], v[236:237], v[180:183]
v_mfma_f32_16x16x16_bf16 v[188:191], v[134:135], v[236:237], v[188:191]
v_mfma_f32_16x16x16_bf16 v[196:199], v[136:137], v[236:237], v[196:199]
v_mfma_f32_16x16x16_bf16 v[204:207], v[138:139], v[236:237], v[204:207]
v_mfma_f32_16x16x16_bf16 v[212:215], v[140:141], v[236:237], v[212:215]
v_mfma_f32_16x16x16_bf16 v[220:223], v[142:143], v[236:237], v[220:223]
v_mfma_f32_16x16x16_bf16 v[244:247], v[12:13], v[238:239], v[244:247]
v_mfma_f32_16x16x16_bf16 v[168:171], v[128:129], v[238:239], v[168:171]
v_mfma_f32_16x16x16_bf16 v[176:179], v[130:131], v[238:239], v[176:179]
v_mfma_f32_16x16x16_bf16 v[184:187], v[132:133], v[238:239], v[184:187]
v_mfma_f32_16x16x16_bf16 v[192:195], v[134:135], v[238:239], v[192:195]
v_mfma_f32_16x16x16_bf16 v[200:203], v[136:137], v[238:239], v[200:203]
v_mfma_f32_16x16x16_bf16 v[208:211], v[138:139], v[238:239], v[208:211]
v_mfma_f32_16x16x16_bf16 v[216:219], v[140:141], v[238:239], v[216:219]
v_mfma_f32_16x16x16_bf16 v[224:227], v[142:143], v[238:239], v[224:227]
v_rcp_f32 v14, v240
s_nop 0
v_mul_f32 v164, v14, v164
v_mul_f32 v165, v14, v165
v_mul_f32 v166, v14, v166
v_mul_f32 v167, v14, v167
v_cvt_pk_bf16_f32 v16, v164, v165
v_cvt_pk_bf16_f32 v17, v166, v167
v_mul_f32 v172, v14, v172
v_mul_f32 v173, v14, v173
v_mul_f32 v174, v14, v174
v_mul_f32 v175, v14, v175
v_cvt_pk_bf16_f32 v18, v172, v173
v_cvt_pk_bf16_f32 v19, v174, v175
ds_write_b128 v6, v[16:19] offset:0
v_mul_f32 v180, v14, v180
v_mul_f32 v181, v14, v181
v_mul_f32 v182, v14, v182
v_mul_f32 v183, v14, v183
v_cvt_pk_bf16_f32 v20, v180, v181
v_cvt_pk_bf16_f32 v21, v182, v183
v_mul_f32 v188, v14, v188
v_mul_f32 v189, v14, v189
v_mul_f32 v190, v14, v190
v_mul_f32 v191, v14, v191
v_cvt_pk_bf16_f32 v22, v188, v189
v_cvt_pk_bf16_f32 v23, v190, v191
ds_write_b128 v6, v[20:23] offset:1024
v_mul_f32 v196, v14, v196
v_mul_f32 v197, v14, v197
v_mul_f32 v198, v14, v198
v_mul_f32 v199, v14, v199
v_cvt_pk_bf16_f32 v24, v196, v197
v_cvt_pk_bf16_f32 v25, v198, v199
v_mul_f32 v204, v14, v204
v_mul_f32 v205, v14, v205
v_mul_f32 v206, v14, v206
v_mul_f32 v207, v14, v207
v_cvt_pk_bf16_f32 v26, v204, v205
v_cvt_pk_bf16_f32 v27, v206, v207
ds_write_b128 v6, v[24:27] offset:2048
v_mul_f32 v212, v14, v212
v_mul_f32 v213, v14, v213
v_mul_f32 v214, v14, v214
v_mul_f32 v215, v14, v215
v_cvt_pk_bf16_f32 v28, v212, v213
v_cvt_pk_bf16_f32 v29, v214, v215
v_mul_f32 v220, v14, v220
v_mul_f32 v221, v14, v221
v_mul_f32 v222, v14, v222
v_mul_f32 v223, v14, v223
v_cvt_pk_bf16_f32 v30, v220, v221
v_cvt_pk_bf16_f32 v31, v222, v223
ds_write_b128 v6, v[28:31] offset:3072
v_rcp_f32 v14, v244
s_nop 0
v_mul_f32 v168, v14, v168
v_mul_f32 v169, v14, v169
v_mul_f32 v170, v14, v170
v_mul_f32 v171, v14, v171
v_cvt_pk_bf16_f32 v16, v168, v169
v_cvt_pk_bf16_f32 v17, v170, v171
v_mul_f32 v176, v14, v176
v_mul_f32 v177, v14, v177
v_mul_f32 v178, v14, v178
v_mul_f32 v179, v14, v179
v_cvt_pk_bf16_f32 v18, v176, v177
v_cvt_pk_bf16_f32 v19, v178, v179
ds_write_b128 v6, v[16:19] offset:16384
v_mul_f32 v184, v14, v184
v_mul_f32 v185, v14, v185
v_mul_f32 v186, v14, v186
v_mul_f32 v187, v14, v187
v_cvt_pk_bf16_f32 v20, v184, v185
v_cvt_pk_bf16_f32 v21, v186, v187
v_mul_f32 v192, v14, v192
v_mul_f32 v193, v14, v193
v_mul_f32 v194, v14, v194
v_mul_f32 v195, v14, v195
v_cvt_pk_bf16_f32 v22, v192, v193
v_cvt_pk_bf16_f32 v23, v194, v195
ds_write_b128 v6, v[20:23] offset:17408
v_mul_f32 v200, v14, v200
v_mul_f32 v201, v14, v201
v_mul_f32 v202, v14, v202
v_mul_f32 v203, v14, v203
v_cvt_pk_bf16_f32 v24, v200, v201
v_cvt_pk_bf16_f32 v25, v202, v203
v_mul_f32 v208, v14, v208
v_mul_f32 v209, v14, v209
v_mul_f32 v210, v14, v210
v_mul_f32 v211, v14, v211
v_cvt_pk_bf16_f32 v26, v208, v209
v_cvt_pk_bf16_f32 v27, v210, v211
ds_write_b128 v6, v[24:27] offset:18432
v_mul_f32 v216, v14, v216
v_mul_f32 v217, v14, v217
v_mul_f32 v218, v14, v218
v_mul_f32 v219, v14, v219
v_cvt_pk_bf16_f32 v28, v216, v217
v_cvt_pk_bf16_f32 v29, v218, v219
v_mul_f32 v224, v14, v224
v_mul_f32 v225, v14, v225
v_mul_f32 v226, v14, v226
v_mul_f32 v227, v14, v227
v_cvt_pk_bf16_f32 v30, v224, v225
v_cvt_pk_bf16_f32 v31, v226, v227
ds_write_b128 v6, v[28:31] offset:19456
s_waitcnt lgkmcnt(0)
s_barrier
v_mov_b64 v[48:49], 0
v_mov_b64 v[50:51], 0
v_mov_b64 v[52:53], 0
v_mov_b64 v[54:55], 0
v_mov_b64 v[56:57], 0
v_mov_b64 v[58:59], 0
v_mov_b64 v[60:61], 0
v_mov_b64 v[62:63], 0
v_mov_b64 v[64:65], 0
v_mov_b64 v[66:67], 0
v_mov_b64 v[68:69], 0
v_mov_b64 v[70:71], 0
v_mov_b64 v[72:73], 0
v_mov_b64 v[74:75], 0
v_mov_b64 v[76:77], 0
v_mov_b64 v[78:79], 0
ds_read_b128 v[80:83], v2 offset:0
ds_read_b128 v[84:87], v2 offset:1024
ds_read_b128 v[88:91], v2 offset:2048
ds_read_b128 v[92:95], v2 offset:3072
ds_read_b128 v[96:99], v2 offset:4096
s_waitcnt lgkmcnt(4)
v_mfma_f32_16x16x32_bf16 v[48:51], a[0:3], v[80:83], v[48:51]
v_mfma_f32_16x16x32_bf16 v[56:59], a[4:7], v[80:83], v[56:59]
v_mfma_f32_16x16x32_bf16 v[64:67], a[8:11], v[80:83], v[64:67]
v_mfma_f32_16x16x32_bf16 v[72:75], a[12:15], v[80:83], v[72:75]
ds_read_b128 v[100:103], v2 offset:5120
s_waitcnt lgkmcnt(4)
v_mfma_f32_16x16x32_bf16 v[48:51], a[16:19], v[84:87], v[48:51]
v_mfma_f32_16x16x32_bf16 v[56:59], a[20:23], v[84:87], v[56:59]
v_mfma_f32_16x16x32_bf16 v[64:67], a[24:27], v[84:87], v[64:67]
v_mfma_f32_16x16x32_bf16 v[72:75], a[28:31], v[84:87], v[72:75]
ds_read_b128 v[104:107], v2 offset:6144
s_waitcnt lgkmcnt(4)
v_mfma_f32_16x16x32_bf16 v[48:51], a[32:35], v[88:91], v[48:51]
v_mfma_f32_16x16x32_bf16 v[56:59], a[36:39], v[88:91], v[56:59]
v_mfma_f32_16x16x32_bf16 v[64:67], a[40:43], v[88:91], v[64:67]
v_mfma_f32_16x16x32_bf16 v[72:75], a[44:47], v[88:91], v[72:75]
ds_read_b128 v[108:111], v2 offset:7168
s_waitcnt lgkmcnt(4)
v_mfma_f32_16x16x32_bf16 v[48:51], a[48:51], v[92:95], v[48:51]
v_mfma_f32_16x16x32_bf16 v[56:59], a[52:55], v[92:95], v[56:59]
v_mfma_f32_16x16x32_bf16 v[64:67], a[56:59], v[92:95], v[64:67]
v_mfma_f32_16x16x32_bf16 v[72:75], a[60:63], v[92:95], v[72:75]
ds_read_b128 v[80:83], v2 offset:8192
s_waitcnt lgkmcnt(4)
v_mfma_f32_16x16x32_bf16 v[48:51], a[64:67], v[96:99], v[48:51]
v_mfma_f32_16x16x32_bf16 v[56:59], a[68:71], v[96:99], v[56:59]
v_mfma_f32_16x16x32_bf16 v[64:67], a[72:75], v[96:99], v[64:67]
v_mfma_f32_16x16x32_bf16 v[72:75], a[76:79], v[96:99], v[72:75]
ds_read_b128 v[84:87], v2 offset:9216
s_waitcnt lgkmcnt(4)
v_mfma_f32_16x16x32_bf16 v[48:51], a[80:83], v[100:103], v[48:51]
v_mfma_f32_16x16x32_bf16 v[56:59], a[84:87], v[100:103], v[56:59]
v_mfma_f32_16x16x32_bf16 v[64:67], a[88:91], v[100:103], v[64:67]
v_mfma_f32_16x16x32_bf16 v[72:75], a[92:95], v[100:103], v[72:75]
ds_read_b128 v[88:91], v2 offset:10240
s_waitcnt lgkmcnt(4)
v_mfma_f32_16x16x32_bf16 v[48:51], a[96:99], v[104:107], v[48:51]
v_mfma_f32_16x16x32_bf16 v[56:59], a[100:103], v[104:107], v[56:59]
v_mfma_f32_16x16x32_bf16 v[64:67], a[104:107], v[104:107], v[64:67]
v_mfma_f32_16x16x32_bf16 v[72:75], a[108:111], v[104:107], v[72:75]
ds_read_b128 v[92:95], v2 offset:11264
s_waitcnt lgkmcnt(4)
v_mfma_f32_16x16x32_bf16 v[48:51], a[112:115], v[108:111], v[48:51]
v_mfma_f32_16x16x32_bf16 v[56:59], a[116:119], v[108:111], v[56:59]
v_mfma_f32_16x16x32_bf16 v[64:67], a[120:123], v[108:111], v[64:67]
v_mfma_f32_16x16x32_bf16 v[72:75], a[124:127], v[108:111], v[72:75]
ds_read_b128 v[96:99], v2 offset:12288
s_waitcnt lgkmcnt(4)
v_mfma_f32_16x16x32_bf16 v[48:51], a[128:131], v[80:83], v[48:51]
v_mfma_f32_16x16x32_bf16 v[56:59], a[132:135], v[80:83], v[56:59]
v_mfma_f32_16x16x32_bf16 v[64:67], a[136:139], v[80:83], v[64:67]
v_mfma_f32_16x16x32_bf16 v[72:75], a[140:143], v[80:83], v[72:75]
ds_read_b128 v[100:103], v2 offset:13312
s_waitcnt lgkmcnt(4)
v_mfma_f32_16x16x32_bf16 v[48:51], a[144:147], v[84:87], v[48:51]
v_mfma_f32_16x16x32_bf16 v[56:59], a[148:151], v[84:87], v[56:59]
v_mfma_f32_16x16x32_bf16 v[64:67], a[152:155], v[84:87], v[64:67]
v_mfma_f32_16x16x32_bf16 v[72:75], a[156:159], v[84:87], v[72:75]
ds_read_b128 v[104:107], v2 offset:14336
s_waitcnt lgkmcnt(4)
v_mfma_f32_16x16x32_bf16 v[48:51], a[160:163], v[88:91], v[48:51]
v_mfma_f32_16x16x32_bf16 v[56:59], a[164:167], v[88:91], v[56:59]
v_mfma_f32_16x16x32_bf16 v[64:67], a[168:171], v[88:91], v[64:67]
v_mfma_f32_16x16x32_bf16 v[72:75], a[172:175], v[88:91], v[72:75]
ds_read_b128 v[108:111], v2 offset:15360
s_waitcnt lgkmcnt(4)
v_mfma_f32_16x16x32_bf16 v[48:51], a[176:179], v[92:95], v[48:51]
v_mfma_f32_16x16x32_bf16 v[56:59], a[180:183], v[92:95], v[56:59]
v_mfma_f32_16x16x32_bf16 v[64:67], a[184:187], v[92:95], v[64:67]
v_mfma_f32_16x16x32_bf16 v[72:75], a[188:191], v[92:95], v[72:75]
ds_read_b128 v[80:83], v2 offset:16384
s_waitcnt lgkmcnt(4)
v_mfma_f32_16x16x32_bf16 v[48:51], a[192:195], v[96:99], v[48:51]
v_mfma_f32_16x16x32_bf16 v[56:59], a[196:199], v[96:99], v[56:59]
v_mfma_f32_16x16x32_bf16 v[64:67], a[200:203], v[96:99], v[64:67]
v_mfma_f32_16x16x32_bf16 v[72:75], a[204:207], v[96:99], v[72:75]
ds_read_b128 v[84:87], v2 offset:17408
s_waitcnt lgkmcnt(4)
v_mfma_f32_16x16x32_bf16 v[48:51], a[208:211], v[100:103], v[48:51]
v_mfma_f32_16x16x32_bf16 v[56:59], a[212:215], v[100:103], v[56:59]
v_mfma_f32_16x16x32_bf16 v[64:67], a[216:219], v[100:103], v[64:67]
v_mfma_f32_16x16x32_bf16 v[72:75], a[220:223], v[100:103], v[72:75]
ds_read_b128 v[88:91], v2 offset:18432
s_waitcnt lgkmcnt(4)
v_mfma_f32_16x16x32_bf16 v[48:51], a[224:227], v[104:107], v[48:51]
v_mfma_f32_16x16x32_bf16 v[56:59], a[228:231], v[104:107], v[56:59]
v_mfma_f32_16x16x32_bf16 v[64:67], a[232:235], v[104:107], v[64:67]
v_mfma_f32_16x16x32_bf16 v[72:75], a[236:239], v[104:107], v[72:75]
ds_read_b128 v[92:95], v2 offset:19456
s_waitcnt lgkmcnt(4)
v_mfma_f32_16x16x32_bf16 v[48:51], a[240:243], v[108:111], v[48:51]
v_mfma_f32_16x16x32_bf16 v[56:59], a[244:247], v[108:111], v[56:59]
v_mfma_f32_16x16x32_bf16 v[64:67], a[248:251], v[108:111], v[64:67]
v_mfma_f32_16x16x32_bf16 v[72:75], a[252:255], v[108:111], v[72:75]
ds_read_b128 v[96:99], v2 offset:20480
s_waitcnt lgkmcnt(4)
v_mfma_f32_16x16x32_bf16 v[52:55], a[0:3], v[80:83], v[52:55]
v_mfma_f32_16x16x32_bf16 v[60:63], a[4:7], v[80:83], v[60:63]
v_mfma_f32_16x16x32_bf16 v[68:71], a[8:11], v[80:83], v[68:71]
v_mfma_f32_16x16x32_bf16 v[76:79], a[12:15], v[80:83], v[76:79]
ds_read_b128 v[100:103], v2 offset:21504
s_waitcnt lgkmcnt(4)
v_mfma_f32_16x16x32_bf16 v[52:55], a[16:19], v[84:87], v[52:55]
v_mfma_f32_16x16x32_bf16 v[60:63], a[20:23], v[84:87], v[60:63]
v_mfma_f32_16x16x32_bf16 v[68:71], a[24:27], v[84:87], v[68:71]
v_mfma_f32_16x16x32_bf16 v[76:79], a[28:31], v[84:87], v[76:79]
ds_read_b128 v[104:107], v2 offset:22528
s_waitcnt lgkmcnt(4)
v_mfma_f32_16x16x32_bf16 v[52:55], a[32:35], v[88:91], v[52:55]
v_mfma_f32_16x16x32_bf16 v[60:63], a[36:39], v[88:91], v[60:63]
v_mfma_f32_16x16x32_bf16 v[68:71], a[40:43], v[88:91], v[68:71]
v_mfma_f32_16x16x32_bf16 v[76:79], a[44:47], v[88:91], v[76:79]
ds_read_b128 v[108:111], v2 offset:23552
s_waitcnt lgkmcnt(4)
v_mfma_f32_16x16x32_bf16 v[52:55], a[48:51], v[92:95], v[52:55]
v_mfma_f32_16x16x32_bf16 v[60:63], a[52:55], v[92:95], v[60:63]
v_mfma_f32_16x16x32_bf16 v[68:71], a[56:59], v[92:95], v[68:71]
v_mfma_f32_16x16x32_bf16 v[76:79], a[60:63], v[92:95], v[76:79]
ds_read_b128 v[80:83], v2 offset:24576
s_waitcnt lgkmcnt(4)
v_mfma_f32_16x16x32_bf16 v[52:55], a[64:67], v[96:99], v[52:55]
v_mfma_f32_16x16x32_bf16 v[60:63], a[68:71], v[96:99], v[60:63]
v_mfma_f32_16x16x32_bf16 v[68:71], a[72:75], v[96:99], v[68:71]
v_mfma_f32_16x16x32_bf16 v[76:79], a[76:79], v[96:99], v[76:79]
ds_read_b128 v[84:87], v2 offset:25600
s_waitcnt lgkmcnt(4)
v_mfma_f32_16x16x32_bf16 v[52:55], a[80:83], v[100:103], v[52:55]
v_mfma_f32_16x16x32_bf16 v[60:63], a[84:87], v[100:103], v[60:63]
v_mfma_f32_16x16x32_bf16 v[68:71], a[88:91], v[100:103], v[68:71]
v_mfma_f32_16x16x32_bf16 v[76:79], a[92:95], v[100:103], v[76:79]
ds_read_b128 v[88:91], v2 offset:26624
s_waitcnt lgkmcnt(4)
v_mfma_f32_16x16x32_bf16 v[52:55], a[96:99], v[104:107], v[52:55]
v_mfma_f32_16x16x32_bf16 v[60:63], a[100:103], v[104:107], v[60:63]
v_mfma_f32_16x16x32_bf16 v[68:71], a[104:107], v[104:107], v[68:71]
v_mfma_f32_16x16x32_bf16 v[76:79], a[108:111], v[104:107], v[76:79]
ds_read_b128 v[92:95], v2 offset:27648
s_waitcnt lgkmcnt(4)
v_mfma_f32_16x16x32_bf16 v[52:55], a[112:115], v[108:111], v[52:55]
v_mfma_f32_16x16x32_bf16 v[60:63], a[116:119], v[108:111], v[60:63]
v_mfma_f32_16x16x32_bf16 v[68:71], a[120:123], v[108:111], v[68:71]
v_mfma_f32_16x16x32_bf16 v[76:79], a[124:127], v[108:111], v[76:79]
ds_read_b128 v[96:99], v2 offset:28672
s_waitcnt lgkmcnt(4)
v_mfma_f32_16x16x32_bf16 v[52:55], a[128:131], v[80:83], v[52:55]
v_mfma_f32_16x16x32_bf16 v[60:63], a[132:135], v[80:83], v[60:63]
v_mfma_f32_16x16x32_bf16 v[68:71], a[136:139], v[80:83], v[68:71]
v_mfma_f32_16x16x32_bf16 v[76:79], a[140:143], v[80:83], v[76:79]
ds_read_b128 v[100:103], v2 offset:29696
s_waitcnt lgkmcnt(4)
v_mfma_f32_16x16x32_bf16 v[52:55], a[144:147], v[84:87], v[52:55]
v_mfma_f32_16x16x32_bf16 v[60:63], a[148:151], v[84:87], v[60:63]
v_mfma_f32_16x16x32_bf16 v[68:71], a[152:155], v[84:87], v[68:71]
v_mfma_f32_16x16x32_bf16 v[76:79], a[156:159], v[84:87], v[76:79]
ds_read_b128 v[104:107], v2 offset:30720
s_waitcnt lgkmcnt(4)
v_mfma_f32_16x16x32_bf16 v[52:55], a[160:163], v[88:91], v[52:55]
v_mfma_f32_16x16x32_bf16 v[60:63], a[164:167], v[88:91], v[60:63]
v_mfma_f32_16x16x32_bf16 v[68:71], a[168:171], v[88:91], v[68:71]
v_mfma_f32_16x16x32_bf16 v[76:79], a[172:175], v[88:91], v[76:79]
ds_read_b128 v[108:111], v2 offset:31744
s_waitcnt lgkmcnt(4)
v_mfma_f32_16x16x32_bf16 v[52:55], a[176:179], v[92:95], v[52:55]
v_mfma_f32_16x16x32_bf16 v[60:63], a[180:183], v[92:95], v[60:63]
v_mfma_f32_16x16x32_bf16 v[68:71], a[184:187], v[92:95], v[68:71]
v_mfma_f32_16x16x32_bf16 v[76:79], a[188:191], v[92:95], v[76:79]
s_waitcnt lgkmcnt(3)
v_mfma_f32_16x16x32_bf16 v[52:55], a[192:195], v[96:99], v[52:55]
v_mfma_f32_16x16x32_bf16 v[60:63], a[196:199], v[96:99], v[60:63]
v_mfma_f32_16x16x32_bf16 v[68:71], a[200:203], v[96:99], v[68:71]
v_mfma_f32_16x16x32_bf16 v[76:79], a[204:207], v[96:99], v[76:79]
s_waitcnt lgkmcnt(2)
v_mfma_f32_16x16x32_bf16 v[52:55], a[208:211], v[100:103], v[52:55]
v_mfma_f32_16x16x32_bf16 v[60:63], a[212:215], v[100:103], v[60:63]
v_mfma_f32_16x16x32_bf16 v[68:71], a[216:219], v[100:103], v[68:71]
v_mfma_f32_16x16x32_bf16 v[76:79], a[220:223], v[100:103], v[76:79]
s_waitcnt lgkmcnt(1)
v_mfma_f32_16x16x32_bf16 v[52:55], a[224:227], v[104:107], v[52:55]
v_mfma_f32_16x16x32_bf16 v[60:63], a[228:231], v[104:107], v[60:63]
v_mfma_f32_16x16x32_bf16 v[68:71], a[232:235], v[104:107], v[68:71]
v_mfma_f32_16x16x32_bf16 v[76:79], a[236:239], v[104:107], v[76:79]
s_waitcnt lgkmcnt(0)
v_mfma_f32_16x16x32_bf16 v[52:55], a[240:243], v[108:111], v[52:55]
v_mfma_f32_16x16x32_bf16 v[60:63], a[244:247], v[108:111], v[60:63]
v_mfma_f32_16x16x32_bf16 v[68:71], a[248:251], v[108:111], v[68:71]
v_mfma_f32_16x16x32_bf16 v[76:79], a[252:255], v[108:111], v[76:79]
s_lshl_b32 s34, s17, 3
s_add_u32 s34, s34, s14
s_lshl_b32 s34, s34, 15
s_add_u32 s34, s34, 104857600
s_add_u32 s44, s4, s34
s_addc_u32 s45, s5, 0
v_cvt_pk_bf16_f32 v16, v48, v49
v_cvt_pk_bf16_f32 v17, v50, v51
v_cvt_pk_bf16_f32 v18, v56, v57
v_cvt_pk_bf16_f32 v19, v58, v59
v_cvt_pk_bf16_f32 v20, v64, v65
v_cvt_pk_bf16_f32 v21, v66, v67
v_cvt_pk_bf16_f32 v22, v72, v73
v_cvt_pk_bf16_f32 v23, v74, v75
global_store_dwordx4 v7, v[16:19], s[44:45] offset:0 sc1
global_store_dwordx4 v7, v[20:23], s[44:45] offset:64 sc1
v_cvt_pk_bf16_f32 v24, v52, v53
v_cvt_pk_bf16_f32 v25, v54, v55
v_cvt_pk_bf16_f32 v26, v60, v61
v_cvt_pk_bf16_f32 v27, v62, v63
v_cvt_pk_bf16_f32 v28, v68, v69
v_cvt_pk_bf16_f32 v29, v70, v71
v_cvt_pk_bf16_f32 v30, v76, v77
v_cvt_pk_bf16_f32 v31, v78, v79
s_add_u32 s44, s44, 16384
s_addc_u32 s45, s45, 0
global_store_dwordx4 v7, v[24:27], s[44:45] offset:0 sc1
global_store_dwordx4 v7, v[28:31], s[44:45] offset:64 sc1
s_lshl_b32 s34, s17, 7
s_add_u32 s34, s34, 32768
s_add_u32 s42, s4, s34
s_addc_u32 s43, s5, 0
s_waitcnt vmcnt(0)
s_barrier
s_cmp_lg_u32 s11, 0
s_cbranch_scc1 SG_51
v_mov_b32 v250, 0
v_mov_b32 v251, 1
s_mov_b64 exec, 1
global_atomic_add v250, v251, s[42:43] offset:0
s_mov_b64 exec, -1
SG_51:
s_add_u32 s17, s17, 4
s_cmp_lt_u32 s17, 64
s_cbranch_scc1 A_loop
s_branch L_end
L_notA:
s_cmp_ge_u32 s12, 152
s_cbranch_scc1 L_notC
s_sub_u32 s34, s12, 64
s_mul_i32 s35, s34, 0x1746
s_lshr_b32 s36, s35, 16
s_mul_i32 s35, s36, 11
s_sub_u32 s14, s34, s35
s_and_b32 s16, s36, 1
s_lshr_b32 s15, s36, 1
s_load_dwordx4 s[40:43], s[0:1], 64
s_load_dwordx2 s[44:45], s[0:1], 80
v_lshrrev_b32 v204, 4, v0
v_and_b32 v200, 15, v0
v_lshlrev_b32 v201, 1, v204
v_xor_b32 v200, v200, v201
v_lshlrev_b32 v200, 4, v200
v_xor_b32 v201, 128, v200
s_mov_b32 s34, 2752
v_mul_lo_u32 v204, v204, s34
s_mul_i32 s34, s11, 44032
v_add_u32 v204, s34, v204
v_add_u32 v200, v200, v204
v_add_u32 v201, v201, v204
v_lshrrev_b32 v204, 4, v0
v_bfe_u32 v205, v0, 2, 2
v_lshlrev_b32 v202, 3, v204
v_add_u32 v202, v202, v205
v_lshlrev_b32 v205, 1, v205
v_and_b32 v204, 1, v204
v_lshlrev_b32 v204, 3, v204
v_add_u32 v205, v205, v204
v_lshlrev_b32 v202, 8, v202
v_and_b32 v204, 3, v0
v_lshrrev_b32 v203, 1, v204
v_xor_b32 v205, v205, v203
v_lshlrev_b32 v205, 4, v205
v_add_u32 v202, v202, v205
v_and_b32 v204, 1, v204
v_lshlrev_b32 v204, 3, v204
v_add_u32 v202, v202, v204
s_cmp_lg_u32 s14, 10
s_cbranch_scc1 Cnc_52
v_lshrrev_b32 v214, 4, v0
v_lshlrev_b32 v214, 1, v214
v_and_b32 v215, 15, v0
v_xor_b32 v214, v214, v215
v_cmp_le_u32 vcc, 12, v214
v_lshlrev_b32 v214, 4, v214
v_sub_u32 v214, v200, v214
v_cndmask_b32 v200, v200, v214, vcc
v_lshrrev_b32 v214, 4, v0
v_lshlrev_b32 v214, 1, v214
v_and_b32 v215, 15, v0
v_xor_b32 v214, v214, v215
v_xor_b32 v214, 8, v214
v_cmp_le_u32 vcc, 12, v214
v_lshlrev_b32 v214, 4, v214
v_sub_u32 v214, v201, v214
v_cndmask_b32 v201, v201, v214, vcc
Cnc_52:
s_lshl_b32 s34, s11, 6
v_xor_b32 v210, s34, v202
v_xor_b32 v211, 32, v210
v_add_u32 v212, 0x10000, v210
v_add_u32 v213, 0x10000, v211
s_waitcnt lgkmcnt(0)
s_lshl_b32 s34, s14, 8
s_add_u32 s40, s40, s34
s_addc_u32 s41, s41, 0
s_add_u32 s36, s40, 0
s_addc_u32 s37, s41, 0
s_lshl_b32 s34, s11, 12
s_add_u32 m0, s34, 0
s_nop 0
global_load_lds_dwordx4 v200, s[36:37]
s_add_u32 s36, s40, 11008
s_addc_u32 s37, s41, 0
s_lshl_b32 s34, s11, 12
s_add_u32 m0, s34, 1024
s_nop 0
global_load_lds_dwordx4 v200, s[36:37]
s_add_u32 s36, s40, 22016
s_addc_u32 s37, s41, 0
s_lshl_b32 s34, s11, 12
s_add_u32 m0, s34, 2048
s_nop 0
global_load_lds_dwordx4 v201, s[36:37]
s_add_u32 s36, s40, 33024
s_addc_u32 s37, s41, 0
s_lshl_b32 s34, s11, 12
s_add_u32 m0, s34, 3072
s_nop 0
global_load_lds_dwordx4 v201, s[36:37]
s_add_u32 s36, s40, 176128
s_addc_u32 s37, s41, 0
s_lshl_b32 s34, s11, 12
s_add_u32 m0, s34, 16384
s_nop 0
global_load_lds_dwordx4 v200, s[36:37]
s_add_u32 s36, s40, 187136
s_addc_u32 s37, s41, 0
s_lshl_b32 s34, s11, 12
s_add_u32 m0, s34, 17408
s_nop 0
global_load_lds_dwordx4 v200, s[36:37]
s_add_u32 s36, s40, 198144
s_addc_u32 s37, s41, 0
s_lshl_b32 s34, s11, 12
s_add_u32 m0, s34, 18432
s_nop 0
global_load_lds_dwordx4 v201, s[36:37]
s_add_u32 s36, s40, 209152
s_addc_u32 s37, s41, 0
s_lshl_b32 s34, s11, 12
s_add_u32 m0, s34, 19456
s_nop 0
global_load_lds_dwordx4 v201, s[36:37]
s_add_u32 s36, s40, 352256
s_addc_u32 s37, s41, 0
s_lshl_b32 s34, s11, 12
s_add_u32 m0, s34, 32768
s_nop 0
global_load_lds_dwordx4 v200, s[36:37]
s_add_u32 s36, s40, 363264
s_addc_u32 s37, s41, 0
s_lshl_b32 s34, s11, 12
s_add_u32 m0, s34, 33792
s_nop 0
global_load_lds_dwordx4 v200, s[36:37]
s_add_u32 s36, s40, 374272
s_addc_u32 s37, s41, 0
s_lshl_b32 s34, s11, 12
s_add_u32 m0, s34, 34816
s_nop 0
global_load_lds_dwordx4 v201, s[36:37]
s_add_u32 s36, s40, 385280
s_addc_u32 s37, s41, 0
s_lshl_b32 s34, s11, 12
s_add_u32 m0, s34, 35840
s_nop 0
global_load_lds_dwordx4 v201, s[36:37]
s_add_u32 s36, s40, 528384
s_addc_u32 s37, s41, 0
s_lshl_b32 s34, s11, 12
s_add_u32 m0, s34, 49152
s_nop 0
global_load_lds_dwordx4 v200, s[36:37]
s_add_u32 s36, s40, 539392
s_addc_u32 s37, s41, 0
s_lshl_b32 s34, s11, 12
s_add_u32 m0, s34, 50176
s_nop 0
global_load_lds_dwordx4 v200, s[36:37]
s_add_u32 s36, s40, 550400
s_addc_u32 s37, s41, 0
s_lshl_b32 s34, s11, 12
s_add_u32 m0, s34, 51200
s_nop 0
global_load_lds_dwordx4 v201, s[36:37]
s_add_u32 s36, s40, 561408
s_addc_u32 s37, s41, 0
s_lshl_b32 s34, s11, 12
s_add_u32 m0, s34, 52224
s_nop 0
global_load_lds_dwordx4 v201, s[36:37]
s_add_u32 s36, s40, 704512
s_addc_u32 s37, s41, 0
s_lshl_b32 s34, s11, 12
s_add_u32 m0, s34, 65536
s_nop 0
global_load_lds_dwordx4 v200, s[36:37]
s_add_u32 s36, s40, 715520
s_addc_u32 s37, s41, 0
s_lshl_b32 s34, s11, 12
s_add_u32 m0, s34, 66560
s_nop 0
global_load_lds_dwordx4 v200, s[36:37]
s_add_u32 s36, s40, 726528
s_addc_u32 s37, s41, 0
s_lshl_b32 s34, s11, 12
s_add_u32 m0, s34, 67584
s_nop 0
global_load_lds_dwordx4 v201, s[36:37]
s_add_u32 s36, s40, 737536
s_addc_u32 s37, s41, 0
s_lshl_b32 s34, s11, 12
s_add_u32 m0, s34, 68608
s_nop 0
global_load_lds_dwordx4 v201, s[36:37]
s_add_u32 s36, s40, 880640
s_addc_u32 s37, s41, 0
s_lshl_b32 s34, s11, 12
s_add_u32 m0, s34, 81920
s_nop 0
global_load_lds_dwordx4 v200, s[36:37]
s_add_u32 s36, s40, 891648
s_addc_u32 s37, s41, 0
s_lshl_b32 s34, s11, 12
s_add_u32 m0, s34, 82944
s_nop 0
global_load_lds_dwordx4 v200, s[36:37]
s_add_u32 s36, s40, 902656
s_addc_u32 s37, s41, 0
s_lshl_b32 s34, s11, 12
s_add_u32 m0, s34, 83968
s_nop 0
global_load_lds_dwordx4 v201, s[36:37]
s_add_u32 s36, s40, 913664
s_addc_u32 s37, s41, 0
s_lshl_b32 s34, s11, 12
s_add_u32 m0, s34, 84992
s_nop 0
global_load_lds_dwordx4 v201, s[36:37]
s_add_u32 s36, s40, 1056768
s_addc_u32 s37, s41, 0
s_lshl_b32 s34, s11, 12
s_add_u32 m0, s34, 98304
s_nop 0
global_load_lds_dwordx4 v200, s[36:37]
s_add_u32 s36, s40, 1067776
s_addc_u32 s37, s41, 0
s_lshl_b32 s34, s11, 12
s_add_u32 m0, s34, 99328
s_nop 0
global_load_lds_dwordx4 v200, s[36:37]
s_add_u32 s36, s40, 1078784
s_addc_u32 s37, s41, 0
s_lshl_b32 s34, s11, 12
s_add_u32 m0, s34, 100352
s_nop 0
global_load_lds_dwordx4 v201, s[36:37]
s_add_u32 s36, s40, 1089792
s_addc_u32 s37, s41, 0
s_lshl_b32 s34, s11, 12
s_add_u32 m0, s34, 101376
s_nop 0
global_load_lds_dwordx4 v201, s[36:37]
s_add_u32 s36, s40, 1232896
s_addc_u32 s37, s41, 0
s_lshl_b32 s34, s11, 12
s_add_u32 m0, s34, 114688
s_nop 0
global_load_lds_dwordx4 v200, s[36:37]
s_add_u32 s36, s40, 1243904
s_addc_u32 s37, s41, 0
s_lshl_b32 s34, s11, 12
s_add_u32 m0, s34, 115712
s_nop 0
global_load_lds_dwordx4 v200, s[36:37]
s_add_u32 s36, s40, 1254912
s_addc_u32 s37, s41, 0
s_lshl_b32 s34, s11, 12
s_add_u32 m0, s34, 116736
s_nop 0
global_load_lds_dwordx4 v201, s[36:37]
s_add_u32 s36, s40, 1265920
s_addc_u32 s37, s41, 0
s_lshl_b32 s34, s11, 12
s_add_u32 m0, s34, 117760
s_nop 0
global_load_lds_dwordx4 v201, s[36:37]
s_waitcnt vmcnt(28)
s_barrier
ds_read_b64_tr_b16 a[0:1], v210 offset:0
ds_read_b64_tr_b16 a[2:3], v210 offset:1024
ds_read_b64_tr_b16 a[4:5], v210 offset:8192
ds_read_b64_tr_b16 a[6:7], v210 offset:9216
ds_read_b64_tr_b16 a[64:65], v211 offset:0
ds_read_b64_tr_b16 a[66:67], v211 offset:1024
ds_read_b64_tr_b16 a[68:69], v211 offset:8192
ds_read_b64_tr_b16 a[70:71], v211 offset:9216
s_waitcnt lgkmcnt(0)
s_waitcnt vmcnt(24)
s_barrier
ds_read_b64_tr_b16 a[8:9], v210 offset:16384
ds_read_b64_tr_b16 a[10:11], v210 offset:17408
ds_read_b64_tr_b16 a[12:13], v210 offset:24576
ds_read_b64_tr_b16 a[14:15], v210 offset:25600
ds_read_b64_tr_b16 a[72:73], v211 offset:16384
ds_read_b64_tr_b16 a[74:75], v211 offset:17408
ds_read_b64_tr_b16 a[76:77], v211 offset:24576
ds_read_b64_tr_b16 a[78:79], v211 offset:25600
s_waitcnt lgkmcnt(0)
s_waitcnt vmcnt(20)
s_barrier
ds_read_b64_tr_b16 a[16:17], v210 offset:32768
ds_read_b64_tr_b16 a[18:19], v210 offset:33792
ds_read_b64_tr_b16 a[20:21], v210 offset:40960
ds_read_b64_tr_b16 a[22:23], v210 offset:41984
ds_read_b64_tr_b16 a[80:81], v211 offset:32768
ds_read_b64_tr_b16 a[82:83], v211 offset:33792
ds_read_b64_tr_b16 a[84:85], v211 offset:40960
ds_read_b64_tr_b16 a[86:87], v211 offset:41984
s_waitcnt lgkmcnt(0)
s_waitcnt vmcnt(16)
s_barrier
ds_read_b64_tr_b16 a[24:25], v210 offset:49152
ds_read_b64_tr_b16 a[26:27], v210 offset:50176
ds_read_b64_tr_b16 a[28:29], v210 offset:57344
ds_read_b64_tr_b16 a[30:31], v210 offset:58368
ds_read_b64_tr_b16 a[88:89], v211 offset:49152
ds_read_b64_tr_b16 a[90:91], v211 offset:50176
ds_read_b64_tr_b16 a[92:93], v211 offset:57344
ds_read_b64_tr_b16 a[94:95], v211 offset:58368
s_waitcnt lgkmcnt(0)
s_waitcnt vmcnt(12)
s_barrier
ds_read_b64_tr_b16 a[32:33], v212 offset:0
ds_read_b64_tr_b16 a[34:35], v212 offset:1024
ds_read_b64_tr_b16 a[36:37], v212 offset:8192
ds_read_b64_tr_b16 a[38:39], v212 offset:9216
ds_read_b64_tr_b16 a[96:97], v213 offset:0
ds_read_b64_tr_b16 a[98:99], v213 offset:1024
ds_read_b64_tr_b16 a[100:101], v213 offset:8192
ds_read_b64_tr_b16 a[102:103], v213 offset:9216
s_waitcnt lgkmcnt(0)
s_waitcnt vmcnt(8)
s_barrier
ds_read_b64_tr_b16 a[40:41], v212 offset:16384
ds_read_b64_tr_b16 a[42:43], v212 offset:17408
ds_read_b64_tr_b16 a[44:45], v212 offset:24576
ds_read_b64_tr_b16 a[46:47], v212 offset:25600
ds_read_b64_tr_b16 a[104:105], v213 offset:16384
ds_read_b64_tr_b16 a[106:107], v213 offset:17408
ds_read_b64_tr_b16 a[108:109], v213 offset:24576
ds_read_b64_tr_b16 a[110:111], v213 offset:25600
s_waitcnt lgkmcnt(0)
s_waitcnt vmcnt(4)
s_barrier
ds_read_b64_tr_b16 a[48:49], v212 offset:32768
ds_read_b64_tr_b16 a[50:51], v212 offset:33792
ds_read_b64_tr_b16 a[52:53], v212 offset:40960
ds_read_b64_tr_b16 a[54:55], v212 offset:41984
ds_read_b64_tr_b16 a[112:113], v213 offset:32768
ds_read_b64_tr_b16 a[114:115], v213 offset:33792
ds_read_b64_tr_b16 a[116:117], v213 offset:40960
ds_read_b64_tr_b16 a[118:119], v213 offset:41984
s_waitcnt lgkmcnt(0)
s_waitcnt vmcnt(0)
s_barrier
ds_read_b64_tr_b16 a[56:57], v212 offset:49152
ds_read_b64_tr_b16 a[58:59], v212 offset:50176
ds_read_b64_tr_b16 a[60:61], v212 offset:57344
ds_read_b64_tr_b16 a[62:63], v212 offset:58368
ds_read_b64_tr_b16 a[120:121], v213 offset:49152
ds_read_b64_tr_b16 a[122:123], v213 offset:50176
ds_read_b64_tr_b16 a[124:125], v213 offset:57344
ds_read_b64_tr_b16 a[126:127], v213 offset:58368
s_waitcnt lgkmcnt(0)
s_barrier
v_lshrrev_b32 v204, 4, v0
v_and_b32 v200, 15, v0
v_lshlrev_b32 v201, 1, v204
v_xor_b32 v200, v200, v201
v_lshlrev_b32 v200, 4, v200
v_xor_b32 v201, 128, v200
s_mov_b32 s34, 1024
v_mul_lo_u32 v204, v204, s34
s_mul_i32 s34, s11, 16384
v_add_u32 v204, s34, v204
v_add_u32 v200, v200, v204
v_add_u32 v201, v201, v204
v_lshrrev_b32 v204, 4, v0
v_bfe_u32 v205, v0, 2, 2
v_lshlrev_b32 v202, 2, v204
v_add_u32 v202, v202, v205
v_lshlrev_b32 v205, 1, v205
v_lshrrev_b32 v204, 1, v204
v_lshlrev_b32 v204, 3, v204
v_add_u32 v205, v205, v204
v_lshlrev_b32 v202, 8, v202
v_and_b32 v204, 3, v0
v_xor_b32 v205, v205, v204
v_lshlrev_b32 v205, 4, v205
v_add_u32 v202, v202, v205
s_lshl_b32 s34, s14, 17
s_add_u32 s44, s44, s34
s_addc_u32 s45, s45, 0
s_cmp_eq_u32 s14, 10
s_cselect_b32 s34, 1, 0
s_cmp_ge_u32 s11, 2
s_cselect_b32 s35, s34, 0
s_lshl_b32 s35, s35, 15
s_add_u32 s46, s44, 0
s_addc_u32 s47, s45, 0
s_add_u32 s36, s46, 0
s_addc_u32 s37, s47, 0
s_lshl_b32 s34, s11, 12
s_add_u32 m0, s34, 0
s_nop 0
global_load_lds_dwordx4 v200, s[36:37]
s_add_u32 s36, s46, 4096
s_addc_u32 s37, s47, 0
s_lshl_b32 s34, s11, 12
s_add_u32 m0, s34, 1024
s_nop 0
global_load_lds_dwordx4 v200, s[36:37]
s_add_u32 s36, s46, 8192
s_addc_u32 s37, s47, 0
s_lshl_b32 s34, s11, 12
s_add_u32 m0, s34, 2048
s_nop 0
global_load_lds_dwordx4 v201, s[36:37]
s_add_u32 s36, s46, 12288
s_addc_u32 s37, s47, 0
s_lshl_b32 s34, s11, 12
s_add_u32 m0, s34, 3072
s_nop 0
global_load_lds_dwordx4 v201, s[36:37]
s_add_u32 s46, s44, 256
s_addc_u32 s47, s45, 0
s_add_u32 s36, s46, 0
s_addc_u32 s37, s47, 0
s_lshl_b32 s34, s11, 12
s_add_u32 m0, s34, 16384
s_nop 0
global_load_lds_dwordx4 v200, s[36:37]
s_add_u32 s36, s46, 4096
s_addc_u32 s37, s47, 0
s_lshl_b32 s34, s11, 12
s_add_u32 m0, s34, 17408
s_nop 0
global_load_lds_dwordx4 v200, s[36:37]
s_add_u32 s36, s46, 8192
s_addc_u32 s37, s47, 0
s_lshl_b32 s34, s11, 12
s_add_u32 m0, s34, 18432
s_nop 0
global_load_lds_dwordx4 v201, s[36:37]
s_add_u32 s36, s46, 12288
s_addc_u32 s37, s47, 0
s_lshl_b32 s34, s11, 12
s_add_u32 m0, s34, 19456
s_nop 0
global_load_lds_dwordx4 v201, s[36:37]
s_add_u32 s46, s44, 512
s_addc_u32 s47, s45, 0
s_add_u32 s36, s46, 0
s_addc_u32 s37, s47, 0
s_lshl_b32 s34, s11, 12
s_add_u32 m0, s34, 32768
s_nop 0
global_load_lds_dwordx4 v200, s[36:37]
s_add_u32 s36, s46, 4096
s_addc_u32 s37, s47, 0
s_lshl_b32 s34, s11, 12
s_add_u32 m0, s34, 33792
s_nop 0
global_load_lds_dwordx4 v200, s[36:37]
s_add_u32 s36, s46, 8192
s_addc_u32 s37, s47, 0
s_lshl_b32 s34, s11, 12
s_add_u32 m0, s34, 34816
s_nop 0
global_load_lds_dwordx4 v201, s[36:37]
s_add_u32 s36, s46, 12288
s_addc_u32 s37, s47, 0
s_lshl_b32 s34, s11, 12
s_add_u32 m0, s34, 35840
s_nop 0
global_load_lds_dwordx4 v201, s[36:37]
s_add_u32 s46, s44, 768
s_addc_u32 s47, s45, 0
s_add_u32 s36, s46, 0
s_addc_u32 s37, s47, 0
s_lshl_b32 s34, s11, 12
s_add_u32 m0, s34, 49152
s_nop 0
global_load_lds_dwordx4 v200, s[36:37]
s_add_u32 s36, s46, 4096
s_addc_u32 s37, s47, 0
s_lshl_b32 s34, s11, 12
s_add_u32 m0, s34, 50176
s_nop 0
global_load_lds_dwordx4 v200, s[36:37]
s_add_u32 s36, s46, 8192
s_addc_u32 s37, s47, 0
s_lshl_b32 s34, s11, 12
s_add_u32 m0, s34, 51200
s_nop 0
global_load_lds_dwordx4 v201, s[36:37]
s_add_u32 s36, s46, 12288
s_addc_u32 s37, s47, 0
s_lshl_b32 s34, s11, 12
s_add_u32 m0, s34, 52224
s_nop 0
global_load_lds_dwordx4 v201, s[36:37]
s_add_u32 s46, s44, 0
s_addc_u32 s47, s45, 0
s_sub_u32 s46, s46, s35
s_subb_u32 s47, s47, 0
s_add_u32 s36, s46, 65536
s_addc_u32 s37, s47, 0
s_lshl_b32 s34, s11, 12
s_add_u32 m0, s34, 65536
s_nop 0
global_load_lds_dwordx4 v200, s[36:37]
s_add_u32 s36, s46, 69632
s_addc_u32 s37, s47, 0
s_lshl_b32 s34, s11, 12
s_add_u32 m0, s34, 66560
s_nop 0
global_load_lds_dwordx4 v200, s[36:37]
s_add_u32 s36, s46, 73728
s_addc_u32 s37, s47, 0
s_lshl_b32 s34, s11, 12
s_add_u32 m0, s34, 67584
s_nop 0
global_load_lds_dwordx4 v201, s[36:37]
s_add_u32 s36, s46, 77824
s_addc_u32 s37, s47, 0
s_lshl_b32 s34, s11, 12
s_add_u32 m0, s34, 68608
s_nop 0
global_load_lds_dwordx4 v201, s[36:37]
s_add_u32 s46, s44, 256
s_addc_u32 s47, s45, 0
s_sub_u32 s46, s46, s35
s_subb_u32 s47, s47, 0
s_add_u32 s36, s46, 65536
s_addc_u32 s37, s47, 0
s_lshl_b32 s34, s11, 12
s_add_u32 m0, s34, 81920
s_nop 0
global_load_lds_dwordx4 v200, s[36:37]
s_add_u32 s36, s46, 69632
s_addc_u32 s37, s47, 0
s_lshl_b32 s34, s11, 12
s_add_u32 m0, s34, 82944
s_nop 0
global_load_lds_dwordx4 v200, s[36:37]
s_add_u32 s36, s46, 73728
s_addc_u32 s37, s47, 0
s_lshl_b32 s34, s11, 12
s_add_u32 m0, s34, 83968
s_nop 0
global_load_lds_dwordx4 v201, s[36:37]
s_add_u32 s36, s46, 77824
s_addc_u32 s37, s47, 0
s_lshl_b32 s34, s11, 12
s_add_u32 m0, s34, 84992
s_nop 0
global_load_lds_dwordx4 v201, s[36:37]
s_add_u32 s46, s44, 512
s_addc_u32 s47, s45, 0
s_sub_u32 s46, s46, s35
s_subb_u32 s47, s47, 0
s_add_u32 s36, s46, 65536
s_addc_u32 s37, s47, 0
s_lshl_b32 s34, s11, 12
s_add_u32 m0, s34, 98304
s_nop 0
global_load_lds_dwordx4 v200, s[36:37]
s_add_u32 s36, s46, 69632
s_addc_u32 s37, s47, 0
s_lshl_b32 s34, s11, 12
s_add_u32 m0, s34, 99328
s_nop 0
global_load_lds_dwordx4 v200, s[36:37]
s_add_u32 s36, s46, 73728
s_addc_u32 s37, s47, 0
s_lshl_b32 s34, s11, 12
s_add_u32 m0, s34, 100352
s_nop 0
global_load_lds_dwordx4 v201, s[36:37]
s_add_u32 s36, s46, 77824
s_addc_u32 s37, s47, 0
s_lshl_b32 s34, s11, 12
s_add_u32 m0, s34, 101376
s_nop 0
global_load_lds_dwordx4 v201, s[36:37]
s_add_u32 s46, s44, 768
s_addc_u32 s47, s45, 0
s_sub_u32 s46, s46, s35
s_subb_u32 s47, s47, 0
s_add_u32 s36, s46, 65536
s_addc_u32 s37, s47, 0
s_lshl_b32 s34, s11, 12
s_add_u32 m0, s34, 114688
s_nop 0
global_load_lds_dwordx4 v200, s[36:37]
s_add_u32 s36, s46, 69632
s_addc_u32 s37, s47, 0
s_lshl_b32 s34, s11, 12
s_add_u32 m0, s34, 115712
s_nop 0
global_load_lds_dwordx4 v200, s[36:37]
s_add_u32 s36, s46, 73728
s_addc_u32 s37, s47, 0
s_lshl_b32 s34, s11, 12
s_add_u32 m0, s34, 116736
s_nop 0
global_load_lds_dwordx4 v201, s[36:37]
s_add_u32 s36, s46, 77824
s_addc_u32 s37, s47, 0
s_lshl_b32 s34, s11, 12
s_add_u32 m0, s34, 117760
s_nop 0
global_load_lds_dwordx4 v201, s[36:37]
s_lshl_b32 s34, s11, 14
v_add_u32 v210, s34, v202
s_waitcnt vmcnt(0)
s_barrier
v_xor_b32 v211, 0, v210
ds_read_b64_tr_b16 a[128:129], v211 offset:0
ds_read_b64_tr_b16 a[130:131], v211 offset:4096
ds_read_b64_tr_b16 a[132:133], v211 offset:8
ds_read_b64_tr_b16 a[134:135], v211 offset:4104
ds_read_b64_tr_b16 a[160:161], v211 offset:8192
ds_read_b64_tr_b16 a[162:163], v211 offset:12288
ds_read_b64_tr_b16 a[164:165], v211 offset:8200
ds_read_b64_tr_b16 a[166:167], v211 offset:12296
v_xor_b32 v211, 64, v210
ds_read_b64_tr_b16 a[136:137], v211 offset:0
ds_read_b64_tr_b16 a[138:139], v211 offset:4096
ds_read_b64_tr_b16 a[140:141], v211 offset:8
ds_read_b64_tr_b16 a[142:143], v211 offset:4104
ds_read_b64_tr_b16 a[168:169], v211 offset:8192
ds_read_b64_tr_b16 a[170:171], v211 offset:12288
ds_read_b64_tr_b16 a[172:173], v211 offset:8200
ds_read_b64_tr_b16 a[174:175], v211 offset:12296
v_xor_b32 v211, 128, v210
ds_read_b64_tr_b16 a[144:145], v211 offset:0
ds_read_b64_tr_b16 a[146:147], v211 offset:4096
ds_read_b64_tr_b16 a[148:149], v211 offset:8
ds_read_b64_tr_b16 a[150:151], v211 offset:4104
ds_read_b64_tr_b16 a[176:177], v211 offset:8192
ds_read_b64_tr_b16 a[178:179], v211 offset:12288
ds_read_b64_tr_b16 a[180:181], v211 offset:8200
ds_read_b64_tr_b16 a[182:183], v211 offset:12296
v_xor_b32 v211, 192, v210
ds_read_b64_tr_b16 a[152:153], v211 offset:0
ds_read_b64_tr_b16 a[154:155], v211 offset:4096
ds_read_b64_tr_b16 a[156:157], v211 offset:8
ds_read_b64_tr_b16 a[158:159], v211 offset:4104
ds_read_b64_tr_b16 a[184:185], v211 offset:8192
ds_read_b64_tr_b16 a[186:187], v211 offset:12288
ds_read_b64_tr_b16 a[188:189], v211 offset:8200
ds_read_b64_tr_b16 a[190:191], v211 offset:12296
v_xor_b32 v211, 0, v210
v_add_u32 v211, 65536, v211
ds_read_b64_tr_b16 a[192:193], v211 offset:0
ds_read_b64_tr_b16 a[194:195], v211 offset:4096
ds_read_b64_tr_b16 a[196:197], v211 offset:8
ds_read_b64_tr_b16 a[198:199], v211 offset:4104
ds_read_b64_tr_b16 a[224:225], v211 offset:8192
ds_read_b64_tr_b16 a[226:227], v211 offset:12288
ds_read_b64_tr_b16 a[228:229], v211 offset:8200
ds_read_b64_tr_b16 a[230:231], v211 offset:12296
v_xor_b32 v211, 64, v210
v_add_u32 v211, 65536, v211
ds_read_b64_tr_b16 a[200:201], v211 offset:0
ds_read_b64_tr_b16 a[202:203], v211 offset:4096
ds_read_b64_tr_b16 a[204:205], v211 offset:8
ds_read_b64_tr_b16 a[206:207], v211 offset:4104
ds_read_b64_tr_b16 a[232:233], v211 offset:8192
ds_read_b64_tr_b16 a[234:235], v211 offset:12288
ds_read_b64_tr_b16 a[236:237], v211 offset:8200
ds_read_b64_tr_b16 a[238:239], v211 offset:12296
v_xor_b32 v211, 128, v210
v_add_u32 v211, 65536, v211
ds_read_b64_tr_b16 a[208:209], v211 offset:0
ds_read_b64_tr_b16 a[210:211], v211 offset:4096
ds_read_b64_tr_b16 a[212:213], v211 offset:8
ds_read_b64_tr_b16 a[214:215], v211 offset:4104
ds_read_b64_tr_b16 a[240:241], v211 offset:8192
ds_read_b64_tr_b16 a[242:243], v211 offset:12288
ds_read_b64_tr_b16 a[244:245], v211 offset:8200
ds_read_b64_tr_b16 a[246:247], v211 offset:12296
v_xor_b32 v211, 192, v210
v_add_u32 v211, 65536, v211
ds_read_b64_tr_b16 a[216:217], v211 offset:0
ds_read_b64_tr_b16 a[218:219], v211 offset:4096
ds_read_b64_tr_b16 a[220:221], v211 offset:8
ds_read_b64_tr_b16 a[222:223], v211 offset:4104
ds_read_b64_tr_b16 a[248:249], v211 offset:8192
ds_read_b64_tr_b16 a[250:251], v211 offset:12288
ds_read_b64_tr_b16 a[252:253], v211 offset:8200
ds_read_b64_tr_b16 a[254:255], v211 offset:12296
s_waitcnt lgkmcnt(0)
s_barrier
v_lshrrev_b32 v3, 4, v0
v_and_b32 v4, 15, v0
v_lshlrev_b32 v5, 3, v3
s_lshl_b32 s34, s14, 8
s_lshl_b32 s35, s11, 6
s_add_u32 s34, s34, s35
v_add_u32 v5, s34, v5
v_min_u32 v6, 2744, v5
v_add_u32 v7, 32, v5
v_min_u32 v7, 2744, v7
global_load_dwordx2 v[24:25], v6, s[42:43]
global_load_dwordx2 v[26:27], v7, s[42:43]
s_waitcnt vmcnt(0)
v_lshlrev_b32 v16, 16, v24
v_and_b32 v17, 0xffff0000, v24
v_lshlrev_b32 v18, 16, v25
v_and_b32 v19, 0xffff0000, v25
v_lshlrev_b32 v20, 16, v26
v_and_b32 v21, 0xffff0000, v26
v_lshlrev_b32 v22, 16, v27
v_and_b32 v23, 0xffff0000, v27
s_cmp_lg_u32 s14, 10
s_cbranch_scc1 Cz_53
s_cmp_lg_u32 s11, 3
s_cbranch_scc1 Cz_53
v_accvgpr_write_b32 a0, 0
v_accvgpr_write_b32 a1, 0
v_accvgpr_write_b32 a2, 0
v_accvgpr_write_b32 a3, 0
v_accvgpr_write_b32 a4, 0
v_accvgpr_write_b32 a5, 0
v_accvgpr_write_b32 a6, 0
v_accvgpr_write_b32 a7, 0
v_accvgpr_write_b32 a8, 0
v_accvgpr_write_b32 a9, 0
v_accvgpr_write_b32 a10, 0
v_accvgpr_write_b32 a11, 0
v_accvgpr_write_b32 a12, 0
v_accvgpr_write_b32 a13, 0
v_accvgpr_write_b32 a14, 0
v_accvgpr_write_b32 a15, 0
v_accvgpr_write_b32 a16, 0
v_accvgpr_write_b32 a17, 0
v_accvgpr_write_b32 a18, 0
v_accvgpr_write_b32 a19, 0
v_accvgpr_write_b32 a20, 0
v_accvgpr_write_b32 a21, 0
v_accvgpr_write_b32 a22, 0
v_accvgpr_write_b32 a23, 0
v_accvgpr_write_b32 a24, 0
v_accvgpr_write_b32 a25, 0
v_accvgpr_write_b32 a26, 0
v_accvgpr_write_b32 a27, 0
v_accvgpr_write_b32 a28, 0
v_accvgpr_write_b32 a29, 0
v_accvgpr_write_b32 a30, 0
v_accvgpr_write_b32 a31, 0
v_accvgpr_write_b32 a32, 0
v_accvgpr_write_b32 a33, 0
v_accvgpr_write_b32 a34, 0
v_accvgpr_write_b32 a35, 0
v_accvgpr_write_b32 a36, 0
v_accvgpr_write_b32 a37, 0
v_accvgpr_write_b32 a38, 0
v_accvgpr_write_b32 a39, 0
v_accvgpr_write_b32 a40, 0
v_accvgpr_write_b32 a41, 0
v_accvgpr_write_b32 a42, 0
v_accvgpr_write_b32 a43, 0
v_accvgpr_write_b32 a44, 0
v_accvgpr_write_b32 a45, 0
v_accvgpr_write_b32 a46, 0
v_accvgpr_write_b32 a47, 0
v_accvgpr_write_b32 a48, 0
v_accvgpr_write_b32 a49, 0
v_accvgpr_write_b32 a50, 0
v_accvgpr_write_b32 a51, 0
v_accvgpr_write_b32 a52, 0
v_accvgpr_write_b32 a53, 0
v_accvgpr_write_b32 a54, 0
v_accvgpr_write_b32 a55, 0
v_accvgpr_write_b32 a56, 0
v_accvgpr_write_b32 a57, 0
v_accvgpr_write_b32 a58, 0
v_accvgpr_write_b32 a59, 0
v_accvgpr_write_b32 a60, 0
v_accvgpr_write_b32 a61, 0
v_accvgpr_write_b32 a62, 0
v_accvgpr_write_b32 a63, 0
v_accvgpr_write_b32 a64, 0
v_accvgpr_write_b32 a65, 0
v_accvgpr_write_b32 a66, 0
v_accvgpr_write_b32 a67, 0
v_accvgpr_write_b32 a68, 0
v_accvgpr_write_b32 a69, 0
v_accvgpr_write_b32 a70, 0
v_accvgpr_write_b32 a71, 0
v_accvgpr_write_b32 a72, 0
v_accvgpr_write_b32 a73, 0
v_accvgpr_write_b32 a74, 0
v_accvgpr_write_b32 a75, 0
v_accvgpr_write_b32 a76, 0
v_accvgpr_write_b32 a77, 0
v_accvgpr_write_b32 a78, 0
v_accvgpr_write_b32 a79, 0
v_accvgpr_write_b32 a80, 0
v_accvgpr_write_b32 a81, 0
v_accvgpr_write_b32 a82, 0
v_accvgpr_write_b32 a83, 0
v_accvgpr_write_b32 a84, 0
v_accvgpr_write_b32 a85, 0
v_accvgpr_write_b32 a86, 0
v_accvgpr_write_b32 a87, 0
v_accvgpr_write_b32 a88, 0
v_accvgpr_write_b32 a89, 0
v_accvgpr_write_b32 a90, 0
v_accvgpr_write_b32 a91, 0
v_accvgpr_write_b32 a92, 0
v_accvgpr_write_b32 a93, 0
v_accvgpr_write_b32 a94, 0
v_accvgpr_write_b32 a95, 0
v_accvgpr_write_b32 a96, 0
v_accvgpr_write_b32 a97, 0
v_accvgpr_write_b32 a98, 0
v_accvgpr_write_b32 a99, 0
v_accvgpr_write_b32 a100, 0
v_accvgpr_write_b32 a101, 0
v_accvgpr_write_b32 a102, 0
v_accvgpr_write_b32 a103, 0
v_accvgpr_write_b32 a104, 0
v_accvgpr_write_b32 a105, 0
v_accvgpr_write_b32 a106, 0
v_accvgpr_write_b32 a107, 0
v_accvgpr_write_b32 a108, 0
v_accvgpr_write_b32 a109, 0
v_accvgpr_write_b32 a110, 0
v_accvgpr_write_b32 a111, 0
v_accvgpr_write_b32 a112, 0
v_accvgpr_write_b32 a113, 0
v_accvgpr_write_b32 a114, 0
v_accvgpr_write_b32 a115, 0
v_accvgpr_write_b32 a116, 0
v_accvgpr_write_b32 a117, 0
v_accvgpr_write_b32 a118, 0
v_accvgpr_write_b32 a119, 0
v_accvgpr_write_b32 a120, 0
v_accvgpr_write_b32 a121, 0
v_accvgpr_write_b32 a122, 0
v_accvgpr_write_b32 a123, 0
v_accvgpr_write_b32 a124, 0
v_accvgpr_write_b32 a125, 0
v_accvgpr_write_b32 a126, 0
v_accvgpr_write_b32 a127, 0
v_mov_b32 v16, 0
v_mov_b32 v17, 0
v_mov_b32 v18, 0
v_mov_b32 v19, 0
v_mov_b32 v20, 0
v_mov_b32 v21, 0
v_mov_b32 v22, 0
v_mov_b32 v23, 0
Cz_53:
v_lshlrev_b32 v2, 4, v0
s_lshl_b32 s34, s11, 12
v_add_u32 v8, s34, v2
s_lshl_b32 s34, s11, 10
v_add_u32 v9, s34, v2
v_lshlrev_b32 v10, 10, v4
v_lshlrev_b32 v11, 4, v3
v_add_u32 v10, v10, v11
s_lshl_b32 s34, s11, 8
v_add_u32 v10, s34, v10
s_mov_b32 s28, 0x3d372713
s_mov_b32 s29, 0xc0135761
s_mov_b32 s17, s15
C_loop:
s_cmp_ge_u32 s17, 61
s_cbranch_scc1 GE_54
s_lshl_b32 s34, s17, 7
s_add_u32 s34, s34, 40960
s_lshl_b32 s35, s16, 13
s_add_u32 s34, s34, s35
s_mov_b32 s33, 4
s_branch GJ_55
GE_54:
s_lshl_b32 s34, s17, 7
s_add_u32 s34, s34, 32768
s_mov_b32 s33, 16
GJ_55:
s_add_u32 s42, s4, s34
s_addc_u32 s43, s5, 0
s_cmp_lg_u32 s11, 0
s_cbranch_scc1 W1_56
v_mov_b32 v250, 0
s_mov_b32 s96, 0
W_57:
global_load_dword v251, v250, s[42:43] offset:0 sc1
s_waitcnt vmcnt(0)
v_readfirstlane_b32 s97, v251
s_nop 0
s_cmp_ge_u32 s97, s33
s_cbranch_scc1 WE_58
s_sleep 16
s_add_u32 s96, s96, 1
s_cmp_lt_u32 s96, 200000
s_cbranch_scc1 W_57
WE_58:
W1_56:
s_barrier
s_cmp_lt_u32 s17, 61
s_cbranch_scc1 GS_59
s_sleep 34
GS_59:
s_lshl_b32 s34, s17, 15
s_lshl_b32 s35, s16, 14
s_add_u32 s34, s34, s35
s_add_u32 s34, s34, 6291456
s_add_u32 s46, s4, s34
s_addc_u32 s47, s5, 0
v_mov_b32 v32, v16
v_mov_b32 v33, v17
v_mov_b32 v34, v18
v_mov_b32 v35, v19
v_mov_b32 v36, v20
v_mov_b32 v37, v21
v_mov_b32 v38, v22
v_mov_b32 v39, v23
s_mov_b32 s96, 0
LV_60:
global_load_dwordx4 v[96:99], v8, s[46:47] offset:0 sc1
global_load_dwordx4 v[100:103], v8, s[46:47] offset:1024 sc1
global_load_dwordx4 v[104:107], v8, s[46:47] offset:2048 sc1
global_load_dwordx4 v[108:111], v8, s[46:47] offset:3072 sc1
s_waitcnt vmcnt(0)
v_max3_u32 v12, v96, v97, v98
v_max3_u32 v12, v12, v99, v100
v_max3_u32 v12, v12, v101, v102
v_max3_u32 v12, v12, v103, v104
v_max3_u32 v12, v12, v105, v106
v_max3_u32 v12, v12, v107, v108
v_max3_u32 v12, v12, v109, v110
v_max_u32 v12, v12, v111
v_cmp_eq_u32 vcc, -1, v12
s_cbranch_vccz LVE_61
s_sleep 4
s_add_u32 s96, s96, 1
s_cmp_lt_u32 s96, 20000
s_cbranch_scc1 LV_60
LVE_61:
ds_write_b128 v8, v[96:99] offset:0
ds_write_b128 v8, v[100:103] offset:1024
ds_write_b128 v8, v[104:107] offset:2048
ds_write_b128 v8, v[108:111] offset:3072
s_waitcnt lgkmcnt(0)
s_barrier
ds_read_b128 v[64:67], v2 offset:0
ds_read_b128 v[68:71], v2 offset:1024
ds_read_b128 v[72:75], v2 offset:2048
ds_read_b128 v[76:79], v2 offset:3072
ds_read_b128 v[80:83], v2 offset:4096
s_waitcnt lgkmcnt(4)
v_mfma_f32_16x16x32_bf16 v[32:35], a[0:3], v[64:67], v[32:35]
v_mfma_f32_16x16x32_bf16 v[36:39], a[64:67], v[64:67], v[36:39]
ds_read_b128 v[84:87], v2 offset:5120
s_waitcnt lgkmcnt(4)
v_mfma_f32_16x16x32_bf16 v[32:35], a[4:7], v[68:71], v[32:35]
v_mfma_f32_16x16x32_bf16 v[36:39], a[68:71], v[68:71], v[36:39]
ds_read_b128 v[88:91], v2 offset:6144
s_waitcnt lgkmcnt(4)
v_mfma_f32_16x16x32_bf16 v[32:35], a[8:11], v[72:75], v[32:35]
v_mfma_f32_16x16x32_bf16 v[36:39], a[72:75], v[72:75], v[36:39]
ds_read_b128 v[92:95], v2 offset:7168
s_waitcnt lgkmcnt(4)
v_mfma_f32_16x16x32_bf16 v[32:35], a[12:15], v[76:79], v[32:35]
v_mfma_f32_16x16x32_bf16 v[36:39], a[76:79], v[76:79], v[36:39]
ds_read_b128 v[64:67], v2 offset:8192
s_waitcnt lgkmcnt(4)
v_mfma_f32_16x16x32_bf16 v[32:35], a[16:19], v[80:83], v[32:35]
v_mfma_f32_16x16x32_bf16 v[36:39], a[80:83], v[80:83], v[36:39]
ds_read_b128 v[68:71], v2 offset:9216
s_waitcnt lgkmcnt(4)
v_mfma_f32_16x16x32_bf16 v[32:35], a[20:23], v[84:87], v[32:35]
v_mfma_f32_16x16x32_bf16 v[36:39], a[84:87], v[84:87], v[36:39]
ds_read_b128 v[72:75], v2 offset:10240
s_waitcnt lgkmcnt(4)
v_mfma_f32_16x16x32_bf16 v[32:35], a[24:27], v[88:91], v[32:35]
v_mfma_f32_16x16x32_bf16 v[36:39], a[88:91], v[88:91], v[36:39]
ds_read_b128 v[76:79], v2 offset:11264
s_waitcnt lgkmcnt(4)
v_mfma_f32_16x16x32_bf16 v[32:35], a[28:31], v[92:95], v[32:35]
v_mfma_f32_16x16x32_bf16 v[36:39], a[92:95], v[92:95], v[36:39]
ds_read_b128 v[80:83], v2 offset:12288
s_waitcnt lgkmcnt(4)
v_mfma_f32_16x16x32_bf16 v[32:35], a[32:35], v[64:67], v[32:35]
v_mfma_f32_16x16x32_bf16 v[36:39], a[96:99], v[64:67], v[36:39]
ds_read_b128 v[84:87], v2 offset:13312
s_waitcnt lgkmcnt(4)
v_mfma_f32_16x16x32_bf16 v[32:35], a[36:39], v[68:71], v[32:35]
v_mfma_f32_16x16x32_bf16 v[36:39], a[100:103], v[68:71], v[36:39]
ds_read_b128 v[88:91], v2 offset:14336
s_waitcnt lgkmcnt(4)
v_mfma_f32_16x16x32_bf16 v[32:35], a[40:43], v[72:75], v[32:35]
v_mfma_f32_16x16x32_bf16 v[36:39], a[104:107], v[72:75], v[36:39]
ds_read_b128 v[92:95], v2 offset:15360
s_waitcnt lgkmcnt(4)
v_mfma_f32_16x16x32_bf16 v[32:35], a[44:47], v[76:79], v[32:35]
v_mfma_f32_16x16x32_bf16 v[36:39], a[108:111], v[76:79], v[36:39]
s_waitcnt lgkmcnt(3)
v_mfma_f32_16x16x32_bf16 v[32:35], a[48:51], v[80:83], v[32:35]
v_mfma_f32_16x16x32_bf16 v[36:39], a[112:115], v[80:83], v[36:39]
s_waitcnt lgkmcnt(2)
v_mfma_f32_16x16x32_bf16 v[32:35], a[52:55], v[84:87], v[32:35]
v_mfma_f32_16x16x32_bf16 v[36:39], a[116:119], v[84:87], v[36:39]
s_waitcnt lgkmcnt(1)
v_mfma_f32_16x16x32_bf16 v[32:35], a[56:59], v[88:91], v[32:35]
v_mfma_f32_16x16x32_bf16 v[36:39], a[120:123], v[88:91], v[36:39]
s_waitcnt lgkmcnt(0)
v_mfma_f32_16x16x32_bf16 v[32:35], a[60:63], v[92:95], v[32:35]
v_mfma_f32_16x16x32_bf16 v[36:39], a[124:127], v[92:95], v[36:39]
s_nop 3
v_cvt_pk_bf16_f32 v12, v32, v33
v_lshlrev_b32 v32, 16, v12
v_and_b32 v33, 0xffff0000, v12
v_cvt_pk_bf16_f32 v12, v34, v35
v_lshlrev_b32 v34, 16, v12
v_and_b32 v35, 0xffff0000, v12
v_cvt_pk_bf16_f32 v12, v36, v37
v_lshlrev_b32 v36, 16, v12
v_and_b32 v37, 0xffff0000, v12
v_cvt_pk_bf16_f32 v12, v38, v39
v_lshlrev_b32 v38, 16, v12
v_and_b32 v39, 0xffff0000, v12
v_mul_f32 v48, v32, v32
v_mul_f32 v49, v33, v33
v_mul_f32 v50, v34, v34
v_mul_f32 v51, v35, v35
v_mul_f32 v52, v36, v36
v_mul_f32 v53, v37, v37
v_mul_f32 v54, v38, v38
v_mul_f32 v55, v39, v39
v_mul_f32 v48, s28, v48
v_mul_f32 v49, s28, v49
v_mul_f32 v50, s28, v50
v_mul_f32 v51, s28, v51
v_mul_f32 v52, s28, v52
v_mul_f32 v53, s28, v53
v_mul_f32 v54, s28, v54
v_mul_f32 v55, s28, v55
v_fma_f32 v48, v48, v32, v32
v_fma_f32 v49, v49, v33, v33
v_fma_f32 v50, v50, v34, v34
v_fma_f32 v51, v51, v35, v35
v_fma_f32 v52, v52, v36, v36
v_fma_f32 v53, v53, v37, v37
v_fma_f32 v54, v54, v38, v38
v_fma_f32 v55, v55, v39, v39
v_mul_f32 v48, s29, v48
v_mul_f32 v49, s29, v49
v_mul_f32 v50, s29, v50
v_mul_f32 v51, s29, v51
v_mul_f32 v52, s29, v52
v_mul_f32 v53, s29, v53
v_mul_f32 v54, s29, v54
v_mul_f32 v55, s29, v55
v_exp_f32 v48, v48
v_exp_f32 v49, v49
v_exp_f32 v50, v50
v_exp_f32 v51, v51
v_exp_f32 v52, v52
v_exp_f32 v53, v53
v_exp_f32 v54, v54
v_exp_f32 v55, v55
v_add_f32 v48, 1.0, v48
v_add_f32 v49, 1.0, v49
v_add_f32 v50, 1.0, v50
v_add_f32 v51, 1.0, v51
v_add_f32 v52, 1.0, v52
v_add_f32 v53, 1.0, v53
v_add_f32 v54, 1.0, v54
v_add_f32 v55, 1.0, v55
v_rcp_f32 v48, v48
v_rcp_f32 v49, v49
v_rcp_f32 v50, v50
v_rcp_f32 v51, v51
v_rcp_f32 v52, v52
v_rcp_f32 v53, v53
v_rcp_f32 v54, v54
v_rcp_f32 v55, v55
v_mul_f32 v32, v32, v48
v_mul_f32 v33, v33, v49
v_mul_f32 v34, v34, v50
v_mul_f32 v35, v35, v51
v_mul_f32 v36, v36, v52
v_mul_f32 v37, v37, v53
v_mul_f32 v38, v38, v54
v_mul_f32 v39, v39, v55
v_cvt_pk_bf16_f32 v24, v32, v33
v_cvt_pk_bf16_f32 v25, v34, v35
v_cvt_pk_bf16_f32 v26, v36, v37
v_cvt_pk_bf16_f32 v27, v38, v39
ds_write_b128 v9, v[24:27] offset:32768
s_waitcnt lgkmcnt(0)
s_barrier
ds_read_b128 v[96:99], v2 offset:32768
ds_read_b128 v[100:103], v2 offset:33792
ds_read_b128 v[104:107], v2 offset:34816
ds_read_b128 v[108:111], v2 offset:35840
s_waitcnt lgkmcnt(0)
v_mfma_f32_16x16x32_bf16 v[128:131], a[128:131], v[96:99], 0
v_mfma_f32_16x16x32_bf16 v[132:135], a[132:135], v[96:99], 0
v_mfma_f32_16x16x32_bf16 v[136:139], a[136:139], v[96:99], 0
v_mfma_f32_16x16x32_bf16 v[140:143], a[140:143], v[96:99], 0
v_mfma_f32_16x16x32_bf16 v[144:147], a[144:147], v[96:99], 0
v_mfma_f32_16x16x32_bf16 v[148:151], a[148:151], v[96:99], 0
v_mfma_f32_16x16x32_bf16 v[152:155], a[152:155], v[96:99], 0
v_mfma_f32_16x16x32_bf16 v[156:159], a[156:159], v[96:99], 0
v_mfma_f32_16x16x32_bf16 v[128:131], a[160:163], v[100:103], v[128:131]
v_mfma_f32_16x16x32_bf16 v[132:135], a[164:167], v[100:103], v[132:135]
v_mfma_f32_16x16x32_bf16 v[136:139], a[168:171], v[100:103], v[136:139]
v_mfma_f32_16x16x32_bf16 v[140:143], a[172:175], v[100:103], v[140:143]
v_mfma_f32_16x16x32_bf16 v[144:147], a[176:179], v[100:103], v[144:147]
v_mfma_f32_16x16x32_bf16 v[148:151], a[180:183], v[100:103], v[148:151]
v_mfma_f32_16x16x32_bf16 v[152:155], a[184:187], v[100:103], v[152:155]
v_mfma_f32_16x16x32_bf16 v[156:159], a[188:191], v[100:103], v[156:159]
v_mfma_f32_16x16x32_bf16 v[128:131], a[192:195], v[104:107], v[128:131]
v_mfma_f32_16x16x32_bf16 v[132:135], a[196:199], v[104:107], v[132:135]
v_mfma_f32_16x16x32_bf16 v[136:139], a[200:203], v[104:107], v[136:139]
v_mfma_f32_16x16x32_bf16 v[140:143], a[204:207], v[104:107], v[140:143]
v_mfma_f32_16x16x32_bf16 v[144:147], a[208:211], v[104:107], v[144:147]
v_mfma_f32_16x16x32_bf16 v[148:151], a[212:215], v[104:107], v[148:151]
v_mfma_f32_16x16x32_bf16 v[152:155], a[216:219], v[104:107], v[152:155]
v_mfma_f32_16x16x32_bf16 v[156:159], a[220:223], v[104:107], v[156:159]
v_mfma_f32_16x16x32_bf16 v[128:131], a[224:227], v[108:111], v[128:131]
v_mfma_f32_16x16x32_bf16 v[132:135], a[228:231], v[108:111], v[132:135]
v_mfma_f32_16x16x32_bf16 v[136:139], a[232:235], v[108:111], v[136:139]
v_mfma_f32_16x16x32_bf16 v[140:143], a[236:239], v[108:111], v[140:143]
v_mfma_f32_16x16x32_bf16 v[144:147], a[240:243], v[108:111], v[144:147]
v_mfma_f32_16x16x32_bf16 v[148:151], a[244:247], v[108:111], v[148:151]
v_mfma_f32_16x16x32_bf16 v[152:155], a[248:251], v[108:111], v[152:155]
v_mfma_f32_16x16x32_bf16 v[156:159], a[252:255], v[108:111], v[156:159]
s_mul_i32 s34, s17, 11
s_add_u32 s34, s34, s14
s_lshl_b32 s34, s34, 15
s_lshl_b32 s35, s16, 14
s_add_u32 s34, s34, s35
s_add_u32 s34, s34, 121634816
s_add_u32 s46, s4, s34
s_addc_u32 s47, s5, 0
v_cvt_pk_bf16_f32 v64, v128, v129
v_cvt_pk_bf16_f32 v65, v130, v131
v_cvt_pk_bf16_f32 v66, v132, v133
v_cvt_pk_bf16_f32 v67, v134, v135
global_store_dwordx4 v10, v[64:67], s[46:47] offset:0 sc1
v_cvt_pk_bf16_f32 v68, v136, v137
v_cvt_pk_bf16_f32 v69, v138, v139
v_cvt_pk_bf16_f32 v70, v140, v141
v_cvt_pk_bf16_f32 v71, v142, v143
global_store_dwordx4 v10, v[68:71], s[46:47] offset:64 sc1
v_cvt_pk_bf16_f32 v72, v144, v145
v_cvt_pk_bf16_f32 v73, v146, v147
v_cvt_pk_bf16_f32 v74, v148, v149
v_cvt_pk_bf16_f32 v75, v150, v151
global_store_dwordx4 v10, v[72:75], s[46:47] offset:128 sc1
v_cvt_pk_bf16_f32 v76, v152, v153
v_cvt_pk_bf16_f32 v77, v154, v155
v_cvt_pk_bf16_f32 v78, v156, v157
v_cvt_pk_bf16_f32 v79, v158, v159
global_store_dwordx4 v10, v[76:79], s[46:47] offset:192 sc1
s_lshl_b32 s34, s17, 7
s_add_u32 s34, s34, 57344
s_lshl_b32 s35, s16, 13
s_add_u32 s34, s34, s35
s_add_u32 s42, s4, s34
s_addc_u32 s43, s5, 0
s_waitcnt vmcnt(0)
s_barrier
s_cmp_lg_u32 s11, 0
s_cbranch_scc1 SG_62
v_mov_b32 v250, 0
v_mov_b32 v251, 1
s_mov_b64 exec, 1
global_atomic_add v250, v251, s[42:43] offset:0
s_mov_b64 exec, -1
SG_62:
s_add_u32 s17, s17, 4
s_cmp_lt_u32 s17, 64
s_cbranch_scc1 C_loop
s_branch L_end
L_notC:
s_cmp_ge_u32 s12, 216
s_cbranch_scc1 L_end
s_sub_u32 s34, s12, 152
s_and_b32 s14, s34, 7
s_lshr_b32 s15, s34, 3
s_load_dwordx2 s[40:41], s[0:1], 0
s_load_dwordx2 s[46:47], s[0:1], 88
s_load_dwordx2 s[48:49], s[0:1], 112
v_lshlrev_b32 v2, 4, v0
v_lshlrev_b32 v3, 5, v0
s_cmp_lg_u32 s11, 0
s_cbranch_scc1 W1_63
v_mov_b32 v250, 0
s_mov_b32 s96, 0
W_64:
global_load_dword v251, v250, s[6:7] offset:192 sc1
s_waitcnt vmcnt(0)
v_readfirstlane_b32 s97, v251
s_nop 0
s_cmp_ge_u32 s97, 32
s_cbranch_scc1 WE_65
s_sleep 8
s_add_u32 s96, s96, 1
s_cmp_lt_u32 s96, 200000
s_cbranch_scc1 W_64
WE_65:
W1_63:
s_barrier
s_add_u32 s42, s4, 135168
s_addc_u32 s43, s5, 0
s_add_u32 s44, s42, 0
s_addc_u32 s45, s43, 0
global_load_dwordx4 v[16:19], v3, s[44:45] sc1
global_load_dwordx4 v[20:23], v3, s[44:45] offset:16 sc1
s_add_u32 s44, s42, 2048
s_addc_u32 s45, s43, 0
global_load_dwordx4 v[24:27], v3, s[44:45] sc1
global_load_dwordx4 v[28:31], v3, s[44:45] offset:16 sc1
s_add_u32 s44, s42, 4096
s_addc_u32 s45, s43, 0
global_load_dwordx4 v[32:35], v3, s[44:45] sc1
global_load_dwordx4 v[36:39], v3, s[44:45] offset:16 sc1
s_add_u32 s44, s42, 6144
s_addc_u32 s45, s43, 0
global_load_dwordx4 v[40:43], v3, s[44:45] sc1
global_load_dwordx4 v[44:47], v3, s[44:45] offset:16 sc1
s_waitcnt lgkmcnt(0)
global_load_dwordx4 v[56:59], v2, s[46:47]
s_waitcnt vmcnt(0)
v_lshlrev_b32 v48, 16, v56
v_and_b32 v49, 0xffff0000, v56
v_lshlrev_b32 v50, 16, v57
v_and_b32 v51, 0xffff0000, v57
v_lshlrev_b32 v52, 16, v58
v_and_b32 v53, 0xffff0000, v58
v_lshlrev_b32 v54, 16, v59
v_and_b32 v55, 0xffff0000, v59
v_add_f32 v32, 1.0, v32
v_add_f32 v33, 1.0, v33
v_cvt_pk_bf16_f32 v60, v32, v33
v_lshlrev_b32 v32, 16, v60
v_and_b32 v33, 0xffff0000, v60
v_add_f32 v34, 1.0, v34
v_add_f32 v35, 1.0, v35
v_cvt_pk_bf16_f32 v60, v34, v35
v_lshlrev_b32 v34, 16, v60
v_and_b32 v35, 0xffff0000, v60
v_add_f32 v36, 1.0, v36
v_add_f32 v37, 1.0, v37
v_cvt_pk_bf16_f32 v60, v36, v37
v_lshlrev_b32 v36, 16, v60
v_and_b32 v37, 0xffff0000, v60
v_add_f32 v38, 1.0, v38
v_add_f32 v39, 1.0, v39
v_cvt_pk_bf16_f32 v60, v38, v39
v_lshlrev_b32 v38, 16, v60
v_and_b32 v39, 0xffff0000, v60
s_mov_b32 s21, 0x3727c5ac
s_lshl_b32 s18, s14, 2
s_add_u32 s18, s18, s11
s_lshr_b32 s20, s14, 2
v_lshrrev_b32 v4, 2, v0
v_lshlrev_b32 v4, 10, v4
v_and_b32 v5, 3, v0
v_lshlrev_b32 v5, 8, v5
v_add_u32 v4, v4, v5
s_mov_b32 s17, s15
R_loop:
s_cmp_ge_u32 s17, 61
s_cbranch_scc1 GE_66
s_lshl_b32 s34, s17, 7
s_add_u32 s34, s34, 32768
s_mov_b32 s33, 16
s_branch GJ_67
GE_66:
s_lshl_b32 s34, s17, 7
s_add_u32 s34, s34, 24576
s_mov_b32 s33, 559232
GJ_67:
s_add_u32 s42, s4, s34
s_addc_u32 s43, s5, 0
s_cmp_lg_u32 s11, 0
s_cbranch_scc1 W1_68
v_mov_b32 v250, 0
s_mov_b32 s96, 0
W_69:
global_load_dword v251, v250, s[42:43] offset:0 sc1
s_waitcnt vmcnt(0)
v_readfirstlane_b32 s97, v251
s_nop 0
s_cmp_ge_u32 s97, s33
s_cbranch_scc1 WE_70
s_sleep 16
s_add_u32 s96, s96, 1
s_cmp_lt_u32 s96, 200000
s_cbranch_scc1 W_69
WE_70:
W1_68:
s_barrier
s_cmp_lt_u32 s17, 61
s_cbranch_scc1 GS_71
s_sleep 66
GS_71:
s_lshl_b32 s34, s17, 18
s_add_u32 s19, s18, 0
s_lshl_b32 s19, s19, 10
s_add_u32 s34, s34, s19
s_add_u32 s34, s34, 104857600
s_add_u32 s50, s4, s34
s_addc_u32 s51, s5, 0
s_lshl_b32 s34, s17, 15
s_add_u32 s34, s34, s19
s_add_u32 s44, s40, s34
s_addc_u32 s45, s41, 0
global_load_dwordx4 v[128:131], v2, s[44:45]
s_mov_b32 s96, 0
LV_72:
s_mov_b32 s44, s50
s_mov_b32 s45, s51
global_load_dwordx4 v[96:99], v2, s[44:45] sc1
s_add_u32 s44, s44, 32768
s_addc_u32 s45, s45, 0
global_load_dwordx4 v[100:103], v2, s[44:45] sc1
s_add_u32 s44, s44, 32768
s_addc_u32 s45, s45, 0
global_load_dwordx4 v[104:107], v2, s[44:45] sc1
s_add_u32 s44, s44, 32768
s_addc_u32 s45, s45, 0
global_load_dwordx4 v[108:111], v2, s[44:45] sc1
s_add_u32 s44, s44, 32768
s_addc_u32 s45, s45, 0
global_load_dwordx4 v[112:115], v2, s[44:45] sc1
s_add_u32 s44, s44, 32768
s_addc_u32 s45, s45, 0
global_load_dwordx4 v[116:119], v2, s[44:45] sc1
s_add_u32 s44, s44, 32768
s_addc_u32 s45, s45, 0
global_load_dwordx4 v[120:123], v2, s[44:45] sc1
s_add_u32 s44, s44, 32768
s_addc_u32 s45, s45, 0
global_load_dwordx4 v[124:127], v2, s[44:45] sc1
s_add_u32 s44, s44, 32768
s_addc_u32 s45, s45, 0
s_waitcnt vmcnt(0)
v_max3_u32 v60, v96, v97, v98
v_max3_u32 v60, v60, v99, v100
v_max3_u32 v60, v60, v101, v102
v_max3_u32 v60, v60, v103, v104
v_max3_u32 v60, v60, v105, v106
v_max3_u32 v60, v60, v107, v108
v_max3_u32 v60, v60, v109, v110
v_max3_u32 v60, v60, v111, v112
v_max3_u32 v60, v60, v113, v114
v_max3_u32 v60, v60, v115, v116
v_max3_u32 v60, v60, v117, v118
v_max3_u32 v60, v60, v119, v120
v_max3_u32 v60, v60, v121, v122
v_max3_u32 v60, v60, v123, v124
v_max3_u32 v60, v60, v125, v126
v_max_u32 v60, v60, v127
v_cmp_eq_u32 vcc, -1, v60
s_cbranch_vccz LVE_73
s_sleep 4
s_add_u32 s96, s96, 1
s_cmp_lt_u32 s96, 20000
s_cbranch_scc1 LV_72
LVE_73:
v_lshlrev_b32 v80, 16, v96
v_and_b32 v81, 0xffff0000, v96
v_lshlrev_b32 v82, 16, v97
v_and_b32 v83, 0xffff0000, v97
v_lshlrev_b32 v84, 16, v98
v_and_b32 v85, 0xffff0000, v98
v_lshlrev_b32 v86, 16, v99
v_and_b32 v87, 0xffff0000, v99
v_lshlrev_b32 v88, 16, v100
v_and_b32 v89, 0xffff0000, v100
v_lshlrev_b32 v90, 16, v101
v_and_b32 v91, 0xffff0000, v101
v_lshlrev_b32 v92, 16, v102
v_and_b32 v93, 0xffff0000, v102
v_lshlrev_b32 v94, 16, v103
v_and_b32 v95, 0xffff0000, v103
v_add_f32 v80, v80, v88
v_add_f32 v81, v81, v89
v_add_f32 v82, v82, v90
v_add_f32 v83, v83, v91
v_add_f32 v84, v84, v92
v_add_f32 v85, v85, v93
v_add_f32 v86, v86, v94
v_add_f32 v87, v87, v95
v_lshlrev_b32 v88, 16, v104
v_and_b32 v89, 0xffff0000, v104
v_lshlrev_b32 v90, 16, v105
v_and_b32 v91, 0xffff0000, v105
v_lshlrev_b32 v92, 16, v106
v_and_b32 v93, 0xffff0000, v106
v_lshlrev_b32 v94, 16, v107
v_and_b32 v95, 0xffff0000, v107
v_add_f32 v80, v80, v88
v_add_f32 v81, v81, v89
v_add_f32 v82, v82, v90
v_add_f32 v83, v83, v91
v_add_f32 v84, v84, v92
v_add_f32 v85, v85, v93
v_add_f32 v86, v86, v94
v_add_f32 v87, v87, v95
v_lshlrev_b32 v88, 16, v108
v_and_b32 v89, 0xffff0000, v108
v_lshlrev_b32 v90, 16, v109
v_and_b32 v91, 0xffff0000, v109
v_lshlrev_b32 v92, 16, v110
v_and_b32 v93, 0xffff0000, v110
v_lshlrev_b32 v94, 16, v111
v_and_b32 v95, 0xffff0000, v111
v_add_f32 v80, v80, v88
v_add_f32 v81, v81, v89
v_add_f32 v82, v82, v90
v_add_f32 v83, v83, v91
v_add_f32 v84, v84, v92
v_add_f32 v85, v85, v93
v_add_f32 v86, v86, v94
v_add_f32 v87, v87, v95
v_lshlrev_b32 v88, 16, v112
v_and_b32 v89, 0xffff0000, v112
v_lshlrev_b32 v90, 16, v113
v_and_b32 v91, 0xffff0000, v113
v_lshlrev_b32 v92, 16, v114
v_and_b32 v93, 0xffff0000, v114
v_lshlrev_b32 v94, 16, v115
v_and_b32 v95, 0xffff0000, v115
v_add_f32 v80, v80, v88
v_add_f32 v81, v81, v89
v_add_f32 v82, v82, v90
v_add_f32 v83, v83, v91
v_add_f32 v84, v84, v92
v_add_f32 v85, v85, v93
v_add_f32 v86, v86, v94
v_add_f32 v87, v87, v95
v_lshlrev_b32 v88, 16, v116
v_and_b32 v89, 0xffff0000, v116
v_lshlrev_b32 v90, 16, v117
v_and_b32 v91, 0xffff0000, v117
v_lshlrev_b32 v92, 16, v118
v_and_b32 v93, 0xffff0000, v118
v_lshlrev_b32 v94, 16, v119
v_and_b32 v95, 0xffff0000, v119
v_add_f32 v80, v80, v88
v_add_f32 v81, v81, v89
v_add_f32 v82, v82, v90
v_add_f32 v83, v83, v91
v_add_f32 v84, v84, v92
v_add_f32 v85, v85, v93
v_add_f32 v86, v86, v94
v_add_f32 v87, v87, v95
v_lshlrev_b32 v88, 16, v120
v_and_b32 v89, 0xffff0000, v120
v_lshlrev_b32 v90, 16, v121
v_and_b32 v91, 0xffff0000, v121
v_lshlrev_b32 v92, 16, v122
v_and_b32 v93, 0xffff0000, v122
v_lshlrev_b32 v94, 16, v123
v_and_b32 v95, 0xffff0000, v123
v_add_f32 v80, v80, v88
v_add_f32 v81, v81, v89
v_add_f32 v82, v82, v90
v_add_f32 v83, v83, v91
v_add_f32 v84, v84, v92
v_add_f32 v85, v85, v93
v_add_f32 v86, v86, v94
v_add_f32 v87, v87, v95
v_lshlrev_b32 v88, 16, v124
v_and_b32 v89, 0xffff0000, v124
v_lshlrev_b32 v90, 16, v125
v_and_b32 v91, 0xffff0000, v125
v_lshlrev_b32 v92, 16, v126
v_and_b32 v93, 0xffff0000, v126
v_lshlrev_b32 v94, 16, v127
v_and_b32 v95, 0xffff0000, v127
v_add_f32 v80, v80, v88
v_add_f32 v81, v81, v89
v_add_f32 v82, v82, v90
v_add_f32 v83, v83, v91
v_add_f32 v84, v84, v92
v_add_f32 v85, v85, v93
v_add_f32 v86, v86, v94
v_add_f32 v87, v87, v95
v_lshlrev_b32 v64, 16, v128
v_and_b32 v65, 0xffff0000, v128
v_lshlrev_b32 v66, 16, v129
v_and_b32 v67, 0xffff0000, v129
v_lshlrev_b32 v68, 16, v130
v_and_b32 v69, 0xffff0000, v130
v_lshlrev_b32 v70, 16, v131
v_and_b32 v71, 0xffff0000, v131
v_cvt_pk_bf16_f32 v60, v80, v81
v_lshlrev_b32 v80, 16, v60
v_and_b32 v81, 0xffff0000, v60
v_mul_f32 v80, v16, v80
v_mul_f32 v81, v17, v81
v_cvt_pk_bf16_f32 v60, v80, v81
v_lshlrev_b32 v80, 16, v60
v_and_b32 v81, 0xffff0000, v60
v_add_f32 v64, v64, v80
v_add_f32 v65, v65, v81
v_cvt_pk_bf16_f32 v60, v64, v65
v_lshlrev_b32 v64, 16, v60
v_and_b32 v65, 0xffff0000, v60
v_cvt_pk_bf16_f32 v60, v82, v83
v_lshlrev_b32 v82, 16, v60
v_and_b32 v83, 0xffff0000, v60
v_mul_f32 v82, v18, v82
v_mul_f32 v83, v19, v83
v_cvt_pk_bf16_f32 v60, v82, v83
v_lshlrev_b32 v82, 16, v60
v_and_b32 v83, 0xffff0000, v60
v_add_f32 v66, v66, v82
v_add_f32 v67, v67, v83
v_cvt_pk_bf16_f32 v60, v66, v67
v_lshlrev_b32 v66, 16, v60
v_and_b32 v67, 0xffff0000, v60
v_cvt_pk_bf16_f32 v60, v84, v85
v_lshlrev_b32 v84, 16, v60
v_and_b32 v85, 0xffff0000, v60
v_mul_f32 v84, v20, v84
v_mul_f32 v85, v21, v85
v_cvt_pk_bf16_f32 v60, v84, v85
v_lshlrev_b32 v84, 16, v60
v_and_b32 v85, 0xffff0000, v60
v_add_f32 v68, v68, v84
v_add_f32 v69, v69, v85
v_cvt_pk_bf16_f32 v60, v68, v69
v_lshlrev_b32 v68, 16, v60
v_and_b32 v69, 0xffff0000, v60
v_cvt_pk_bf16_f32 v60, v86, v87
v_lshlrev_b32 v86, 16, v60
v_and_b32 v87, 0xffff0000, v60
v_mul_f32 v86, v22, v86
v_mul_f32 v87, v23, v87
v_cvt_pk_bf16_f32 v60, v86, v87
v_lshlrev_b32 v86, 16, v60
v_and_b32 v87, 0xffff0000, v60
v_add_f32 v70, v70, v86
v_add_f32 v71, v71, v87
v_cvt_pk_bf16_f32 v60, v70, v71
v_lshlrev_b32 v70, 16, v60
v_and_b32 v71, 0xffff0000, v60
v_add_f32 v6, v64, v65
v_add_f32 v6, v6, v66
v_add_f32 v6, v6, v67
v_add_f32 v6, v6, v68
v_add_f32 v6, v6, v69
v_add_f32 v6, v6, v70
v_add_f32 v6, v6, v71
s_nop 1
v_add_f32_dpp v6, v6, v6 quad_perm:[1,0,3,2] row_mask:0xf bank_mask:0xf
s_nop 1
v_add_f32_dpp v6, v6, v6 quad_perm:[2,3,0,1] row_mask:0xf bank_mask:0xf
s_nop 1
v_add_f32_dpp v6, v6, v6 row_half_mirror row_mask:0xf bank_mask:0xf
s_nop 1
v_add_f32_dpp v6, v6, v6 row_mirror row_mask:0xf bank_mask:0xf
v_mov_b32 v8, v6
s_nop 1
v_permlane16_swap_b32 v6, v8
v_add_f32 v6, v6, v8
v_mov_b32 v8, v6
s_nop 1
v_permlane32_swap_b32 v6, v8
v_add_f32 v6, v6, v8
v_mul_f32 v6, 0x3b000000, v6
v_mov_b32 v7, 0
v_sub_f32 v9, v64, v6
v_fmac_f32 v7, v9, v9
v_sub_f32 v9, v65, v6
v_fmac_f32 v7, v9, v9
v_sub_f32 v9, v66, v6
v_fmac_f32 v7, v9, v9
v_sub_f32 v9, v67, v6
v_fmac_f32 v7, v9, v9
v_sub_f32 v9, v68, v6
v_fmac_f32 v7, v9, v9
v_sub_f32 v9, v69, v6
v_fmac_f32 v7, v9, v9
v_sub_f32 v9, v70, v6
v_fmac_f32 v7, v9, v9
v_sub_f32 v9, v71, v6
v_fmac_f32 v7, v9, v9
s_nop 1
v_add_f32_dpp v7, v7, v7 quad_perm:[1,0,3,2] row_mask:0xf bank_mask:0xf
s_nop 1
v_add_f32_dpp v7, v7, v7 quad_perm:[2,3,0,1] row_mask:0xf bank_mask:0xf
s_nop 1
v_add_f32_dpp v7, v7, v7 row_half_mirror row_mask:0xf bank_mask:0xf
s_nop 1
v_add_f32_dpp v7, v7, v7 row_mirror row_mask:0xf bank_mask:0xf
v_mov_b32 v8, v7
s_nop 1
v_permlane16_swap_b32 v7, v8
v_add_f32 v7, v7, v8
v_mov_b32 v8, v7
s_nop 1
v_permlane32_swap_b32 v7, v8
v_add_f32 v7, v7, v8
v_mul_f32 v7, 0x3b000000, v7
v_cvt_pk_bf16_f32 v8, v6, v7
v_lshlrev_b32 v6, 16, v8
v_and_b32 v7, 0xffff0000, v8
v_add_f32 v7, s21, v7
v_cvt_pk_bf16_f32 v7, v7, v7
v_lshlrev_b32 v7, 16, v7
v_sqrt_f32 v7, v7
s_nop 0
v_cvt_pk_bf16_f32 v7, v7, v7
v_lshlrev_b32 v7, 16, v7
v_rcp_f32 v7, v7
v_sub_f32 v80, v64, v6
v_sub_f32 v81, v65, v6
v_cvt_pk_bf16_f32 v8, v80, v81
v_lshlrev_b32 v80, 16, v8
v_and_b32 v81, 0xffff0000, v8
v_mul_f32 v80, v80, v7
v_mul_f32 v81, v81, v7
v_cvt_pk_bf16_f32 v8, v80, v81
v_lshlrev_b32 v80, 16, v8
v_and_b32 v81, 0xffff0000, v8
v_mul_f32 v80, v80, v32
v_mul_f32 v81, v81, v33
v_cvt_pk_bf16_f32 v8, v80, v81
v_lshlrev_b32 v80, 16, v8
v_and_b32 v81, 0xffff0000, v8
v_add_f32 v80, v80, v24
v_add_f32 v81, v81, v25
v_cvt_pk_bf16_f32 v88, v80, v81
v_sub_f32 v82, v66, v6
v_sub_f32 v83, v67, v6
v_cvt_pk_bf16_f32 v8, v82, v83
v_lshlrev_b32 v82, 16, v8
v_and_b32 v83, 0xffff0000, v8
v_mul_f32 v82, v82, v7
v_mul_f32 v83, v83, v7
v_cvt_pk_bf16_f32 v8, v82, v83
v_lshlrev_b32 v82, 16, v8
v_and_b32 v83, 0xffff0000, v8
v_mul_f32 v82, v82, v34
v_mul_f32 v83, v83, v35
v_cvt_pk_bf16_f32 v8, v82, v83
v_lshlrev_b32 v82, 16, v8
v_and_b32 v83, 0xffff0000, v8
v_add_f32 v82, v82, v26
v_add_f32 v83, v83, v27
v_cvt_pk_bf16_f32 v89, v82, v83
v_sub_f32 v84, v68, v6
v_sub_f32 v85, v69, v6
v_cvt_pk_bf16_f32 v8, v84, v85
v_lshlrev_b32 v84, 16, v8
v_and_b32 v85, 0xffff0000, v8
v_mul_f32 v84, v84, v7
v_mul_f32 v85, v85, v7
v_cvt_pk_bf16_f32 v8, v84, v85
v_lshlrev_b32 v84, 16, v8
v_and_b32 v85, 0xffff0000, v8
v_mul_f32 v84, v84, v36
v_mul_f32 v85, v85, v37
v_cvt_pk_bf16_f32 v8, v84, v85
v_lshlrev_b32 v84, 16, v8
v_and_b32 v85, 0xffff0000, v8
v_add_f32 v84, v84, v28
v_add_f32 v85, v85, v29
v_cvt_pk_bf16_f32 v90, v84, v85
v_sub_f32 v86, v70, v6
v_sub_f32 v87, v71, v6
v_cvt_pk_bf16_f32 v8, v86, v87
v_lshlrev_b32 v86, 16, v8
v_and_b32 v87, 0xffff0000, v8
v_mul_f32 v86, v86, v7
v_mul_f32 v87, v87, v7
v_cvt_pk_bf16_f32 v8, v86, v87
v_lshlrev_b32 v86, 16, v8
v_and_b32 v87, 0xffff0000, v8
v_mul_f32 v86, v86, v38
v_mul_f32 v87, v87, v39
v_cvt_pk_bf16_f32 v8, v86, v87
v_lshlrev_b32 v86, 16, v8
v_and_b32 v87, 0xffff0000, v8
v_add_f32 v86, v86, v30
v_add_f32 v87, v87, v31
v_cvt_pk_bf16_f32 v91, v86, v87
s_add_u32 s19, s18, 0
s_lshr_b32 s34, s19, 4
s_lshl_b32 s34, s34, 14
s_and_b32 s36, s19, 15
s_lshl_b32 s36, s36, 4
s_add_u32 s34, s34, s36
s_lshl_b32 s36, s17, 15
s_add_u32 s34, s34, s36
s_add_u32 s34, s34, 6291456
s_add_u32 s44, s4, s34
s_addc_u32 s45, s5, 0
global_store_dwordx4 v4, v[88:91], s[44:45] sc1
s_lshl_b32 s34, s17, 7
s_add_u32 s34, s34, 40960
s_lshl_b32 s35, s20, 13
s_add_u32 s34, s34, s35
s_add_u32 s42, s4, s34
s_addc_u32 s43, s5, 0
s_waitcnt vmcnt(0)
s_barrier
s_cmp_lg_u32 s11, 0
s_cbranch_scc1 SG_74
v_mov_b32 v250, 0
v_mov_b32 v251, 1
s_mov_b64 exec, 1
global_atomic_add v250, v251, s[42:43] offset:0
s_mov_b64 exec, -1
SG_74:
s_cmp_ge_u32 s17, 61
s_cbranch_scc1 GE_75
s_lshl_b32 s34, s17, 7
s_add_u32 s34, s34, 57344
s_lshl_b32 s35, s20, 13
s_add_u32 s34, s34, s35
s_mov_b32 s33, 11
s_branch GJ_76
GE_75:
s_lshl_b32 s34, s17, 7
s_add_u32 s34, s34, 40960
s_lshl_b32 s35, s20, 13
s_add_u32 s34, s34, s35
s_mov_b32 s33, 4
GJ_76:
s_add_u32 s42, s4, s34
s_addc_u32 s43, s5, 0
s_cmp_lg_u32 s11, 0
s_cbranch_scc1 W1_77
v_mov_b32 v250, 0
s_mov_b32 s96, 0
W_78:
global_load_dword v251, v250, s[42:43] offset:0 sc1
s_waitcnt vmcnt(0)
v_readfirstlane_b32 s97, v251
s_nop 0
s_cmp_ge_u32 s97, s33
s_cbranch_scc1 WE_79
s_sleep 16
s_add_u32 s96, s96, 1
s_cmp_lt_u32 s96, 200000
s_cbranch_scc1 W_78
WE_79:
W1_77:
s_barrier
s_cmp_lt_u32 s17, 61
s_cbranch_scc1 GS_80
s_sleep 70
GS_80:
s_mul_i32 s34, s17, 360448
s_add_u32 s19, s18, 0
s_lshl_b32 s19, s19, 10
s_add_u32 s34, s34, s19
s_add_u32 s34, s34, 121634816
s_add_u32 s50, s4, s34
s_addc_u32 s51, s5, 0
s_mov_b32 s96, 0
LV_81:
s_mov_b32 s44, s50
s_mov_b32 s45, s51
global_load_dwordx4 v[96:99], v2, s[44:45] sc1
s_add_u32 s44, s44, 32768
s_addc_u32 s45, s45, 0
global_load_dwordx4 v[100:103], v2, s[44:45] sc1
s_add_u32 s44, s44, 32768
s_addc_u32 s45, s45, 0
global_load_dwordx4 v[104:107], v2, s[44:45] sc1
s_add_u32 s44, s44, 32768
s_addc_u32 s45, s45, 0
global_load_dwordx4 v[108:111], v2, s[44:45] sc1
s_add_u32 s44, s44, 32768
s_addc_u32 s45, s45, 0
global_load_dwordx4 v[112:115], v2, s[44:45] sc1
s_add_u32 s44, s44, 32768
s_addc_u32 s45, s45, 0
global_load_dwordx4 v[116:119], v2, s[44:45] sc1
s_add_u32 s44, s44, 32768
s_addc_u32 s45, s45, 0
global_load_dwordx4 v[120:123], v2, s[44:45] sc1
s_add_u32 s44, s44, 32768
s_addc_u32 s45, s45, 0
global_load_dwordx4 v[124:127], v2, s[44:45] sc1
s_add_u32 s44, s44, 32768
s_addc_u32 s45, s45, 0
global_load_dwordx4 v[128:131], v2, s[44:45] sc1
s_add_u32 s44, s44, 32768
s_addc_u32 s45, s45, 0
global_load_dwordx4 v[132:135], v2, s[44:45] sc1
s_add_u32 s44, s44, 32768
s_addc_u32 s45, s45, 0
global_load_dwordx4 v[136:139], v2, s[44:45] sc1
s_add_u32 s44, s44, 32768
s_addc_u32 s45, s45, 0
s_waitcnt vmcnt(0)
v_max3_u32 v60, v96, v97, v98
v_max3_u32 v60, v60, v99, v100
v_max3_u32 v60, v60, v101, v102
v_max3_u32 v60, v60, v103, v104
v_max3_u32 v60, v60, v105, v106
v_max3_u32 v60, v60, v107, v108
v_max3_u32 v60, v60, v109, v110
v_max3_u32 v60, v60, v111, v112
v_max3_u32 v60, v60, v113, v114
v_max3_u32 v60, v60, v115, v116
v_max3_u32 v60, v60, v117, v118
v_max3_u32 v60, v60, v119, v120
v_max3_u32 v60, v60, v121, v122
v_max3_u32 v60, v60, v123, v124
v_max3_u32 v60, v60, v125, v126
v_max3_u32 v60, v60, v127, v128
v_max3_u32 v60, v60, v129, v130
v_max3_u32 v60, v60, v131, v132
v_max3_u32 v60, v60, v133, v134
v_max3_u32 v60, v60, v135, v136
v_max3_u32 v60, v60, v137, v138
v_max_u32 v60, v60, v139
v_cmp_eq_u32 vcc, -1, v60
s_cbranch_vccz LVE_82
s_sleep 4
s_add_u32 s96, s96, 1
s_cmp_lt_u32 s96, 20000
s_cbranch_scc1 LV_81
LVE_82:
v_lshlrev_b32 v80, 16, v96
v_and_b32 v81, 0xffff0000, v96
v_lshlrev_b32 v82, 16, v97
v_and_b32 v83, 0xffff0000, v97
v_lshlrev_b32 v84, 16, v98
v_and_b32 v85, 0xffff0000, v98
v_lshlrev_b32 v86, 16, v99
v_and_b32 v87, 0xffff0000, v99
v_lshlrev_b32 v88, 16, v100
v_and_b32 v89, 0xffff0000, v100
v_lshlrev_b32 v90, 16, v101
v_and_b32 v91, 0xffff0000, v101
v_lshlrev_b32 v92, 16, v102
v_and_b32 v93, 0xffff0000, v102
v_lshlrev_b32 v94, 16, v103
v_and_b32 v95, 0xffff0000, v103
v_add_f32 v80, v80, v88
v_add_f32 v81, v81, v89
v_add_f32 v82, v82, v90
v_add_f32 v83, v83, v91
v_add_f32 v84, v84, v92
v_add_f32 v85, v85, v93
v_add_f32 v86, v86, v94
v_add_f32 v87, v87, v95
v_lshlrev_b32 v88, 16, v104
v_and_b32 v89, 0xffff0000, v104
v_lshlrev_b32 v90, 16, v105
v_and_b32 v91, 0xffff0000, v105
v_lshlrev_b32 v92, 16, v106
v_and_b32 v93, 0xffff0000, v106
v_lshlrev_b32 v94, 16, v107
v_and_b32 v95, 0xffff0000, v107
v_add_f32 v80, v80, v88
v_add_f32 v81, v81, v89
v_add_f32 v82, v82, v90
v_add_f32 v83, v83, v91
v_add_f32 v84, v84, v92
v_add_f32 v85, v85, v93
v_add_f32 v86, v86, v94
v_add_f32 v87, v87, v95
v_lshlrev_b32 v88, 16, v108
v_and_b32 v89, 0xffff0000, v108
v_lshlrev_b32 v90, 16, v109
v_and_b32 v91, 0xffff0000, v109
v_lshlrev_b32 v92, 16, v110
v_and_b32 v93, 0xffff0000, v110
v_lshlrev_b32 v94, 16, v111
v_and_b32 v95, 0xffff0000, v111
v_add_f32 v80, v80, v88
v_add_f32 v81, v81, v89
v_add_f32 v82, v82, v90
v_add_f32 v83, v83, v91
v_add_f32 v84, v84, v92
v_add_f32 v85, v85, v93
v_add_f32 v86, v86, v94
v_add_f32 v87, v87, v95
v_lshlrev_b32 v88, 16, v112
v_and_b32 v89, 0xffff0000, v112
v_lshlrev_b32 v90, 16, v113
v_and_b32 v91, 0xffff0000, v113
v_lshlrev_b32 v92, 16, v114
v_and_b32 v93, 0xffff0000, v114
v_lshlrev_b32 v94, 16, v115
v_and_b32 v95, 0xffff0000, v115
v_add_f32 v80, v80, v88
v_add_f32 v81, v81, v89
v_add_f32 v82, v82, v90
v_add_f32 v83, v83, v91
v_add_f32 v84, v84, v92
v_add_f32 v85, v85, v93
v_add_f32 v86, v86, v94
v_add_f32 v87, v87, v95
v_lshlrev_b32 v88, 16, v116
v_and_b32 v89, 0xffff0000, v116
v_lshlrev_b32 v90, 16, v117
v_and_b32 v91, 0xffff0000, v117
v_lshlrev_b32 v92, 16, v118
v_and_b32 v93, 0xffff0000, v118
v_lshlrev_b32 v94, 16, v119
v_and_b32 v95, 0xffff0000, v119
v_add_f32 v80, v80, v88
v_add_f32 v81, v81, v89
v_add_f32 v82, v82, v90
v_add_f32 v83, v83, v91
v_add_f32 v84, v84, v92
v_add_f32 v85, v85, v93
v_add_f32 v86, v86, v94
v_add_f32 v87, v87, v95
v_lshlrev_b32 v88, 16, v120
v_and_b32 v89, 0xffff0000, v120
v_lshlrev_b32 v90, 16, v121
v_and_b32 v91, 0xffff0000, v121
v_lshlrev_b32 v92, 16, v122
v_and_b32 v93, 0xffff0000, v122
v_lshlrev_b32 v94, 16, v123
v_and_b32 v95, 0xffff0000, v123
v_add_f32 v80, v80, v88
v_add_f32 v81, v81, v89
v_add_f32 v82, v82, v90
v_add_f32 v83, v83, v91
v_add_f32 v84, v84, v92
v_add_f32 v85, v85, v93
v_add_f32 v86, v86, v94
v_add_f32 v87, v87, v95
v_lshlrev_b32 v88, 16, v124
v_and_b32 v89, 0xffff0000, v124
v_lshlrev_b32 v90, 16, v125
v_and_b32 v91, 0xffff0000, v125
v_lshlrev_b32 v92, 16, v126
v_and_b32 v93, 0xffff0000, v126
v_lshlrev_b32 v94, 16, v127
v_and_b32 v95, 0xffff0000, v127
v_add_f32 v80, v80, v88
v_add_f32 v81, v81, v89
v_add_f32 v82, v82, v90
v_add_f32 v83, v83, v91
v_add_f32 v84, v84, v92
v_add_f32 v85, v85, v93
v_add_f32 v86, v86, v94
v_add_f32 v87, v87, v95
v_lshlrev_b32 v88, 16, v128
v_and_b32 v89, 0xffff0000, v128
v_lshlrev_b32 v90, 16, v129
v_and_b32 v91, 0xffff0000, v129
v_lshlrev_b32 v92, 16, v130
v_and_b32 v93, 0xffff0000, v130
v_lshlrev_b32 v94, 16, v131
v_and_b32 v95, 0xffff0000, v131
v_add_f32 v80, v80, v88
v_add_f32 v81, v81, v89
v_add_f32 v82, v82, v90
v_add_f32 v83, v83, v91
v_add_f32 v84, v84, v92
v_add_f32 v85, v85, v93
v_add_f32 v86, v86, v94
v_add_f32 v87, v87, v95
v_lshlrev_b32 v88, 16, v132
v_and_b32 v89, 0xffff0000, v132
v_lshlrev_b32 v90, 16, v133
v_and_b32 v91, 0xffff0000, v133
v_lshlrev_b32 v92, 16, v134
v_and_b32 v93, 0xffff0000, v134
v_lshlrev_b32 v94, 16, v135
v_and_b32 v95, 0xffff0000, v135
v_add_f32 v80, v80, v88
v_add_f32 v81, v81, v89
v_add_f32 v82, v82, v90
v_add_f32 v83, v83, v91
v_add_f32 v84, v84, v92
v_add_f32 v85, v85, v93
v_add_f32 v86, v86, v94
v_add_f32 v87, v87, v95
v_lshlrev_b32 v88, 16, v136
v_and_b32 v89, 0xffff0000, v136
v_lshlrev_b32 v90, 16, v137
v_and_b32 v91, 0xffff0000, v137
v_lshlrev_b32 v92, 16, v138
v_and_b32 v93, 0xffff0000, v138
v_lshlrev_b32 v94, 16, v139
v_and_b32 v95, 0xffff0000, v139
v_add_f32 v80, v80, v88
v_add_f32 v81, v81, v89
v_add_f32 v82, v82, v90
v_add_f32 v83, v83, v91
v_add_f32 v84, v84, v92
v_add_f32 v85, v85, v93
v_add_f32 v86, v86, v94
v_add_f32 v87, v87, v95
v_cvt_pk_bf16_f32 v60, v80, v81
v_lshlrev_b32 v80, 16, v60
v_and_b32 v81, 0xffff0000, v60
v_add_f32 v80, v80, v48
v_add_f32 v81, v81, v49
v_cvt_pk_bf16_f32 v60, v80, v81
v_lshlrev_b32 v80, 16, v60
v_and_b32 v81, 0xffff0000, v60
v_mul_f32 v80, v80, v40
v_mul_f32 v81, v81, v41
v_cvt_pk_bf16_f32 v60, v80, v81
v_lshlrev_b32 v80, 16, v60
v_and_b32 v81, 0xffff0000, v60
v_add_f32 v80, v80, v64
v_add_f32 v81, v81, v65
v_cvt_pk_bf16_f32 v88, v80, v81
v_cvt_pk_bf16_f32 v60, v82, v83
v_lshlrev_b32 v82, 16, v60
v_and_b32 v83, 0xffff0000, v60
v_add_f32 v82, v82, v50
v_add_f32 v83, v83, v51
v_cvt_pk_bf16_f32 v60, v82, v83
v_lshlrev_b32 v82, 16, v60
v_and_b32 v83, 0xffff0000, v60
v_mul_f32 v82, v82, v42
v_mul_f32 v83, v83, v43
v_cvt_pk_bf16_f32 v60, v82, v83
v_lshlrev_b32 v82, 16, v60
v_and_b32 v83, 0xffff0000, v60
v_add_f32 v82, v82, v66
v_add_f32 v83, v83, v67
v_cvt_pk_bf16_f32 v89, v82, v83
v_cvt_pk_bf16_f32 v60, v84, v85
v_lshlrev_b32 v84, 16, v60
v_and_b32 v85, 0xffff0000, v60
v_add_f32 v84, v84, v52
v_add_f32 v85, v85, v53
v_cvt_pk_bf16_f32 v60, v84, v85
v_lshlrev_b32 v84, 16, v60
v_and_b32 v85, 0xffff0000, v60
v_mul_f32 v84, v84, v44
v_mul_f32 v85, v85, v45
v_cvt_pk_bf16_f32 v60, v84, v85
v_lshlrev_b32 v84, 16, v60
v_and_b32 v85, 0xffff0000, v60
v_add_f32 v84, v84, v68
v_add_f32 v85, v85, v69
v_cvt_pk_bf16_f32 v90, v84, v85
v_cvt_pk_bf16_f32 v60, v86, v87
v_lshlrev_b32 v86, 16, v60
v_and_b32 v87, 0xffff0000, v60
v_add_f32 v86, v86, v54
v_add_f32 v87, v87, v55
v_cvt_pk_bf16_f32 v60, v86, v87
v_lshlrev_b32 v86, 16, v60
v_and_b32 v87, 0xffff0000, v60
v_mul_f32 v86, v86, v46
v_mul_f32 v87, v87, v47
v_cvt_pk_bf16_f32 v60, v86, v87
v_lshlrev_b32 v86, 16, v60
v_and_b32 v87, 0xffff0000, v60
v_add_f32 v86, v86, v70
v_add_f32 v87, v87, v71
v_cvt_pk_bf16_f32 v91, v86, v87
s_add_u32 s19, s18, 0
s_lshl_b32 s34, s17, 15
s_lshl_b32 s36, s19, 10
s_add_u32 s34, s34, s36
s_add_u32 s44, s48, s34
s_addc_u32 s45, s49, 0
global_store_dwordx4 v2, v[88:91], s[44:45] sc1
s_nop 1
s_add_u32 s17, s17, 8
s_cmp_lt_u32 s17, 64
s_cbranch_scc1 R_loop
s_waitcnt vmcnt(0)
s_branch L_end
L_chain:
s_mov_b32 s10, s9
s_cmp_eq_u32 s8, 0
s_cselect_b32 s90, 0x10001, 1
v_lshlrev_b32 v3, 4, v0
s_lshl_b32 s34, s11, 11
v_add_u32 v4, s34, v3
s_lshl_b32 s34, s11, 14
s_add_u32 s34, s34, 30208
v_add_u32 v5, s34, v3
v_add_u32 v1, 0x10000, v5
v_and_b32 v24, 15, v0
v_lshrrev_b32 v25, 4, v0
v_mov_b32 v2, 0x4444
v_mov_b32 v26, 0xeeee
v_cmp_le_u32 vcc, 8, v24
s_nop 1
v_cndmask_b32 v2, v2, v26, vcc
v_lshrrev_b32 v26, 1, v25
v_lshlrev_b32 v26, 8, v26
v_lshlrev_b32 v27, 4, v24
v_add_u32 v26, v26, v27
v_and_b32 v27, 1, v25
v_lshlrev_b32 v27, 3, v27
v_add_u32 v26, v26, v27
s_lshl_b32 s34, s11, 9
v_add_u32 v6, s34, v26
v_lshrrev_b32 v26, 2, v0
v_lshlrev_b32 v26, 4, v26
v_and_b32 v27, 1, v0
v_lshlrev_b32 v27, 3, v27
v_add_u32 v7, v26, v27
v_and_b32 v26, 7, v24
v_mul_u32_u24 v26, 288, v26
v_add_u32 v12, 161280, v26
v_lshlrev_b32 v27, 3, v25
v_add_u32 v8, v12, v27
s_lshl_b32 s34, s11, 6
v_add_u32 v8, s34, v8
v_lshlrev_b32 v27, 4, v25
v_add_u32 v12, v12, v27
v_lshrrev_b32 v26, 5, v0
v_lshlrev_b32 v26, 3, v26
v_and_b32 v27, 1, v25
v_lshlrev_b32 v27, 2, v27
v_add_u32 v26, v26, v27
v_lshrrev_b32 v27, 2, v24
v_add_u32 v26, v26, v27
v_lshlrev_b32 v26, 11, v26
v_and_b32 v27, 3, v24
v_lshlrev_b32 v27, 4, v27
v_add_u32 v26, v26, v27
s_lshl_b32 s34, s11, 16
s_lshl_b32 s35, s10, 6
s_add_u32 s34, s34, s35
v_add_u32 v9, s34, v26
s_lshl_b32 s34, s10, 13
v_add_u32 v10, s34, v4
s_lshr_b32 s34, s10, 3
s_lshl_b32 s34, s34, 3
s_bfe_u32 s35, s10, 0x10002
s_lshl_b32 s35, s35, 2
s_add_u32 s34, s34, s35
s_bfe_u32 s35, s10, 0x10001
s_add_u32 s34, s34, s35
v_and_b32 v26, 1, v25
v_lshlrev_b32 v26, 1, v26
v_add_u32 v26, s34, v26
v_bfe_u32 v27, v0, 2, 2
s_and_b32 s34, s10, 1
s_lshl_b32 s34, s34, 2
v_add_u32 v27, s34, v27
v_bfe_u32 v28, v0, 1, 1
s_lshl_b32 s34, s11, 1
v_add_u32 v28, s34, v28
v_and_b32 v29, 1, v28
v_lshlrev_b32 v29, 3, v29
v_add_u32 v29, v29, v27
v_lshlrev_b32 v29, 4, v29
v_lshrrev_b32 v30, 1, v28
v_lshlrev_b32 v30, 2, v30
v_add_u32 v29, v29, v30
v_lshlrev_b32 v30, 8, v26
v_add_u32 v11, v29, v30
v_lshlrev_b32 v27, 10, v27
v_lshlrev_b32 v26, 5, v26
v_lshlrev_b32 v28, 2, v28
v_add_u32 v27, v27, v26
v_add_u32 v127, v27, v28
v_and_b32 v26, 7, v24
v_lshrrev_b32 v27, 1, v26
v_and_b32 v28, 1, v26
v_mov_b32 v29, 0x3f80
v_mov_b32 v30, 0x3f800000
v_cmp_eq_u32 vcc, 1, v28
s_nop 1
v_cndmask_b32 v29, v29, v30, vcc
v_cmp_eq_u32 vcc, 0, v27
s_nop 1
v_cndmask_b32 v16, 0, v29, vcc
v_cmp_eq_u32 vcc, 1, v27
s_nop 1
v_cndmask_b32 v17, 0, v29, vcc
v_cmp_eq_u32 vcc, 2, v27
s_nop 1
v_cndmask_b32 v18, 0, v29, vcc
v_cmp_eq_u32 vcc, 3, v27
s_nop 1
v_cndmask_b32 v19, 0, v29, vcc
v_mov_b32 v20, 0x3f803f80
v_mov_b32 v21, 0x3f803f80
v_mov_b32 v22, 0x3f803f80
v_mov_b32 v23, 0x3f803f80
v_cmp_gt_u32 vcc, 2, v25
s_nop 1
v_cndmask_b32 v14, 0, v20, vcc
v_mov_b32 v15, v14
s_mov_b32 s40, 0x55555555
s_mov_b32 s41, 0
s_mov_b32 s18, 0xf0f0f0f0
s_mov_b32 s19, 0xf0f0f0f0
s_mov_b32 s20, 0xff00ff00
s_mov_b32 s21, 0xff00ff00
s_mov_b32 s14, 0x3e0293ee
s_mov_b32 s15, 0x3e0293ee
s_mov_b32 s8, 0x439cd760
s_add_u32 s26, s4, 2097152
s_addc_u32 s27, s5, 0
s_add_u32 s48, s4, 2162688
s_addc_u32 s49, s5, 0
s_lshl_b32 s34, s10, 13
s_add_u32 s30, s4, s34
s_addc_u32 s31, s5, 0
s_add_u32 s32, s30, 50331648
s_addc_u32 s33, s31, 0
s_add_u32 s30, s30, 33554432
s_addc_u32 s31, s31, 0
s_load_dwordx2 s[36:37], s[0:1], 8
s_waitcnt lgkmcnt(0)
s_mov_b64 exec, s[40:41]
global_load_dword v126, v127, s[36:37]
s_mov_b64 exec, -1
v_mov_b32 v28, -1
v_mov_b32 v29, -1
v_mov_b32 v30, -1
v_mov_b32 v31, -1
s_lshl_b32 s34, s10, 13
s_add_u32 s34, s34, 1048576
s_add_u32 s36, s4, s34
s_addc_u32 s37, s5, 0
global_store_dwordx4 v4, v[28:31], s[36:37] sc1
global_store_dwordx4 v4, v[28:31], s[36:37] offset:1024 sc1
s_lshl_b32 s34, s10, 13
s_add_u32 s34, s34, 1310720
s_add_u32 s36, s4, s34
s_addc_u32 s37, s5, 0
global_store_dwordx4 v4, v[28:31], s[36:37] sc1
global_store_dwordx4 v4, v[28:31], s[36:37] offset:1024 sc1
s_mov_b64 exec, s[40:41]
s_add_u32 s36, s26, 0
s_addc_u32 s37, s27, 0
global_store_dword v11, v28, s[36:37] sc1
s_add_u32 s36, s26, 8192
s_addc_u32 s37, s27, 0
global_store_dword v11, v28, s[36:37] sc1
s_add_u32 s36, s26, 16384
s_addc_u32 s37, s27, 0
global_store_dword v11, v28, s[36:37] sc1
s_add_u32 s36, s26, 24576
s_addc_u32 s37, s27, 0
global_store_dword v11, v28, s[36:37] sc1
s_mov_b64 exec, -1
s_load_dwordx4 s[56:59], s[0:1], 16
s_load_dwordx4 s[60:63], s[0:1], 32
v_lshrrev_b32 v24, 4, v0
v_and_b32 v25, 15, v0
v_lshlrev_b32 v26, 1, v24
v_xor_b32 v25, v25, v26
v_lshlrev_b32 v25, 4, v25
v_lshlrev_b32 v24, 13, v24
v_add_u32 v24, v24, v25
s_lshl_b32 s34, s11, 17
s_lshl_b32 s35, s10, 8
s_add_u32 s34, s34, s35
v_add_u32 v24, s34, v24
v_xor_b32 v25, 128, v24
v_lshrrev_b32 v26, 4, v0
v_bfe_u32 v27, v0, 2, 2
v_and_b32 v28, 3, v0
v_lshlrev_b32 v29, 3, v26
v_add_u32 v29, v29, v27
v_lshlrev_b32 v29, 8, v29
v_lshrrev_b32 v30, 1, v28
v_lshlrev_b32 v31, 1, v27
v_and_b32 v32, 1, v26
v_lshlrev_b32 v32, 3, v32
v_add_u32 v31, v31, v32
s_lshl_b32 s34, s11, 2
v_add_u32 v30, s34, v30
v_xor_b32 v30, v30, v31
v_lshlrev_b32 v30, 4, v30
v_add_u32 v29, v29, v30
v_and_b32 v32, 1, v28
v_lshlrev_b32 v32, 3, v32
v_add_u32 v29, v29, v32
v_add_u32 v38, 30208, v29
v_xor_b32 v39, 32, v29
v_add_u32 v39, 30208, v39
v_add_u32 v36, 0x10000, v38
v_add_u32 v37, 0x10000, v39
v_lshrrev_b32 v33, 1, v26
v_lshlrev_b32 v33, 3, v33
v_and_b32 v34, 1, v26
v_lshlrev_b32 v34, 2, v34
v_add_u32 v33, v33, v34
v_and_b32 v34, 1, v27
v_add_u32 v33, v33, v34
v_lshlrev_b32 v33, 10, v33
v_add_u32 v33, v33, v32
s_lshl_b32 s34, s11, 8
s_add_u32 s34, s34, 30208
v_add_u32 v33, s34, v33
v_lshrrev_b32 v34, 1, v27
v_lshlrev_b32 v34, 1, v34
v_lshrrev_b32 v35, 1, v28
v_add_u32 v34, v34, v35
v_and_b32 v35, 1, v27
v_lshlrev_b32 v35, 1, v35
v_lshrrev_b32 v40, 1, v26
v_and_b32 v40, 1, v40
v_lshlrev_b32 v40, 3, v40
v_add_u32 v35, v35, v40
v_xor_b32 v34, v34, v35
s_waitcnt lgkmcnt(0)
s_add_u32 s36, s56, 0
s_addc_u32 s37, s57, 0
s_lshl_b32 s34, s11, 12
s_add_u32 m0, s34, 30208
s_nop 0
global_load_lds_dwordx4 v24, s[36:37]
s_add_u32 s36, s56, 32768
s_addc_u32 s37, s57, 0
s_lshl_b32 s34, s11, 12
s_add_u32 m0, s34, 31232
s_nop 0
global_load_lds_dwordx4 v24, s[36:37]
s_add_u32 s36, s56, 65536
s_addc_u32 s37, s57, 0
s_lshl_b32 s34, s11, 12
s_add_u32 m0, s34, 32256
s_nop 0
global_load_lds_dwordx4 v25, s[36:37]
s_add_u32 s36, s56, 98304
s_addc_u32 s37, s57, 0
s_lshl_b32 s34, s11, 12
s_add_u32 m0, s34, 33280
s_nop 0
global_load_lds_dwordx4 v25, s[36:37]
s_add_u32 s36, s56, 524288
s_addc_u32 s37, s57, 0
s_lshl_b32 s34, s11, 12
s_add_u32 m0, s34, 46592
s_nop 0
global_load_lds_dwordx4 v24, s[36:37]
s_add_u32 s36, s56, 557056
s_addc_u32 s37, s57, 0
s_lshl_b32 s34, s11, 12
s_add_u32 m0, s34, 47616
s_nop 0
global_load_lds_dwordx4 v24, s[36:37]
s_add_u32 s36, s56, 589824
s_addc_u32 s37, s57, 0
s_lshl_b32 s34, s11, 12
s_add_u32 m0, s34, 48640
s_nop 0
global_load_lds_dwordx4 v25, s[36:37]
s_add_u32 s36, s56, 622592
s_addc_u32 s37, s57, 0
s_lshl_b32 s34, s11, 12
s_add_u32 m0, s34, 49664
s_nop 0
global_load_lds_dwordx4 v25, s[36:37]
s_add_u32 s36, s56, 1048576
s_addc_u32 s37, s57, 0
s_lshl_b32 s34, s11, 12
s_add_u32 m0, s34, 62976
s_nop 0
global_load_lds_dwordx4 v24, s[36:37]
s_add_u32 s36, s56, 1081344
s_addc_u32 s37, s57, 0
s_lshl_b32 s34, s11, 12
s_add_u32 m0, s34, 64000
s_nop 0
global_load_lds_dwordx4 v24, s[36:37]
s_add_u32 s36, s56, 1114112
s_addc_u32 s37, s57, 0
s_lshl_b32 s34, s11, 12
s_add_u32 m0, s34, 65024
s_nop 0
global_load_lds_dwordx4 v25, s[36:37]
s_add_u32 s36, s56, 1146880
s_addc_u32 s37, s57, 0
s_lshl_b32 s34, s11, 12
s_add_u32 m0, s34, 66048
s_nop 0
global_load_lds_dwordx4 v25, s[36:37]
s_add_u32 s36, s56, 1572864
s_addc_u32 s37, s57, 0
s_lshl_b32 s34, s11, 12
s_add_u32 m0, s34, 79360
s_nop 0
global_load_lds_dwordx4 v24, s[36:37]
s_add_u32 s36, s56, 1605632
s_addc_u32 s37, s57, 0
s_lshl_b32 s34, s11, 12
s_add_u32 m0, s34, 80384
s_nop 0
global_load_lds_dwordx4 v24, s[36:37]
s_add_u32 s36, s56, 1638400
s_addc_u32 s37, s57, 0
s_lshl_b32 s34, s11, 12
s_add_u32 m0, s34, 81408
s_nop 0
global_load_lds_dwordx4 v25, s[36:37]
s_add_u32 s36, s56, 1671168
s_addc_u32 s37, s57, 0
s_lshl_b32 s34, s11, 12
s_add_u32 m0, s34, 82432
s_nop 0
global_load_lds_dwordx4 v25, s[36:37]
s_add_u32 s36, s56, 2097152
s_addc_u32 s37, s57, 0
s_lshl_b32 s34, s11, 12
s_add_u32 m0, s34, 95744
s_nop 0
global_load_lds_dwordx4 v24, s[36:37]
s_add_u32 s36, s56, 2129920
s_addc_u32 s37, s57, 0
s_lshl_b32 s34, s11, 12
s_add_u32 m0, s34, 96768
s_nop 0
global_load_lds_dwordx4 v24, s[36:37]
s_add_u32 s36, s56, 2162688
s_addc_u32 s37, s57, 0
s_lshl_b32 s34, s11, 12
s_add_u32 m0, s34, 97792
s_nop 0
global_load_lds_dwordx4 v25, s[36:37]
s_add_u32 s36, s56, 2195456
s_addc_u32 s37, s57, 0
s_lshl_b32 s34, s11, 12
s_add_u32 m0, s34, 98816
s_nop 0
global_load_lds_dwordx4 v25, s[36:37]
s_add_u32 s36, s56, 2621440
s_addc_u32 s37, s57, 0
s_lshl_b32 s34, s11, 12
s_add_u32 m0, s34, 112128
s_nop 0
global_load_lds_dwordx4 v24, s[36:37]
s_add_u32 s36, s56, 2654208
s_addc_u32 s37, s57, 0
s_lshl_b32 s34, s11, 12
s_add_u32 m0, s34, 113152
s_nop 0
global_load_lds_dwordx4 v24, s[36:37]
s_add_u32 s36, s56, 2686976
s_addc_u32 s37, s57, 0
s_lshl_b32 s34, s11, 12
s_add_u32 m0, s34, 114176
s_nop 0
global_load_lds_dwordx4 v25, s[36:37]
s_add_u32 s36, s56, 2719744
s_addc_u32 s37, s57, 0
s_lshl_b32 s34, s11, 12
s_add_u32 m0, s34, 115200
s_nop 0
global_load_lds_dwordx4 v25, s[36:37]
s_add_u32 s36, s56, 3145728
s_addc_u32 s37, s57, 0
s_lshl_b32 s34, s11, 12
s_add_u32 m0, s34, 128512
s_nop 0
global_load_lds_dwordx4 v24, s[36:37]
s_add_u32 s36, s56, 3178496
s_addc_u32 s37, s57, 0
s_lshl_b32 s34, s11, 12
s_add_u32 m0, s34, 129536
s_nop 0
global_load_lds_dwordx4 v24, s[36:37]
s_add_u32 s36, s56, 3211264
s_addc_u32 s37, s57, 0
s_lshl_b32 s34, s11, 12
s_add_u32 m0, s34, 130560
s_nop 0
global_load_lds_dwordx4 v25, s[36:37]
s_add_u32 s36, s56, 3244032
s_addc_u32 s37, s57, 0
s_lshl_b32 s34, s11, 12
s_add_u32 m0, s34, 131584
s_nop 0
global_load_lds_dwordx4 v25, s[36:37]
s_add_u32 s36, s56, 3670016
s_addc_u32 s37, s57, 0
s_lshl_b32 s34, s11, 12
s_add_u32 m0, s34, 144896
s_nop 0
global_load_lds_dwordx4 v24, s[36:37]
s_add_u32 s36, s56, 3702784
s_addc_u32 s37, s57, 0
s_lshl_b32 s34, s11, 12
s_add_u32 m0, s34, 145920
s_nop 0
global_load_lds_dwordx4 v24, s[36:37]
s_add_u32 s36, s56, 3735552
s_addc_u32 s37, s57, 0
s_lshl_b32 s34, s11, 12
s_add_u32 m0, s34, 146944
s_nop 0
global_load_lds_dwordx4 v25, s[36:37]
s_add_u32 s36, s56, 3768320
s_addc_u32 s37, s57, 0
s_lshl_b32 s34, s11, 12
s_add_u32 m0, s34, 147968
s_nop 0
global_load_lds_dwordx4 v25, s[36:37]
s_waitcnt vmcnt(28)
s_barrier
s_cmp_lg_u32 s11, 0
s_cbranch_scc1 RC_83
v_mov_b32 v41, 0
v_mov_b32 v42, s90
s_mov_b64 exec, 1
global_atomic_add v41, v42, s[6:7] offset:12
s_mov_b64 exec, -1
RC_83:
ds_read_b64_tr_b16 a[0:1], v38 offset:0
ds_read_b64_tr_b16 a[2:3], v38 offset:1024
ds_read_b64_tr_b16 a[4:5], v38 offset:8192
ds_read_b64_tr_b16 a[6:7], v38 offset:9216
ds_read_b64_tr_b16 a[64:65], v39 offset:0
ds_read_b64_tr_b16 a[66:67], v39 offset:1024
ds_read_b64_tr_b16 a[68:69], v39 offset:8192
ds_read_b64_tr_b16 a[70:71], v39 offset:9216
s_waitcnt lgkmcnt(0)
s_barrier
s_add_u32 s36, s58, 0
s_addc_u32 s37, s59, 0
s_lshl_b32 s34, s11, 12
s_add_u32 m0, s34, 30208
s_nop 0
global_load_lds_dwordx4 v24, s[36:37]
s_add_u32 s36, s58, 32768
s_addc_u32 s37, s59, 0
s_lshl_b32 s34, s11, 12
s_add_u32 m0, s34, 31232
s_nop 0
global_load_lds_dwordx4 v24, s[36:37]
s_add_u32 s36, s58, 65536
s_addc_u32 s37, s59, 0
s_lshl_b32 s34, s11, 12
s_add_u32 m0, s34, 32256
s_nop 0
global_load_lds_dwordx4 v25, s[36:37]
s_add_u32 s36, s58, 98304
s_addc_u32 s37, s59, 0
s_lshl_b32 s34, s11, 12
s_add_u32 m0, s34, 33280
s_nop 0
global_load_lds_dwordx4 v25, s[36:37]
s_waitcnt vmcnt(28)
s_barrier
ds_read_b64_tr_b16 a[8:9], v38 offset:16384
ds_read_b64_tr_b16 a[10:11], v38 offset:17408
ds_read_b64_tr_b16 a[12:13], v38 offset:24576
ds_read_b64_tr_b16 a[14:15], v38 offset:25600
ds_read_b64_tr_b16 a[72:73], v39 offset:16384
ds_read_b64_tr_b16 a[74:75], v39 offset:17408
ds_read_b64_tr_b16 a[76:77], v39 offset:24576
ds_read_b64_tr_b16 a[78:79], v39 offset:25600
s_waitcnt lgkmcnt(0)
s_barrier
s_add_u32 s36, s58, 524288
s_addc_u32 s37, s59, 0
s_lshl_b32 s34, s11, 12
s_add_u32 m0, s34, 46592
s_nop 0
global_load_lds_dwordx4 v24, s[36:37]
s_add_u32 s36, s58, 557056
s_addc_u32 s37, s59, 0
s_lshl_b32 s34, s11, 12
s_add_u32 m0, s34, 47616
s_nop 0
global_load_lds_dwordx4 v24, s[36:37]
s_add_u32 s36, s58, 589824
s_addc_u32 s37, s59, 0
s_lshl_b32 s34, s11, 12
s_add_u32 m0, s34, 48640
s_nop 0
global_load_lds_dwordx4 v25, s[36:37]
s_add_u32 s36, s58, 622592
s_addc_u32 s37, s59, 0
s_lshl_b32 s34, s11, 12
s_add_u32 m0, s34, 49664
s_nop 0
global_load_lds_dwordx4 v25, s[36:37]
s_waitcnt vmcnt(28)
s_barrier
ds_read_b64_tr_b16 a[16:17], v38 offset:32768
ds_read_b64_tr_b16 a[18:19], v38 offset:33792
ds_read_b64_tr_b16 a[20:21], v38 offset:40960
ds_read_b64_tr_b16 a[22:23], v38 offset:41984
ds_read_b64_tr_b16 a[80:81], v39 offset:32768
ds_read_b64_tr_b16 a[82:83], v39 offset:33792
ds_read_b64_tr_b16 a[84:85], v39 offset:40960
ds_read_b64_tr_b16 a[86:87], v39 offset:41984
s_waitcnt lgkmcnt(0)
s_barrier
s_add_u32 s36, s58, 1048576
s_addc_u32 s37, s59, 0
s_lshl_b32 s34, s11, 12
s_add_u32 m0, s34, 62976
s_nop 0
global_load_lds_dwordx4 v24, s[36:37]
s_add_u32 s36, s58, 1081344
s_addc_u32 s37, s59, 0
s_lshl_b32 s34, s11, 12
s_add_u32 m0, s34, 64000
s_nop 0
global_load_lds_dwordx4 v24, s[36:37]
s_add_u32 s36, s58, 1114112
s_addc_u32 s37, s59, 0
s_lshl_b32 s34, s11, 12
s_add_u32 m0, s34, 65024
s_nop 0
global_load_lds_dwordx4 v25, s[36:37]
s_add_u32 s36, s58, 1146880
s_addc_u32 s37, s59, 0
s_lshl_b32 s34, s11, 12
s_add_u32 m0, s34, 66048
s_nop 0
global_load_lds_dwordx4 v25, s[36:37]
s_waitcnt vmcnt(28)
s_barrier
ds_read_b64_tr_b16 a[24:25], v38 offset:49152
ds_read_b64_tr_b16 a[26:27], v38 offset:50176
ds_read_b64_tr_b16 a[28:29], v38 offset:57344
ds_read_b64_tr_b16 a[30:31], v38 offset:58368
ds_read_b64_tr_b16 a[88:89], v39 offset:49152
ds_read_b64_tr_b16 a[90:91], v39 offset:50176
ds_read_b64_tr_b16 a[92:93], v39 offset:57344
ds_read_b64_tr_b16 a[94:95], v39 offset:58368
s_waitcnt lgkmcnt(0)
s_barrier
s_add_u32 s36, s58, 1572864
s_addc_u32 s37, s59, 0
s_lshl_b32 s34, s11, 12
s_add_u32 m0, s34, 79360
s_nop 0
global_load_lds_dwordx4 v24, s[36:37]
s_add_u32 s36, s58, 1605632
s_addc_u32 s37, s59, 0
s_lshl_b32 s34, s11, 12
s_add_u32 m0, s34, 80384
s_nop 0
global_load_lds_dwordx4 v24, s[36:37]
s_add_u32 s36, s58, 1638400
s_addc_u32 s37, s59, 0
s_lshl_b32 s34, s11, 12
s_add_u32 m0, s34, 81408
s_nop 0
global_load_lds_dwordx4 v25, s[36:37]
s_add_u32 s36, s58, 1671168
s_addc_u32 s37, s59, 0
s_lshl_b32 s34, s11, 12
s_add_u32 m0, s34, 82432
s_nop 0
global_load_lds_dwordx4 v25, s[36:37]
s_waitcnt vmcnt(28)
s_barrier
ds_read_b64_tr_b16 a[32:33], v36 offset:0
ds_read_b64_tr_b16 a[34:35], v36 offset:1024
ds_read_b64_tr_b16 a[36:37], v36 offset:8192
ds_read_b64_tr_b16 a[38:39], v36 offset:9216
ds_read_b64_tr_b16 a[96:97], v37 offset:0
ds_read_b64_tr_b16 a[98:99], v37 offset:1024
ds_read_b64_tr_b16 a[100:101], v37 offset:8192
ds_read_b64_tr_b16 a[102:103], v37 offset:9216
s_waitcnt lgkmcnt(0)
s_barrier
s_add_u32 s36, s58, 2097152
s_addc_u32 s37, s59, 0
s_lshl_b32 s34, s11, 12
s_add_u32 m0, s34, 95744
s_nop 0
global_load_lds_dwordx4 v24, s[36:37]
s_add_u32 s36, s58, 2129920
s_addc_u32 s37, s59, 0
s_lshl_b32 s34, s11, 12
s_add_u32 m0, s34, 96768
s_nop 0
global_load_lds_dwordx4 v24, s[36:37]
s_add_u32 s36, s58, 2162688
s_addc_u32 s37, s59, 0
s_lshl_b32 s34, s11, 12
s_add_u32 m0, s34, 97792
s_nop 0
global_load_lds_dwordx4 v25, s[36:37]
s_add_u32 s36, s58, 2195456
s_addc_u32 s37, s59, 0
s_lshl_b32 s34, s11, 12
s_add_u32 m0, s34, 98816
s_nop 0
global_load_lds_dwordx4 v25, s[36:37]
s_waitcnt vmcnt(28)
s_barrier
ds_read_b64_tr_b16 a[40:41], v36 offset:16384
ds_read_b64_tr_b16 a[42:43], v36 offset:17408
ds_read_b64_tr_b16 a[44:45], v36 offset:24576
ds_read_b64_tr_b16 a[46:47], v36 offset:25600
ds_read_b64_tr_b16 a[104:105], v37 offset:16384
ds_read_b64_tr_b16 a[106:107], v37 offset:17408
ds_read_b64_tr_b16 a[108:109], v37 offset:24576
ds_read_b64_tr_b16 a[110:111], v37 offset:25600
s_waitcnt lgkmcnt(0)
s_barrier
s_add_u32 s36, s58, 2621440
s_addc_u32 s37, s59, 0
s_lshl_b32 s34, s11, 12
s_add_u32 m0, s34, 112128
s_nop 0
global_load_lds_dwordx4 v24, s[36:37]
s_add_u32 s36, s58, 2654208
s_addc_u32 s37, s59, 0
s_lshl_b32 s34, s11, 12
s_add_u32 m0, s34, 113152
s_nop 0
global_load_lds_dwordx4 v24, s[36:37]
s_add_u32 s36, s58, 2686976
s_addc_u32 s37, s59, 0
s_lshl_b32 s34, s11, 12
s_add_u32 m0, s34, 114176
s_nop 0
global_load_lds_dwordx4 v25, s[36:37]
s_add_u32 s36, s58, 2719744
s_addc_u32 s37, s59, 0
s_lshl_b32 s34, s11, 12
s_add_u32 m0, s34, 115200
s_nop 0
global_load_lds_dwordx4 v25, s[36:37]
s_waitcnt vmcnt(28)
s_barrier
ds_read_b64_tr_b16 a[48:49], v36 offset:32768
ds_read_b64_tr_b16 a[50:51], v36 offset:33792
ds_read_b64_tr_b16 a[52:53], v36 offset:40960
ds_read_b64_tr_b16 a[54:55], v36 offset:41984
ds_read_b64_tr_b16 a[112:113], v37 offset:32768
ds_read_b64_tr_b16 a[114:115], v37 offset:33792
ds_read_b64_tr_b16 a[116:117], v37 offset:40960
ds_read_b64_tr_b16 a[118:119], v37 offset:41984
s_waitcnt lgkmcnt(0)
s_barrier
s_add_u32 s36, s58, 3145728
s_addc_u32 s37, s59, 0
s_lshl_b32 s34, s11, 12
s_add_u32 m0, s34, 128512
s_nop 0
global_load_lds_dwordx4 v24, s[36:37]
s_add_u32 s36, s58, 3178496
s_addc_u32 s37, s59, 0
s_lshl_b32 s34, s11, 12
s_add_u32 m0, s34, 129536
s_nop 0
global_load_lds_dwordx4 v24, s[36:37]
s_add_u32 s36, s58, 3211264
s_addc_u32 s37, s59, 0
s_lshl_b32 s34, s11, 12
s_add_u32 m0, s34, 130560
s_nop 0
global_load_lds_dwordx4 v25, s[36:37]
s_add_u32 s36, s58, 3244032
s_addc_u32 s37, s59, 0
s_lshl_b32 s34, s11, 12
s_add_u32 m0, s34, 131584
s_nop 0
global_load_lds_dwordx4 v25, s[36:37]
s_waitcnt vmcnt(28)
s_barrier
ds_read_b64_tr_b16 a[56:57], v36 offset:49152
ds_read_b64_tr_b16 a[58:59], v36 offset:50176
ds_read_b64_tr_b16 a[60:61], v36 offset:57344
ds_read_b64_tr_b16 a[62:63], v36 offset:58368
ds_read_b64_tr_b16 a[120:121], v37 offset:49152
ds_read_b64_tr_b16 a[122:123], v37 offset:50176
ds_read_b64_tr_b16 a[124:125], v37 offset:57344
ds_read_b64_tr_b16 a[126:127], v37 offset:58368
s_waitcnt lgkmcnt(0)
s_barrier
s_add_u32 s36, s58, 3670016
s_addc_u32 s37, s59, 0
s_lshl_b32 s34, s11, 12
s_add_u32 m0, s34, 144896
s_nop 0
global_load_lds_dwordx4 v24, s[36:37]
s_add_u32 s36, s58, 3702784
s_addc_u32 s37, s59, 0
s_lshl_b32 s34, s11, 12
s_add_u32 m0, s34, 145920
s_nop 0
global_load_lds_dwordx4 v24, s[36:37]
s_add_u32 s36, s58, 3735552
s_addc_u32 s37, s59, 0
s_lshl_b32 s34, s11, 12
s_add_u32 m0, s34, 146944
s_nop 0
global_load_lds_dwordx4 v25, s[36:37]
s_add_u32 s36, s58, 3768320
s_addc_u32 s37, s59, 0
s_lshl_b32 s34, s11, 12
s_add_u32 m0, s34, 147968
s_nop 0
global_load_lds_dwordx4 v25, s[36:37]
s_waitcnt vmcnt(28)
s_barrier
ds_read_b64_tr_b16 a[128:129], v38 offset:0
ds_read_b64_tr_b16 a[130:131], v38 offset:1024
ds_read_b64_tr_b16 a[132:133], v38 offset:8192
ds_read_b64_tr_b16 a[134:135], v38 offset:9216
ds_read_b64_tr_b16 a[192:193], v39 offset:0
ds_read_b64_tr_b16 a[194:195], v39 offset:1024
ds_read_b64_tr_b16 a[196:197], v39 offset:8192
ds_read_b64_tr_b16 a[198:199], v39 offset:9216
s_waitcnt lgkmcnt(0)
s_barrier
s_add_u32 s36, s60, 0
s_addc_u32 s37, s61, 0
s_lshl_b32 s34, s11, 12
s_add_u32 m0, s34, 30208
s_nop 0
global_load_lds_dwordx4 v24, s[36:37]
s_add_u32 s36, s60, 32768
s_addc_u32 s37, s61, 0
s_lshl_b32 s34, s11, 12
s_add_u32 m0, s34, 31232
s_nop 0
global_load_lds_dwordx4 v24, s[36:37]
s_add_u32 s36, s60, 65536
s_addc_u32 s37, s61, 0
s_lshl_b32 s34, s11, 12
s_add_u32 m0, s34, 32256
s_nop 0
global_load_lds_dwordx4 v25, s[36:37]
s_add_u32 s36, s60, 98304
s_addc_u32 s37, s61, 0
s_lshl_b32 s34, s11, 12
s_add_u32 m0, s34, 33280
s_nop 0
global_load_lds_dwordx4 v25, s[36:37]
s_waitcnt vmcnt(28)
s_barrier
ds_read_b64_tr_b16 a[136:137], v38 offset:16384
ds_read_b64_tr_b16 a[138:139], v38 offset:17408
ds_read_b64_tr_b16 a[140:141], v38 offset:24576
ds_read_b64_tr_b16 a[142:143], v38 offset:25600
ds_read_b64_tr_b16 a[200:201], v39 offset:16384
ds_read_b64_tr_b16 a[202:203], v39 offset:17408
ds_read_b64_tr_b16 a[204:205], v39 offset:24576
ds_read_b64_tr_b16 a[206:207], v39 offset:25600
s_waitcnt lgkmcnt(0)
s_barrier
s_add_u32 s36, s60, 524288
s_addc_u32 s37, s61, 0
s_lshl_b32 s34, s11, 12
s_add_u32 m0, s34, 46592
s_nop 0
global_load_lds_dwordx4 v24, s[36:37]
s_add_u32 s36, s60, 557056
s_addc_u32 s37, s61, 0
s_lshl_b32 s34, s11, 12
s_add_u32 m0, s34, 47616
s_nop 0
global_load_lds_dwordx4 v24, s[36:37]
s_add_u32 s36, s60, 589824
s_addc_u32 s37, s61, 0
s_lshl_b32 s34, s11, 12
s_add_u32 m0, s34, 48640
s_nop 0
global_load_lds_dwordx4 v25, s[36:37]
s_add_u32 s36, s60, 622592
s_addc_u32 s37, s61, 0
s_lshl_b32 s34, s11, 12
s_add_u32 m0, s34, 49664
s_nop 0
global_load_lds_dwordx4 v25, s[36:37]
s_waitcnt vmcnt(28)
s_barrier
ds_read_b64_tr_b16 a[144:145], v38 offset:32768
ds_read_b64_tr_b16 a[146:147], v38 offset:33792
ds_read_b64_tr_b16 a[148:149], v38 offset:40960
ds_read_b64_tr_b16 a[150:151], v38 offset:41984
ds_read_b64_tr_b16 a[208:209], v39 offset:32768
ds_read_b64_tr_b16 a[210:211], v39 offset:33792
ds_read_b64_tr_b16 a[212:213], v39 offset:40960
ds_read_b64_tr_b16 a[214:215], v39 offset:41984
s_waitcnt lgkmcnt(0)
s_barrier
s_add_u32 s36, s60, 1048576
s_addc_u32 s37, s61, 0
s_lshl_b32 s34, s11, 12
s_add_u32 m0, s34, 62976
s_nop 0
global_load_lds_dwordx4 v24, s[36:37]
s_add_u32 s36, s60, 1081344
s_addc_u32 s37, s61, 0
s_lshl_b32 s34, s11, 12
s_add_u32 m0, s34, 64000
s_nop 0
global_load_lds_dwordx4 v24, s[36:37]
s_add_u32 s36, s60, 1114112
s_addc_u32 s37, s61, 0
s_lshl_b32 s34, s11, 12
s_add_u32 m0, s34, 65024
s_nop 0
global_load_lds_dwordx4 v25, s[36:37]
s_add_u32 s36, s60, 1146880
s_addc_u32 s37, s61, 0
s_lshl_b32 s34, s11, 12
s_add_u32 m0, s34, 66048
s_nop 0
global_load_lds_dwordx4 v25, s[36:37]
s_waitcnt vmcnt(28)
s_barrier
ds_read_b64_tr_b16 a[152:153], v38 offset:49152
ds_read_b64_tr_b16 a[154:155], v38 offset:50176
ds_read_b64_tr_b16 a[156:157], v38 offset:57344
ds_read_b64_tr_b16 a[158:159], v38 offset:58368
ds_read_b64_tr_b16 a[216:217], v39 offset:49152
ds_read_b64_tr_b16 a[218:219], v39 offset:50176
ds_read_b64_tr_b16 a[220:221], v39 offset:57344
ds_read_b64_tr_b16 a[222:223], v39 offset:58368
s_waitcnt lgkmcnt(0)
s_barrier
s_add_u32 s36, s60, 1572864
s_addc_u32 s37, s61, 0
s_lshl_b32 s34, s11, 12
s_add_u32 m0, s34, 79360
s_nop 0
global_load_lds_dwordx4 v24, s[36:37]
s_add_u32 s36, s60, 1605632
s_addc_u32 s37, s61, 0
s_lshl_b32 s34, s11, 12
s_add_u32 m0, s34, 80384
s_nop 0
global_load_lds_dwordx4 v24, s[36:37]
s_add_u32 s36, s60, 1638400
s_addc_u32 s37, s61, 0
s_lshl_b32 s34, s11, 12
s_add_u32 m0, s34, 81408
s_nop 0
global_load_lds_dwordx4 v25, s[36:37]
s_add_u32 s36, s60, 1671168
s_addc_u32 s37, s61, 0
s_lshl_b32 s34, s11, 12
s_add_u32 m0, s34, 82432
s_nop 0
global_load_lds_dwordx4 v25, s[36:37]
s_waitcnt vmcnt(28)
s_barrier
ds_read_b64_tr_b16 a[160:161], v36 offset:0
ds_read_b64_tr_b16 a[162:163], v36 offset:1024
ds_read_b64_tr_b16 a[164:165], v36 offset:8192
ds_read_b64_tr_b16 a[166:167], v36 offset:9216
ds_read_b64_tr_b16 a[224:225], v37 offset:0
ds_read_b64_tr_b16 a[226:227], v37 offset:1024
ds_read_b64_tr_b16 a[228:229], v37 offset:8192
ds_read_b64_tr_b16 a[230:231], v37 offset:9216
s_waitcnt lgkmcnt(0)
s_barrier
s_add_u32 s36, s60, 2097152
s_addc_u32 s37, s61, 0
s_lshl_b32 s34, s11, 12
s_add_u32 m0, s34, 95744
s_nop 0
global_load_lds_dwordx4 v24, s[36:37]
s_add_u32 s36, s60, 2129920
s_addc_u32 s37, s61, 0
s_lshl_b32 s34, s11, 12
s_add_u32 m0, s34, 96768
s_nop 0
global_load_lds_dwordx4 v24, s[36:37]
s_add_u32 s36, s60, 2162688
s_addc_u32 s37, s61, 0
s_lshl_b32 s34, s11, 12
s_add_u32 m0, s34, 97792
s_nop 0
global_load_lds_dwordx4 v25, s[36:37]
s_add_u32 s36, s60, 2195456
s_addc_u32 s37, s61, 0
s_lshl_b32 s34, s11, 12
s_add_u32 m0, s34, 98816
s_nop 0
global_load_lds_dwordx4 v25, s[36:37]
s_waitcnt vmcnt(28)
s_barrier
ds_read_b64_tr_b16 a[168:169], v36 offset:16384
ds_read_b64_tr_b16 a[170:171], v36 offset:17408
ds_read_b64_tr_b16 a[172:173], v36 offset:24576
ds_read_b64_tr_b16 a[174:175], v36 offset:25600
ds_read_b64_tr_b16 a[232:233], v37 offset:16384
ds_read_b64_tr_b16 a[234:235], v37 offset:17408
ds_read_b64_tr_b16 a[236:237], v37 offset:24576
ds_read_b64_tr_b16 a[238:239], v37 offset:25600
s_waitcnt lgkmcnt(0)
s_barrier
s_add_u32 s36, s60, 2621440
s_addc_u32 s37, s61, 0
s_lshl_b32 s34, s11, 12
s_add_u32 m0, s34, 112128
s_nop 0
global_load_lds_dwordx4 v24, s[36:37]
s_add_u32 s36, s60, 2654208
s_addc_u32 s37, s61, 0
s_lshl_b32 s34, s11, 12
s_add_u32 m0, s34, 113152
s_nop 0
global_load_lds_dwordx4 v24, s[36:37]
s_add_u32 s36, s60, 2686976
s_addc_u32 s37, s61, 0
s_lshl_b32 s34, s11, 12
s_add_u32 m0, s34, 114176
s_nop 0
global_load_lds_dwordx4 v25, s[36:37]
s_add_u32 s36, s60, 2719744
s_addc_u32 s37, s61, 0
s_lshl_b32 s34, s11, 12
s_add_u32 m0, s34, 115200
s_nop 0
global_load_lds_dwordx4 v25, s[36:37]
s_waitcnt vmcnt(28)
s_barrier
ds_read_b64_tr_b16 a[176:177], v36 offset:32768
ds_read_b64_tr_b16 a[178:179], v36 offset:33792
ds_read_b64_tr_b16 a[180:181], v36 offset:40960
ds_read_b64_tr_b16 a[182:183], v36 offset:41984
ds_read_b64_tr_b16 a[240:241], v37 offset:32768
ds_read_b64_tr_b16 a[242:243], v37 offset:33792
ds_read_b64_tr_b16 a[244:245], v37 offset:40960
ds_read_b64_tr_b16 a[246:247], v37 offset:41984
s_waitcnt lgkmcnt(0)
s_barrier
s_add_u32 s36, s60, 3145728
s_addc_u32 s37, s61, 0
s_lshl_b32 s34, s11, 12
s_add_u32 m0, s34, 128512
s_nop 0
global_load_lds_dwordx4 v24, s[36:37]
s_add_u32 s36, s60, 3178496
s_addc_u32 s37, s61, 0
s_lshl_b32 s34, s11, 12
s_add_u32 m0, s34, 129536
s_nop 0
global_load_lds_dwordx4 v24, s[36:37]
s_add_u32 s36, s60, 3211264
s_addc_u32 s37, s61, 0
s_lshl_b32 s34, s11, 12
s_add_u32 m0, s34, 130560
s_nop 0
global_load_lds_dwordx4 v25, s[36:37]
s_add_u32 s36, s60, 3244032
s_addc_u32 s37, s61, 0
s_lshl_b32 s34, s11, 12
s_add_u32 m0, s34, 131584
s_nop 0
global_load_lds_dwordx4 v25, s[36:37]
s_waitcnt vmcnt(28)
s_barrier
ds_read_b64_tr_b16 a[184:185], v36 offset:49152
ds_read_b64_tr_b16 a[186:187], v36 offset:50176
ds_read_b64_tr_b16 a[188:189], v36 offset:57344
ds_read_b64_tr_b16 a[190:191], v36 offset:58368
ds_read_b64_tr_b16 a[248:249], v37 offset:49152
ds_read_b64_tr_b16 a[250:251], v37 offset:50176
ds_read_b64_tr_b16 a[252:253], v37 offset:57344
ds_read_b64_tr_b16 a[254:255], v37 offset:58368
s_waitcnt lgkmcnt(0)
s_barrier
s_add_u32 s36, s60, 3670016
s_addc_u32 s37, s61, 0
s_lshl_b32 s34, s11, 12
s_add_u32 m0, s34, 144896
s_nop 0
global_load_lds_dwordx4 v24, s[36:37]
s_add_u32 s36, s60, 3702784
s_addc_u32 s37, s61, 0
s_lshl_b32 s34, s11, 12
s_add_u32 m0, s34, 145920
s_nop 0
global_load_lds_dwordx4 v24, s[36:37]
s_add_u32 s36, s60, 3735552
s_addc_u32 s37, s61, 0
s_lshl_b32 s34, s11, 12
s_add_u32 m0, s34, 146944
s_nop 0
global_load_lds_dwordx4 v25, s[36:37]
s_add_u32 s36, s60, 3768320
s_addc_u32 s37, s61, 0
s_lshl_b32 s34, s11, 12
s_add_u32 m0, s34, 147968
s_nop 0
global_load_lds_dwordx4 v25, s[36:37]
s_waitcnt vmcnt(28)
s_barrier
ds_read_b64_tr_b16 v[128:129], v38 offset:0
ds_read_b64_tr_b16 v[130:131], v38 offset:1024
ds_read_b64_tr_b16 v[132:133], v38 offset:8192
ds_read_b64_tr_b16 v[134:135], v38 offset:9216
ds_read_b64_tr_b16 v[192:193], v39 offset:0
ds_read_b64_tr_b16 v[194:195], v39 offset:1024
ds_read_b64_tr_b16 v[196:197], v39 offset:8192
ds_read_b64_tr_b16 v[198:199], v39 offset:9216
s_waitcnt lgkmcnt(0)
s_barrier
s_lshr_b32 s34, s11, 1
s_lshl_b32 s34, s34, 3
s_add_u32 s34, s34, 0
v_xor_b32 v35, s34, v0
v_lshlrev_b32 v35, 4, v35
s_lshl_b32 s34, s10, 17
s_lshl_b32 s35, s11, 12
s_add_u32 s34, s34, s35
s_add_u32 s34, s34, 0
s_add_u32 s36, s62, s34
s_addc_u32 s37, s63, 0
s_lshl_b32 s34, s11, 12
s_add_u32 m0, s34, 30208
s_nop 0
global_load_lds_dwordx4 v35, s[36:37]
s_lshr_b32 s34, s11, 1
s_lshl_b32 s34, s34, 3
s_add_u32 s34, s34, 2
v_xor_b32 v35, s34, v0
v_lshlrev_b32 v35, 4, v35
s_lshl_b32 s34, s10, 17
s_lshl_b32 s35, s11, 12
s_add_u32 s34, s34, s35
s_add_u32 s34, s34, 1024
s_add_u32 s36, s62, s34
s_addc_u32 s37, s63, 0
s_lshl_b32 s34, s11, 12
s_add_u32 m0, s34, 31232
s_nop 0
global_load_lds_dwordx4 v35, s[36:37]
s_lshr_b32 s34, s11, 1
s_lshl_b32 s34, s34, 3
s_add_u32 s34, s34, 4
v_xor_b32 v35, s34, v0
v_lshlrev_b32 v35, 4, v35
s_lshl_b32 s34, s10, 17
s_lshl_b32 s35, s11, 12
s_add_u32 s34, s34, s35
s_add_u32 s34, s34, 2048
s_add_u32 s36, s62, s34
s_addc_u32 s37, s63, 0
s_lshl_b32 s34, s11, 12
s_add_u32 m0, s34, 32256
s_nop 0
global_load_lds_dwordx4 v35, s[36:37]
s_lshr_b32 s34, s11, 1
s_lshl_b32 s34, s34, 3
s_add_u32 s34, s34, 6
v_xor_b32 v35, s34, v0
v_lshlrev_b32 v35, 4, v35
s_lshl_b32 s34, s10, 17
s_lshl_b32 s35, s11, 12
s_add_u32 s34, s34, s35
s_add_u32 s34, s34, 3072
s_add_u32 s36, s62, s34
s_addc_u32 s37, s63, 0
s_lshl_b32 s34, s11, 12
s_add_u32 m0, s34, 33280
s_nop 0
global_load_lds_dwordx4 v35, s[36:37]
s_waitcnt vmcnt(28)
s_barrier
ds_read_b64_tr_b16 v[136:137], v38 offset:16384
ds_read_b64_tr_b16 v[138:139], v38 offset:17408
ds_read_b64_tr_b16 v[140:141], v38 offset:24576
ds_read_b64_tr_b16 v[142:143], v38 offset:25600
ds_read_b64_tr_b16 v[200:201], v39 offset:16384
ds_read_b64_tr_b16 v[202:203], v39 offset:17408
ds_read_b64_tr_b16 v[204:205], v39 offset:24576
ds_read_b64_tr_b16 v[206:207], v39 offset:25600
s_waitcnt lgkmcnt(0)
s_barrier
s_lshr_b32 s34, s11, 1
s_lshl_b32 s34, s34, 3
s_add_u32 s34, s34, 0
v_xor_b32 v35, s34, v0
v_lshlrev_b32 v35, 4, v35
s_lshl_b32 s34, s10, 17
s_lshl_b32 s35, s11, 12
s_add_u32 s34, s34, s35
s_add_u32 s34, s34, 16384
s_add_u32 s36, s62, s34
s_addc_u32 s37, s63, 0
s_lshl_b32 s34, s11, 12
s_add_u32 m0, s34, 46592
s_nop 0
global_load_lds_dwordx4 v35, s[36:37]
s_lshr_b32 s34, s11, 1
s_lshl_b32 s34, s34, 3
s_add_u32 s34, s34, 2
v_xor_b32 v35, s34, v0
v_lshlrev_b32 v35, 4, v35
s_lshl_b32 s34, s10, 17
s_lshl_b32 s35, s11, 12
s_add_u32 s34, s34, s35
s_add_u32 s34, s34, 17408
s_add_u32 s36, s62, s34
s_addc_u32 s37, s63, 0
s_lshl_b32 s34, s11, 12
s_add_u32 m0, s34, 47616
s_nop 0
global_load_lds_dwordx4 v35, s[36:37]
s_lshr_b32 s34, s11, 1
s_lshl_b32 s34, s34, 3
s_add_u32 s34, s34, 4
v_xor_b32 v35, s34, v0
v_lshlrev_b32 v35, 4, v35
s_lshl_b32 s34, s10, 17
s_lshl_b32 s35, s11, 12
s_add_u32 s34, s34, s35
s_add_u32 s34, s34, 18432
s_add_u32 s36, s62, s34
s_addc_u32 s37, s63, 0
s_lshl_b32 s34, s11, 12
s_add_u32 m0, s34, 48640
s_nop 0
global_load_lds_dwordx4 v35, s[36:37]
s_lshr_b32 s34, s11, 1
s_lshl_b32 s34, s34, 3
s_add_u32 s34, s34, 6
v_xor_b32 v35, s34, v0
v_lshlrev_b32 v35, 4, v35
s_lshl_b32 s34, s10, 17
s_lshl_b32 s35, s11, 12
s_add_u32 s34, s34, s35
s_add_u32 s34, s34, 19456
s_add_u32 s36, s62, s34
s_addc_u32 s37, s63, 0
s_lshl_b32 s34, s11, 12
s_add_u32 m0, s34, 49664
s_nop 0
global_load_lds_dwordx4 v35, s[36:37]
s_waitcnt vmcnt(28)
s_barrier
ds_read_b64_tr_b16 v[144:145], v38 offset:32768
ds_read_b64_tr_b16 v[146:147], v38 offset:33792
ds_read_b64_tr_b16 v[148:149], v38 offset:40960
ds_read_b64_tr_b16 v[150:151], v38 offset:41984
ds_read_b64_tr_b16 v[208:209], v39 offset:32768
ds_read_b64_tr_b16 v[210:211], v39 offset:33792
ds_read_b64_tr_b16 v[212:213], v39 offset:40960
ds_read_b64_tr_b16 v[214:215], v39 offset:41984
s_waitcnt lgkmcnt(0)
s_barrier
s_lshr_b32 s34, s11, 1
s_lshl_b32 s34, s34, 3
s_add_u32 s34, s34, 0
v_xor_b32 v35, s34, v0
v_lshlrev_b32 v35, 4, v35
s_lshl_b32 s34, s10, 17
s_lshl_b32 s35, s11, 12
s_add_u32 s34, s34, s35
s_add_u32 s34, s34, 32768
s_add_u32 s36, s62, s34
s_addc_u32 s37, s63, 0
s_lshl_b32 s34, s11, 12
s_add_u32 m0, s34, 62976
s_nop 0
global_load_lds_dwordx4 v35, s[36:37]
s_lshr_b32 s34, s11, 1
s_lshl_b32 s34, s34, 3
s_add_u32 s34, s34, 2
v_xor_b32 v35, s34, v0
v_lshlrev_b32 v35, 4, v35
s_lshl_b32 s34, s10, 17
s_lshl_b32 s35, s11, 12
s_add_u32 s34, s34, s35
s_add_u32 s34, s34, 33792
s_add_u32 s36, s62, s34
s_addc_u32 s37, s63, 0
s_lshl_b32 s34, s11, 12
s_add_u32 m0, s34, 64000
s_nop 0
global_load_lds_dwordx4 v35, s[36:37]
s_lshr_b32 s34, s11, 1
s_lshl_b32 s34, s34, 3
s_add_u32 s34, s34, 4
v_xor_b32 v35, s34, v0
v_lshlrev_b32 v35, 4, v35
s_lshl_b32 s34, s10, 17
s_lshl_b32 s35, s11, 12
s_add_u32 s34, s34, s35
s_add_u32 s34, s34, 34816
s_add_u32 s36, s62, s34
s_addc_u32 s37, s63, 0
s_lshl_b32 s34, s11, 12
s_add_u32 m0, s34, 65024
s_nop 0
global_load_lds_dwordx4 v35, s[36:37]
s_lshr_b32 s34, s11, 1
s_lshl_b32 s34, s34, 3
s_add_u32 s34, s34, 6
v_xor_b32 v35, s34, v0
v_lshlrev_b32 v35, 4, v35
s_lshl_b32 s34, s10, 17
s_lshl_b32 s35, s11, 12
s_add_u32 s34, s34, s35
s_add_u32 s34, s34, 35840
s_add_u32 s36, s62, s34
s_addc_u32 s37, s63, 0
s_lshl_b32 s34, s11, 12
s_add_u32 m0, s34, 66048
s_nop 0
global_load_lds_dwordx4 v35, s[36:37]
s_waitcnt vmcnt(28)
s_barrier
ds_read_b64_tr_b16 v[152:153], v38 offset:49152
ds_read_b64_tr_b16 v[154:155], v38 offset:50176
ds_read_b64_tr_b16 v[156:157], v38 offset:57344
ds_read_b64_tr_b16 v[158:159], v38 offset:58368
ds_read_b64_tr_b16 v[216:217], v39 offset:49152
ds_read_b64_tr_b16 v[218:219], v39 offset:50176
ds_read_b64_tr_b16 v[220:221], v39 offset:57344
ds_read_b64_tr_b16 v[222:223], v39 offset:58368
s_waitcnt lgkmcnt(0)
s_barrier
s_lshr_b32 s34, s11, 1
s_lshl_b32 s34, s34, 3
s_add_u32 s34, s34, 0
v_xor_b32 v35, s34, v0
v_lshlrev_b32 v35, 4, v35
s_lshl_b32 s34, s10, 17
s_lshl_b32 s35, s11, 12
s_add_u32 s34, s34, s35
s_add_u32 s34, s34, 49152
s_add_u32 s36, s62, s34
s_addc_u32 s37, s63, 0
s_lshl_b32 s34, s11, 12
s_add_u32 m0, s34, 79360
s_nop 0
global_load_lds_dwordx4 v35, s[36:37]
s_lshr_b32 s34, s11, 1
s_lshl_b32 s34, s34, 3
s_add_u32 s34, s34, 2
v_xor_b32 v35, s34, v0
v_lshlrev_b32 v35, 4, v35
s_lshl_b32 s34, s10, 17
s_lshl_b32 s35, s11, 12
s_add_u32 s34, s34, s35
s_add_u32 s34, s34, 50176
s_add_u32 s36, s62, s34
s_addc_u32 s37, s63, 0
s_lshl_b32 s34, s11, 12
s_add_u32 m0, s34, 80384
s_nop 0
global_load_lds_dwordx4 v35, s[36:37]
s_lshr_b32 s34, s11, 1
s_lshl_b32 s34, s34, 3
s_add_u32 s34, s34, 4
v_xor_b32 v35, s34, v0
v_lshlrev_b32 v35, 4, v35
s_lshl_b32 s34, s10, 17
s_lshl_b32 s35, s11, 12
s_add_u32 s34, s34, s35
s_add_u32 s34, s34, 51200
s_add_u32 s36, s62, s34
s_addc_u32 s37, s63, 0
s_lshl_b32 s34, s11, 12
s_add_u32 m0, s34, 81408
s_nop 0
global_load_lds_dwordx4 v35, s[36:37]
s_lshr_b32 s34, s11, 1
s_lshl_b32 s34, s34, 3
s_add_u32 s34, s34, 6
v_xor_b32 v35, s34, v0
v_lshlrev_b32 v35, 4, v35
s_lshl_b32 s34, s10, 17
s_lshl_b32 s35, s11, 12
s_add_u32 s34, s34, s35
s_add_u32 s34, s34, 52224
s_add_u32 s36, s62, s34
s_addc_u32 s37, s63, 0
s_lshl_b32 s34, s11, 12
s_add_u32 m0, s34, 82432
s_nop 0
global_load_lds_dwordx4 v35, s[36:37]
s_waitcnt vmcnt(28)
s_barrier
ds_read_b64_tr_b16 v[160:161], v36 offset:0
ds_read_b64_tr_b16 v[162:163], v36 offset:1024
ds_read_b64_tr_b16 v[164:165], v36 offset:8192
ds_read_b64_tr_b16 v[166:167], v36 offset:9216
ds_read_b64_tr_b16 v[224:225], v37 offset:0
ds_read_b64_tr_b16 v[226:227], v37 offset:1024
ds_read_b64_tr_b16 v[228:229], v37 offset:8192
ds_read_b64_tr_b16 v[230:231], v37 offset:9216
s_waitcnt lgkmcnt(0)
s_barrier
s_lshr_b32 s34, s11, 1
s_lshl_b32 s34, s34, 3
s_add_u32 s34, s34, 0
v_xor_b32 v35, s34, v0
v_lshlrev_b32 v35, 4, v35
s_lshl_b32 s34, s10, 17
s_lshl_b32 s35, s11, 12
s_add_u32 s34, s34, s35
s_add_u32 s34, s34, 65536
s_add_u32 s36, s62, s34
s_addc_u32 s37, s63, 0
s_lshl_b32 s34, s11, 12
s_add_u32 m0, s34, 95744
s_nop 0
global_load_lds_dwordx4 v35, s[36:37]
s_lshr_b32 s34, s11, 1
s_lshl_b32 s34, s34, 3
s_add_u32 s34, s34, 2
v_xor_b32 v35, s34, v0
v_lshlrev_b32 v35, 4, v35
s_lshl_b32 s34, s10, 17
s_lshl_b32 s35, s11, 12
s_add_u32 s34, s34, s35
s_add_u32 s34, s34, 66560
s_add_u32 s36, s62, s34
s_addc_u32 s37, s63, 0
s_lshl_b32 s34, s11, 12
s_add_u32 m0, s34, 96768
s_nop 0
global_load_lds_dwordx4 v35, s[36:37]
s_lshr_b32 s34, s11, 1
s_lshl_b32 s34, s34, 3
s_add_u32 s34, s34, 4
v_xor_b32 v35, s34, v0
v_lshlrev_b32 v35, 4, v35
s_lshl_b32 s34, s10, 17
s_lshl_b32 s35, s11, 12
s_add_u32 s34, s34, s35
s_add_u32 s34, s34, 67584
s_add_u32 s36, s62, s34
s_addc_u32 s37, s63, 0
s_lshl_b32 s34, s11, 12
s_add_u32 m0, s34, 97792
s_nop 0
global_load_lds_dwordx4 v35, s[36:37]
s_lshr_b32 s34, s11, 1
s_lshl_b32 s34, s34, 3
s_add_u32 s34, s34, 6
v_xor_b32 v35, s34, v0
v_lshlrev_b32 v35, 4, v35
s_lshl_b32 s34, s10, 17
s_lshl_b32 s35, s11, 12
s_add_u32 s34, s34, s35
s_add_u32 s34, s34, 68608
s_add_u32 s36, s62, s34
s_addc_u32 s37, s63, 0
s_lshl_b32 s34, s11, 12
s_add_u32 m0, s34, 98816
s_nop 0
global_load_lds_dwordx4 v35, s[36:37]
s_waitcnt vmcnt(28)
s_barrier
ds_read_b64_tr_b16 v[168:169], v36 offset:16384
ds_read_b64_tr_b16 v[170:171], v36 offset:17408
ds_read_b64_tr_b16 v[172:173], v36 offset:24576
ds_read_b64_tr_b16 v[174:175], v36 offset:25600
ds_read_b64_tr_b16 v[232:233], v37 offset:16384
ds_read_b64_tr_b16 v[234:235], v37 offset:17408
ds_read_b64_tr_b16 v[236:237], v37 offset:24576
ds_read_b64_tr_b16 v[238:239], v37 offset:25600
s_waitcnt lgkmcnt(0)
s_barrier
s_lshr_b32 s34, s11, 1
s_lshl_b32 s34, s34, 3
s_add_u32 s34, s34, 0
v_xor_b32 v35, s34, v0
v_lshlrev_b32 v35, 4, v35
s_lshl_b32 s34, s10, 17
s_lshl_b32 s35, s11, 12
s_add_u32 s34, s34, s35
s_add_u32 s34, s34, 81920
s_add_u32 s36, s62, s34
s_addc_u32 s37, s63, 0
s_lshl_b32 s34, s11, 12
s_add_u32 m0, s34, 112128
s_nop 0
global_load_lds_dwordx4 v35, s[36:37]
s_lshr_b32 s34, s11, 1
s_lshl_b32 s34, s34, 3
s_add_u32 s34, s34, 2
v_xor_b32 v35, s34, v0
v_lshlrev_b32 v35, 4, v35
s_lshl_b32 s34, s10, 17
s_lshl_b32 s35, s11, 12
s_add_u32 s34, s34, s35
s_add_u32 s34, s34, 82944
s_add_u32 s36, s62, s34
s_addc_u32 s37, s63, 0
s_lshl_b32 s34, s11, 12
s_add_u32 m0, s34, 113152
s_nop 0
global_load_lds_dwordx4 v35, s[36:37]
s_lshr_b32 s34, s11, 1
s_lshl_b32 s34, s34, 3
s_add_u32 s34, s34, 4
v_xor_b32 v35, s34, v0
v_lshlrev_b32 v35, 4, v35
s_lshl_b32 s34, s10, 17
s_lshl_b32 s35, s11, 12
s_add_u32 s34, s34, s35
s_add_u32 s34, s34, 83968
s_add_u32 s36, s62, s34
s_addc_u32 s37, s63, 0
s_lshl_b32 s34, s11, 12
s_add_u32 m0, s34, 114176
s_nop 0
global_load_lds_dwordx4 v35, s[36:37]
s_lshr_b32 s34, s11, 1
s_lshl_b32 s34, s34, 3
s_add_u32 s34, s34, 6
v_xor_b32 v35, s34, v0
v_lshlrev_b32 v35, 4, v35
s_lshl_b32 s34, s10, 17
s_lshl_b32 s35, s11, 12
s_add_u32 s34, s34, s35
s_add_u32 s34, s34, 84992
s_add_u32 s36, s62, s34
s_addc_u32 s37, s63, 0
s_lshl_b32 s34, s11, 12
s_add_u32 m0, s34, 115200
s_nop 0
global_load_lds_dwordx4 v35, s[36:37]
s_waitcnt vmcnt(28)
s_barrier
ds_read_b64_tr_b16 v[176:177], v36 offset:32768
ds_read_b64_tr_b16 v[178:179], v36 offset:33792
ds_read_b64_tr_b16 v[180:181], v36 offset:40960
ds_read_b64_tr_b16 v[182:183], v36 offset:41984
ds_read_b64_tr_b16 v[240:241], v37 offset:32768
ds_read_b64_tr_b16 v[242:243], v37 offset:33792
ds_read_b64_tr_b16 v[244:245], v37 offset:40960
ds_read_b64_tr_b16 v[246:247], v37 offset:41984
s_waitcnt lgkmcnt(0)
s_barrier
s_lshr_b32 s34, s11, 1
s_lshl_b32 s34, s34, 3
s_add_u32 s34, s34, 0
v_xor_b32 v35, s34, v0
v_lshlrev_b32 v35, 4, v35
s_lshl_b32 s34, s10, 17
s_lshl_b32 s35, s11, 12
s_add_u32 s34, s34, s35
s_add_u32 s34, s34, 98304
s_add_u32 s36, s62, s34
s_addc_u32 s37, s63, 0
s_lshl_b32 s34, s11, 12
s_add_u32 m0, s34, 128512
s_nop 0
global_load_lds_dwordx4 v35, s[36:37]
s_lshr_b32 s34, s11, 1
s_lshl_b32 s34, s34, 3
s_add_u32 s34, s34, 2
v_xor_b32 v35, s34, v0
v_lshlrev_b32 v35, 4, v35
s_lshl_b32 s34, s10, 17
s_lshl_b32 s35, s11, 12
s_add_u32 s34, s34, s35
s_add_u32 s34, s34, 99328
s_add_u32 s36, s62, s34
s_addc_u32 s37, s63, 0
s_lshl_b32 s34, s11, 12
s_add_u32 m0, s34, 129536
s_nop 0
global_load_lds_dwordx4 v35, s[36:37]
s_lshr_b32 s34, s11, 1
s_lshl_b32 s34, s34, 3
s_add_u32 s34, s34, 4
v_xor_b32 v35, s34, v0
v_lshlrev_b32 v35, 4, v35
s_lshl_b32 s34, s10, 17
s_lshl_b32 s35, s11, 12
s_add_u32 s34, s34, s35
s_add_u32 s34, s34, 100352
s_add_u32 s36, s62, s34
s_addc_u32 s37, s63, 0
s_lshl_b32 s34, s11, 12
s_add_u32 m0, s34, 130560
s_nop 0
global_load_lds_dwordx4 v35, s[36:37]
s_lshr_b32 s34, s11, 1
s_lshl_b32 s34, s34, 3
s_add_u32 s34, s34, 6
v_xor_b32 v35, s34, v0
v_lshlrev_b32 v35, 4, v35
s_lshl_b32 s34, s10, 17
s_lshl_b32 s35, s11, 12
s_add_u32 s34, s34, s35
s_add_u32 s34, s34, 101376
s_add_u32 s36, s62, s34
s_addc_u32 s37, s63, 0
s_lshl_b32 s34, s11, 12
s_add_u32 m0, s34, 131584
s_nop 0
global_load_lds_dwordx4 v35, s[36:37]
s_waitcnt vmcnt(28)
s_barrier
ds_read_b64_tr_b16 v[184:185], v36 offset:49152
ds_read_b64_tr_b16 v[186:187], v36 offset:50176
ds_read_b64_tr_b16 v[188:189], v36 offset:57344
ds_read_b64_tr_b16 v[190:191], v36 offset:58368
ds_read_b64_tr_b16 v[248:249], v37 offset:49152
ds_read_b64_tr_b16 v[250:251], v37 offset:50176
ds_read_b64_tr_b16 v[252:253], v37 offset:57344
ds_read_b64_tr_b16 v[254:255], v37 offset:58368
s_waitcnt lgkmcnt(0)
s_barrier
s_lshr_b32 s34, s11, 1
s_lshl_b32 s34, s34, 3
s_add_u32 s34, s34, 0
v_xor_b32 v35, s34, v0
v_lshlrev_b32 v35, 4, v35
s_lshl_b32 s34, s10, 17
s_lshl_b32 s35, s11, 12
s_add_u32 s34, s34, s35
s_add_u32 s34, s34, 114688
s_add_u32 s36, s62, s34
s_addc_u32 s37, s63, 0
s_lshl_b32 s34, s11, 12
s_add_u32 m0, s34, 144896
s_nop 0
global_load_lds_dwordx4 v35, s[36:37]
s_lshr_b32 s34, s11, 1
s_lshl_b32 s34, s34, 3
s_add_u32 s34, s34, 2
v_xor_b32 v35, s34, v0
v_lshlrev_b32 v35, 4, v35
s_lshl_b32 s34, s10, 17
s_lshl_b32 s35, s11, 12
s_add_u32 s34, s34, s35
s_add_u32 s34, s34, 115712
s_add_u32 s36, s62, s34
s_addc_u32 s37, s63, 0
s_lshl_b32 s34, s11, 12
s_add_u32 m0, s34, 145920
s_nop 0
global_load_lds_dwordx4 v35, s[36:37]
s_lshr_b32 s34, s11, 1
s_lshl_b32 s34, s34, 3
s_add_u32 s34, s34, 4
v_xor_b32 v35, s34, v0
v_lshlrev_b32 v35, 4, v35
s_lshl_b32 s34, s10, 17
s_lshl_b32 s35, s11, 12
s_add_u32 s34, s34, s35
s_add_u32 s34, s34, 116736
s_add_u32 s36, s62, s34
s_addc_u32 s37, s63, 0
s_lshl_b32 s34, s11, 12
s_add_u32 m0, s34, 146944
s_nop 0
global_load_lds_dwordx4 v35, s[36:37]
s_lshr_b32 s34, s11, 1
s_lshl_b32 s34, s34, 3
s_add_u32 s34, s34, 6
v_xor_b32 v35, s34, v0
v_lshlrev_b32 v35, 4, v35
s_lshl_b32 s34, s10, 17
s_lshl_b32 s35, s11, 12
s_add_u32 s34, s34, s35
s_add_u32 s34, s34, 117760
s_add_u32 s36, s62, s34
s_addc_u32 s37, s63, 0
s_lshl_b32 s34, s11, 12
s_add_u32 m0, s34, 147968
s_nop 0
global_load_lds_dwordx4 v35, s[36:37]
s_waitcnt vmcnt(16)
s_barrier
v_xor_b32 v35, 0, v34
v_lshlrev_b32 v35, 4, v35
v_add_u32 v35, v35, v33
ds_read_b64_tr_b16 v[48:49], v35 offset:0
ds_read_b64_tr_b16 v[52:53], v35 offset:16384
ds_read_b64_tr_b16 v[56:57], v35 offset:32768
ds_read_b64_tr_b16 v[60:61], v35 offset:49152
v_xor_b32 v35, 4, v34
v_lshlrev_b32 v35, 4, v35
v_add_u32 v35, v35, v33
ds_read_b64_tr_b16 v[50:51], v35 offset:2048
ds_read_b64_tr_b16 v[54:55], v35 offset:18432
ds_read_b64_tr_b16 v[58:59], v35 offset:34816
ds_read_b64_tr_b16 v[62:63], v35 offset:51200
v_xor_b32 v35, 4, v34
v_lshlrev_b32 v35, 4, v35
v_add_u32 v35, v35, v33
ds_read_b64_tr_b16 v[64:65], v35 offset:0
ds_read_b64_tr_b16 v[68:69], v35 offset:16384
ds_read_b64_tr_b16 v[72:73], v35 offset:32768
ds_read_b64_tr_b16 v[76:77], v35 offset:49152
v_xor_b32 v35, 0, v34
v_lshlrev_b32 v35, 4, v35
v_add_u32 v35, v35, v33
ds_read_b64_tr_b16 v[66:67], v35 offset:2048
ds_read_b64_tr_b16 v[70:71], v35 offset:18432
ds_read_b64_tr_b16 v[74:75], v35 offset:34816
ds_read_b64_tr_b16 v[78:79], v35 offset:51200
v_xor_b32 v35, 8, v34
v_lshlrev_b32 v35, 4, v35
v_add_u32 v35, v35, v33
ds_read_b64_tr_b16 v[80:81], v35 offset:0
ds_read_b64_tr_b16 v[84:85], v35 offset:16384
ds_read_b64_tr_b16 v[88:89], v35 offset:32768
ds_read_b64_tr_b16 v[92:93], v35 offset:49152
v_xor_b32 v35, 12, v34
v_lshlrev_b32 v35, 4, v35
v_add_u32 v35, v35, v33
ds_read_b64_tr_b16 v[82:83], v35 offset:2048
ds_read_b64_tr_b16 v[86:87], v35 offset:18432
ds_read_b64_tr_b16 v[90:91], v35 offset:34816
ds_read_b64_tr_b16 v[94:95], v35 offset:51200
v_xor_b32 v35, 12, v34
v_lshlrev_b32 v35, 4, v35
v_add_u32 v35, v35, v33
ds_read_b64_tr_b16 v[96:97], v35 offset:0
ds_read_b64_tr_b16 v[100:101], v35 offset:16384
ds_read_b64_tr_b16 v[104:105], v35 offset:32768
ds_read_b64_tr_b16 v[108:109], v35 offset:49152
v_xor_b32 v35, 8, v34
v_lshlrev_b32 v35, 4, v35
v_add_u32 v35, v35, v33
ds_read_b64_tr_b16 v[98:99], v35 offset:2048
ds_read_b64_tr_b16 v[102:103], v35 offset:18432
ds_read_b64_tr_b16 v[106:107], v35 offset:34816
ds_read_b64_tr_b16 v[110:111], v35 offset:51200
s_waitcnt lgkmcnt(0)
s_barrier
ds_write_b128 v5, v[48:51] offset:0
ds_write_b128 v5, v[52:55] offset:1024
ds_write_b128 v5, v[56:59] offset:2048
ds_write_b128 v5, v[60:63] offset:3072
ds_write_b128 v5, v[64:67] offset:4096
ds_write_b128 v5, v[68:71] offset:5120
ds_write_b128 v5, v[72:75] offset:6144
ds_write_b128 v5, v[76:79] offset:7168
ds_write_b128 v5, v[80:83] offset:8192
ds_write_b128 v5, v[84:87] offset:9216
ds_write_b128 v5, v[88:91] offset:10240
ds_write_b128 v5, v[92:95] offset:11264
ds_write_b128 v5, v[96:99] offset:12288
ds_write_b128 v5, v[100:103] offset:13312
ds_write_b128 v5, v[104:107] offset:14336
ds_write_b128 v5, v[108:111] offset:15360
s_waitcnt lgkmcnt(0)
s_waitcnt vmcnt(0)
s_barrier
v_xor_b32 v35, 0, v34
v_lshlrev_b32 v35, 4, v35
v_add_u32 v35, v35, v33
v_add_u32 v35, 0x10000, v35
ds_read_b64_tr_b16 v[48:49], v35 offset:0
ds_read_b64_tr_b16 v[52:53], v35 offset:16384
ds_read_b64_tr_b16 v[56:57], v35 offset:32768
ds_read_b64_tr_b16 v[60:61], v35 offset:49152
v_xor_b32 v35, 4, v34
v_lshlrev_b32 v35, 4, v35
v_add_u32 v35, v35, v33
v_add_u32 v35, 0x10000, v35
ds_read_b64_tr_b16 v[50:51], v35 offset:2048
ds_read_b64_tr_b16 v[54:55], v35 offset:18432
ds_read_b64_tr_b16 v[58:59], v35 offset:34816
ds_read_b64_tr_b16 v[62:63], v35 offset:51200
v_xor_b32 v35, 4, v34
v_lshlrev_b32 v35, 4, v35
v_add_u32 v35, v35, v33
v_add_u32 v35, 0x10000, v35
ds_read_b64_tr_b16 v[64:65], v35 offset:0
ds_read_b64_tr_b16 v[68:69], v35 offset:16384
ds_read_b64_tr_b16 v[72:73], v35 offset:32768
ds_read_b64_tr_b16 v[76:77], v35 offset:49152
v_xor_b32 v35, 0, v34
v_lshlrev_b32 v35, 4, v35
v_add_u32 v35, v35, v33
v_add_u32 v35, 0x10000, v35
ds_read_b64_tr_b16 v[66:67], v35 offset:2048
ds_read_b64_tr_b16 v[70:71], v35 offset:18432
ds_read_b64_tr_b16 v[74:75], v35 offset:34816
ds_read_b64_tr_b16 v[78:79], v35 offset:51200
v_xor_b32 v35, 8, v34
v_lshlrev_b32 v35, 4, v35
v_add_u32 v35, v35, v33
v_add_u32 v35, 0x10000, v35
ds_read_b64_tr_b16 v[80:81], v35 offset:0
ds_read_b64_tr_b16 v[84:85], v35 offset:16384
ds_read_b64_tr_b16 v[88:89], v35 offset:32768
ds_read_b64_tr_b16 v[92:93], v35 offset:49152
v_xor_b32 v35, 12, v34
v_lshlrev_b32 v35, 4, v35
v_add_u32 v35, v35, v33
v_add_u32 v35, 0x10000, v35
ds_read_b64_tr_b16 v[82:83], v35 offset:2048
ds_read_b64_tr_b16 v[86:87], v35 offset:18432
ds_read_b64_tr_b16 v[90:91], v35 offset:34816
ds_read_b64_tr_b16 v[94:95], v35 offset:51200
v_xor_b32 v35, 12, v34
v_lshlrev_b32 v35, 4, v35
v_add_u32 v35, v35, v33
v_add_u32 v35, 0x10000, v35
ds_read_b64_tr_b16 v[96:97], v35 offset:0
ds_read_b64_tr_b16 v[100:101], v35 offset:16384
ds_read_b64_tr_b16 v[104:105], v35 offset:32768
ds_read_b64_tr_b16 v[108:109], v35 offset:49152
v_xor_b32 v35, 8, v34
v_lshlrev_b32 v35, 4, v35
v_add_u32 v35, v35, v33
v_add_u32 v35, 0x10000, v35
ds_read_b64_tr_b16 v[98:99], v35 offset:2048
ds_read_b64_tr_b16 v[102:103], v35 offset:18432
ds_read_b64_tr_b16 v[106:107], v35 offset:34816
ds_read_b64_tr_b16 v[110:111], v35 offset:51200
s_waitcnt lgkmcnt(0)
s_barrier
ds_write_b128 v1, v[48:51] offset:0
ds_write_b128 v1, v[52:55] offset:1024
ds_write_b128 v1, v[56:59] offset:2048
ds_write_b128 v1, v[60:63] offset:3072
ds_write_b128 v1, v[64:67] offset:4096
ds_write_b128 v1, v[68:71] offset:5120
ds_write_b128 v1, v[72:75] offset:6144
ds_write_b128 v1, v[76:79] offset:7168
ds_write_b128 v1, v[80:83] offset:8192
ds_write_b128 v1, v[84:87] offset:9216
ds_write_b128 v1, v[88:91] offset:10240
ds_write_b128 v1, v[92:95] offset:11264
ds_write_b128 v1, v[96:99] offset:12288
ds_write_b128 v1, v[100:103] offset:13312
ds_write_b128 v1, v[104:107] offset:14336
ds_write_b128 v1, v[108:111] offset:15360
s_waitcnt lgkmcnt(0)
s_add_u32 s98, s4, 8192
s_addc_u32 s99, s5, 0
s_cmp_eq_u32 s11, 0
s_cselect_b32 s46, 1, 0
s_mov_b32 s47, 0
s_cmp_lg_u32 s11, 0
s_cbranch_scc1 SWS_86
v_mov_b32 v24, 0
s_mov_b32 s36, 0
SW_84:
global_load_dword v25, v24, s[6:7] offset:12 sc1
global_load_dword v26, v24, s[6:7] offset:8 sc1
global_load_dword v27, v24, s[98:99] sc1
global_load_dword v28, v24, s[6:7] offset:160 sc1
s_waitcnt vmcnt(0)
v_readfirstlane_b32 s37, v25
v_readfirstlane_b32 s38, v26
v_readfirstlane_b32 s39, v27
s_lshr_b32 s35, s37, 16
s_and_b32 s37, s37, 0xffff
s_cmp_ge_u32 s37, 32
s_cselect_b32 s37, 1, 0
s_cmp_ge_u32 s38, 1
s_cselect_b32 s37, s37, 0
s_cmp_ge_u32 s39, 32
s_cselect_b32 s37, s37, 0
v_readfirstlane_b32 s38, v28
s_nop 0
s_cmp_ge_u32 s38, 8
s_cselect_b32 s37, s37, 0
s_cmp_lg_u32 s37, 0
s_cbranch_scc1 SWE_85
s_sleep 1
s_add_u32 s36, s36, 1
s_cmp_lt_u32 s36, 200000
s_cbranch_scc1 SW_84
SWE_85:
v_mov_b32 v24, 27136
v_mov_b32 v25, s35
ds_write_b32 v24, v25
s_waitcnt lgkmcnt(0)
SWS_86:
s_barrier
v_mov_b32 v24, 27136
ds_read_b32 v25, v24
s_waitcnt lgkmcnt(0)
v_readfirstlane_b32 s90, v25
s_barrier
s_mov_b32 s13, 0
s_lshl_b32 s34, s11, 11
s_add_u32 m0, s34, 10752
s_nop 0
global_load_lds_dwordx4 v4, s[30:31]
global_load_lds_dwordx4 v4, s[30:31] offset:1024 sc1
s_add_u32 s30, s30, 0x40000
s_addc_u32 s31, s31, 0
s_lshl_b32 s34, s11, 11
s_add_u32 m0, s34, 18944
s_nop 0
global_load_lds_dwordx4 v4, s[32:33]
global_load_lds_dwordx4 v4, s[32:33] offset:1024
s_add_u32 s32, s32, 0x40000
s_addc_u32 s33, s33, 0
s_mov_b32 s44, 0
s_mov_b32 s12, 0
s_mov_b32 s60, 0
s_mov_b32 s61, 0
s_mov_b32 s28, s26
s_mov_b32 s29, s27
s_add_u32 s94, s4, 3670016
s_addc_u32 s95, s5, 0
s_lshl_b32 s34, s11, 11
s_add_u32 s58, s34, 10752
s_add_u32 s59, s34, 18944
s_add_u32 s52, s26, 16384
s_addc_u32 s53, s27, 0
v_mov_b64 v[88:89], 0
v_mov_b64 v[90:91], 0
v_mov_b64 v[92:93], 0
v_mov_b64 v[94:95], 0
v_mov_b64 v[96:97], 0
v_mov_b64 v[98:99], 0
v_mov_b64 v[100:101], 0
v_mov_b64 v[102:103], 0
v_mov_b32 v104, -1
s_cmp_lg_u32 s90, 32
s_cbranch_scc1 L_safe_S
s_mov_b64 exec, s[40:41]
global_store_dword v11, v126, s[26:27]
s_mov_b64 exec, -1
L_loop:
s_mov_b32 s45, 0
s_nop 15
s_nop 15
global_load_dwordx4 v[56:59], v4, s[28:29] sc1
global_load_dwordx4 v[60:63], v4, s[28:29] offset:1024 sc1
s_nop 15
s_nop 15
global_load_dwordx4 v[64:67], v4, s[28:29] sc1
global_load_dwordx4 v[68:71], v4, s[28:29] offset:1024 sc1
s_mov_b64 exec, s[40:41]
global_store_dword v11, v104, s[52:53]
s_mov_b64 exec, -1
s_waitcnt vmcnt(3)
ds_write_b128 v4, v[56:59]
v_max3_u32 v0, v56, v57, v58
v_max3_u32 v13, v59, v60, v61
ds_write_b128 v4, v[60:63] offset:1024
v_max3_u32 v0, v0, v62, v63
v_max_u32 v0, v0, v13
v_cmp_eq_u32 vcc, -1, v0
s_cbranch_vccz L_agok
global_load_dwordx4 v[56:59], v4, s[28:29] sc1
global_load_dwordx4 v[60:63], v4, s[28:29] offset:1024 sc1
s_add_u32 s60, s60, 1
s_waitcnt vmcnt(3)
ds_write_b128 v4, v[64:67]
v_max3_u32 v0, v64, v65, v66
v_max3_u32 v13, v67, v68, v69
ds_write_b128 v4, v[68:71] offset:1024
v_max3_u32 v0, v0, v70, v71
v_max_u32 v0, v0, v13
v_cmp_eq_u32 vcc, -1, v0
s_cbranch_vccnz L_agretry
L_agok:
s_waitcnt lgkmcnt(0)
s_barrier
ds_read_b128 v[24:27], v3 offset:0
ds_read_b128 v[28:31], v3 offset:1024
ds_read_b128 v[32:35], v3 offset:2048
s_waitcnt lgkmcnt(2)
v_smfmac_f32_16x16x64_bf16 v[88:91], v[24:27], a[0:7], v2
ds_read_b128 v[36:39], v3 offset:3072
v_smfmac_f32_16x16x64_bf16 v[92:95], v[24:27], a[64:71], v2
ds_read_b128 v[40:43], v3 offset:4096
s_waitcnt lgkmcnt(3)
v_smfmac_f32_16x16x64_bf16 v[88:91], v[28:31], a[8:15], v2
ds_read_b128 v[44:47], v3 offset:5120
v_smfmac_f32_16x16x64_bf16 v[92:95], v[28:31], a[72:79], v2
ds_read_b128 v[48:51], v3 offset:6144
s_waitcnt lgkmcnt(4)
v_smfmac_f32_16x16x64_bf16 v[88:91], v[32:35], a[16:23], v2
ds_read_b128 v[52:55], v3 offset:7168
v_smfmac_f32_16x16x64_bf16 v[92:95], v[32:35], a[80:87], v2
ds_read_b128 v[72:75], v3 offset:10752
s_waitcnt lgkmcnt(5)
v_smfmac_f32_16x16x64_bf16 v[88:91], v[36:39], a[24:31], v2
ds_read_b128 v[76:79], v3 offset:11776
v_smfmac_f32_16x16x64_bf16 v[92:95], v[36:39], a[88:95], v2
ds_read_b128 v[80:83], v3 offset:12800
s_waitcnt lgkmcnt(6)
v_smfmac_f32_16x16x64_bf16 v[88:91], v[40:43], a[32:39], v2
ds_read_b128 v[84:87], v3 offset:13824
v_smfmac_f32_16x16x64_bf16 v[92:95], v[40:43], a[96:103], v2
ds_read_b128 v[116:119], v3 offset:14848
s_waitcnt lgkmcnt(7)
v_smfmac_f32_16x16x64_bf16 v[88:91], v[44:47], a[40:47], v2
ds_read_b128 v[120:123], v3 offset:15872
v_smfmac_f32_16x16x64_bf16 v[92:95], v[44:47], a[104:111], v2
ds_read_b128 v[124:127], v3 offset:16896
s_waitcnt lgkmcnt(8)
v_smfmac_f32_16x16x64_bf16 v[88:91], v[48:51], a[48:55], v2
ds_read_b128 v[112:115], v3 offset:17920
v_smfmac_f32_16x16x64_bf16 v[92:95], v[48:51], a[112:119], v2
s_waitcnt lgkmcnt(8)
s_and_b32 s34, s12, 1
s_lshl_b32 s34, s34, 18
v_smfmac_f32_16x16x64_bf16 v[88:91], v[52:55], a[56:63], v2
s_add_u32 s34, s34, 1048576
s_add_u32 s16, s4, s34
s_addc_u32 s17, s5, 0
v_smfmac_f32_16x16x64_bf16 v[92:95], v[52:55], a[120:127], v2
s_add_u32 s24, s16, 32768
s_addc_u32 s25, s17, 0
v_smfmac_f32_16x16x64_bf16 v[96:99], v[24:27], a[128:135], v2
s_waitcnt lgkmcnt(0)
s_barrier
s_cmp_ge_u32 s12, s13
s_cbranch_scc1 KVSLOW
KVRET:
v_smfmac_f32_16x16x64_bf16 v[100:103], v[24:27], a[192:199], v2
v_permlane32_swap_b32 v88, v92
v_permlane32_swap_b32 v89, v93
v_permlane32_swap_b32 v90, v94
v_permlane32_swap_b32 v91, v95
v_pk_add_f32 v[88:89], v[88:89], v[92:93]
v_pk_add_f32 v[90:91], v[90:91], v[94:95]
v_cvt_pk_bf16_f32 v88, v88, v89
v_cvt_pk_bf16_f32 v89, v90, v91
ds_write_b64 v6, v[88:89] offset:8192
v_smfmac_f32_16x16x64_bf16 v[96:99], v[28:31], a[136:143], v2
s_bfe_u32 s50, s12, 0x10001
s_add_u32 s34, s12, 1
s_and_b32 s35, s34, 3
v_smfmac_f32_16x16x64_bf16 v[100:103], v[28:31], a[200:207], v2
s_lshl_b32 s35, s35, 13
s_add_u32 s54, s26, s35
s_addc_u32 s55, s27, 0
v_smfmac_f32_16x16x64_bf16 v[96:99], v[32:35], a[144:151], v2
s_xor_b32 s35, s35, 0x4000
s_add_u32 s52, s26, s35
s_addc_u32 s53, s27, 0
v_smfmac_f32_16x16x64_bf16 v[100:103], v[32:35], a[208:215], v2
s_lshl_b32 s34, s12, 5
s_add_u32 s34, s34, s10
s_lshl_b32 s35, s34, 11
v_smfmac_f32_16x16x64_bf16 v[96:99], v[36:39], a[152:159], v2
s_add_u32 s35, s35, 83886080
s_add_u32 s92, s4, s35
s_addc_u32 s93, s5, 0
v_smfmac_f32_16x16x64_bf16 v[100:103], v[36:39], a[216:223], v2
s_lshl_b32 s35, s34, 13
s_add_u32 s35, s35, 88080384
s_add_u32 s94, s4, s35
s_addc_u32 s95, s5, 0
v_smfmac_f32_16x16x64_bf16 v[96:99], v[40:43], a[160:167], v2
s_waitcnt vmcnt(0)
s_lshl_b32 s34, s12, 7
s_add_u32 s35, s34, 24448
s_cmp_eq_u32 s12, 0
s_cselect_b32 s35, 73728, s35
v_smfmac_f32_16x16x64_bf16 v[100:103], v[40:43], a[224:231], v2
s_mov_b32 m0, s58
s_nop 0
global_load_lds_dwordx4 v4, s[30:31] sc1
v_mov_b64 v[88:89], 0
v_smfmac_f32_16x16x64_bf16 v[96:99], v[44:47], a[168:175], v2
s_add_u32 s62, s4, s35
s_addc_u32 s63, s5, 0
v_smfmac_f32_16x16x64_bf16 v[100:103], v[44:47], a[232:239], v2
v_mov_b64 v[90:91], 0
v_smfmac_f32_16x16x64_bf16 v[96:99], v[48:51], a[176:183], v2
v_smfmac_f32_16x16x64_bf16 v[100:103], v[48:51], a[240:247], v2
global_load_lds_dwordx4 v4, s[30:31] offset:1024 sc1
s_add_u32 s30, s30, 0x40000
s_addc_u32 s31, s31, 0
v_mov_b64 v[92:93], 0
v_smfmac_f32_16x16x64_bf16 v[96:99], v[52:55], a[184:191], v2
v_smfmac_f32_16x16x64_bf16 v[100:103], v[52:55], a[248:255], v2
v_mov_b64 v[94:95], 0
v_smfmac_f32_16x16x64_bf16 v[88:91], v[24:27], v[128:135], v2
v_smfmac_f32_16x16x64_bf16 v[92:95], v[24:27], v[192:199], v2
v_permlane32_swap_b32 v96, v100
v_permlane32_swap_b32 v97, v101
v_permlane32_swap_b32 v98, v102
v_permlane32_swap_b32 v99, v103
v_pk_add_f32 v[96:97], v[96:97], v[100:101]
v_pk_add_f32 v[98:99], v[98:99], v[102:103]
v_cvt_pk_bf16_f32 v96, v96, v97
v_cvt_pk_bf16_f32 v97, v98, v99
ds_write_b64 v6, v[96:97] offset:27136
v_smfmac_f32_16x16x64_bf16 v[88:91], v[28:31], v[136:143], v2
global_store_dwordx2 v6, v[96:97], s[92:93] sc1
v_smfmac_f32_16x16x64_bf16 v[92:95], v[28:31], v[200:207], v2
v_smfmac_f32_16x16x64_bf16 v[88:91], v[32:35], v[144:151], v2
v_smfmac_f32_16x16x64_bf16 v[92:95], v[32:35], v[208:215], v2
s_waitcnt lgkmcnt(0)
s_barrier
ds_read_b64_tr_b16 v[56:57], v7 offset:8192
ds_read_b64_tr_b16 v[58:59], v7 offset:8448
v_smfmac_f32_16x16x64_bf16 v[88:91], v[36:39], v[152:159], v2
s_mov_b64 exec, s[46:47]
s_cbranch_execz XF_88
global_atomic_add v3, v2, s[62:63]
XF_88:
s_mov_b64 exec, -1
ds_read_b64_tr_b16 v[60:61], v7 offset:8704
ds_read_b64_tr_b16 v[62:63], v7 offset:8960
v_smfmac_f32_16x16x64_bf16 v[92:95], v[36:39], v[216:223], v2
ds_read_b64_tr_b16 v[64:65], v7 offset:9216
ds_read_b64_tr_b16 v[66:67], v7 offset:9472
ds_read_b128 v[24:27], v4 offset:18944
v_smfmac_f32_16x16x64_bf16 v[88:91], v[40:43], v[160:167], v2
ds_read_b64_tr_b16 v[68:69], v7 offset:9728
ds_read_b64_tr_b16 v[70:71], v7 offset:9984
ds_read_b128 v[28:31], v4 offset:19968
v_smfmac_f32_16x16x64_bf16 v[92:95], v[40:43], v[224:231], v2
v_smfmac_f32_16x16x64_bf16 v[88:91], v[44:47], v[168:175], v2
v_smfmac_f32_16x16x64_bf16 v[92:95], v[44:47], v[232:239], v2
ds_read_b64_tr_b16 v[32:33], v7 offset:27136
ds_read_b64_tr_b16 v[34:35], v7 offset:27392
ds_read_b64_tr_b16 v[36:37], v7 offset:27648
ds_read_b64_tr_b16 v[38:39], v7 offset:27904
ds_read_b64_tr_b16 v[40:41], v7 offset:28160
ds_read_b64_tr_b16 v[42:43], v7 offset:28416
ds_read_b64_tr_b16 v[44:45], v7 offset:28672
ds_read_b64_tr_b16 v[46:47], v7 offset:28928
s_waitcnt lgkmcnt(8)
v_mfma_f32_16x16x32_bf16 v[104:107], v[72:75], v[56:59], 0
v_mfma_f32_16x16x32_bf16 v[108:111], v[116:119], v[56:59], 0
v_mfma_f32_16x16x32_bf16 v[104:107], v[76:79], v[60:63], v[104:107]
v_mfma_f32_16x16x32_bf16 v[108:111], v[120:123], v[60:63], v[108:111]
v_mfma_f32_16x16x32_bf16 v[104:107], v[80:83], v[64:67], v[104:107]
v_mfma_f32_16x16x32_bf16 v[108:111], v[124:127], v[64:67], v[108:111]
v_mfma_f32_16x16x32_bf16 v[104:107], v[84:87], v[68:71], v[104:107]
v_mfma_f32_16x16x32_bf16 v[108:111], v[112:115], v[68:71], v[108:111]
s_waitcnt lgkmcnt(0)
v_mfma_f32_16x16x32_bf16 v[112:115], v[32:35], v[56:59], 0
v_mfma_f32_16x16x32_bf16 v[112:115], v[36:39], v[60:63], v[112:115]
v_max3_f32 v0, |v104|, |v105|, |v106|
v_mfma_f32_16x16x32_bf16 v[112:115], v[40:43], v[64:67], v[112:115]
v_max3_f32 v13, |v108|, |v109|, |v110|
v_mfma_f32_16x16x32_bf16 v[112:115], v[44:47], v[68:71], v[112:115]
v_max3_f32 v0, v0, |v107|, |v111|
v_max_f32 v0, v0, v13
v_smfmac_f32_16x16x64_bf16 v[88:91], v[48:51], v[176:183], v2
s_mov_b32 m0, s59
ds_read_b128 v[56:59], v5 offset:0
global_load_lds_dwordx4 v4, s[32:33] sc1
v_smfmac_f32_16x16x64_bf16 v[92:95], v[48:51], v[240:247], v2
ds_read_b128 v[60:63], v5 offset:1024
v_smfmac_f32_16x16x64_bf16 v[88:91], v[52:55], v[184:191], v2
ds_read_b128 v[64:67], v5 offset:2048
v_smfmac_f32_16x16x64_bf16 v[92:95], v[52:55], v[248:255], v2
ds_read_b128 v[68:71], v5 offset:3072
v_max3_f32 v0, v0, |v112|, |v113|
v_max3_f32 v0, v0, |v114|, |v115|
v_cmp_lt_f32 vcc, s8, v0
v_pk_mul_f32 v[104:105], v[104:105], s[14:15]
v_pk_mul_f32 v[106:107], v[106:107], s[14:15]
v_pk_mul_f32 v[108:109], v[108:109], s[14:15]
v_pk_mul_f32 v[110:111], v[110:111], s[14:15]
v_pk_mul_f32 v[112:113], v[112:113], s[14:15]
v_pk_mul_f32 v[114:115], v[114:115], s[14:15]
global_load_lds_dwordx4 v4, s[32:33] offset:1024 sc1
s_add_u32 s32, s32, 0x40000
s_addc_u32 s33, s33, 0
s_cbranch_vccnz SMSLOW
SMRET:
v_cvt_pk_bf16_f32 v96, v88, v89
v_cvt_pk_bf16_f32 v97, v90, v91
v_cvt_pk_bf16_f32 v98, v92, v93
v_cvt_pk_bf16_f32 v99, v94, v95
global_store_dwordx4 v4, v[96:99], s[94:95] sc1
s_cmp_eq_u32 s12, 63
s_cbranch_scc1 L_fin
v_exp_f32 v104, v104
ds_read_b128 v[72:75], v1 offset:0
v_exp_f32 v105, v105
ds_read_b128 v[76:79], v1 offset:1024
v_exp_f32 v106, v106
ds_read_b128 v[80:83], v1 offset:2048
v_exp_f32 v107, v107
ds_read_b128 v[84:87], v1 offset:3072
v_exp_f32 v108, v108
ds_read_b128 v[32:35], v5 offset:4096
v_exp_f32 v109, v109
ds_read_b128 v[36:39], v5 offset:5120
v_exp_f32 v110, v110
ds_read_b128 v[40:43], v5 offset:6144
v_exp_f32 v111, v111
ds_read_b128 v[44:47], v5 offset:7168
v_cvt_pk_bf16_f32 v104, v104, v105
v_cvt_pk_bf16_f32 v105, v106, v107
v_cvt_pk_bf16_f32 v106, v108, v109
v_cvt_pk_bf16_f32 v107, v110, v111
ds_read_b128 v[48:51], v1 offset:4096
ds_read_b128 v[52:55], v1 offset:5120
s_waitcnt lgkmcnt(14)
v_mfma_f32_16x16x32_bf16 v[124:127], v[20:23], v[104:107], 0
v_exp_f32 v112, v112
v_mfma_f32_16x16x32_bf16 v[116:119], v[24:27], v[104:107], 0
v_exp_f32 v113, v113
v_mfma_f32_16x16x32_bf16 v[120:123], v[28:31], v[104:107], 0
v_exp_f32 v114, v114
v_exp_f32 v115, v115
v_cvt_pk_bf16_f32 v112, v112, v113
v_cvt_pk_bf16_f32 v113, v114, v115
s_nop 1
v_mfma_f32_16x16x16_bf16 v[124:127], v[14:15], v[112:113], v[124:127]
v_mfma_f32_16x16x16_bf16 v[116:119], v[96:97], v[112:113], v[116:119]
v_mfma_f32_16x16x16_bf16 v[120:123], v[98:99], v[112:113], v[120:123]
ds_read_b128 v[88:91], v1 offset:6144
ds_read_b128 v[92:95], v1 offset:7168
ds_read_b128 v[24:27], v5 offset:8192
ds_read_b128 v[28:31], v5 offset:9216
v_rcp_f32 v0, v124
s_nop 0
v_pk_mul_f32 v[116:117], v[116:117], v[0:1] op_sel_hi:[1,0]
v_pk_mul_f32 v[118:119], v[118:119], v[0:1] op_sel_hi:[1,0]
v_cvt_pk_bf16_f32 v116, v116, v117
v_cvt_pk_bf16_f32 v117, v118, v119
ds_write_b64 v8, v[116:117] offset:0
v_pk_mul_f32 v[120:121], v[120:121], v[0:1] op_sel_hi:[1,0]
v_pk_mul_f32 v[122:123], v[122:123], v[0:1] op_sel_hi:[1,0]
v_cvt_pk_bf16_f32 v120, v120, v121
v_cvt_pk_bf16_f32 v121, v122, v123
ds_write_b64 v8, v[120:121] offset:32
v_mov_b64 v[96:97], 0
v_mov_b64 v[98:99], 0
v_mov_b64 v[100:101], 0
v_mov_b64 v[102:103], 0
v_mov_b64 v[104:105], 0
v_mov_b64 v[106:107], 0
v_mov_b64 v[108:109], 0
v_mov_b64 v[110:111], 0
s_waitcnt lgkmcnt(0)
s_barrier
ds_read_b128 v[112:115], v12 offset:0
ds_read_b128 v[116:119], v12 offset:64
ds_read_b128 v[120:123], v12 offset:128
ds_read_b128 v[124:127], v12 offset:192
s_waitcnt lgkmcnt(3)
v_smfmac_f32_16x16x64_bf16 v[96:99], v[112:115], v[56:63], v2
ds_read_b128 v[56:59], v5 offset:10240
ds_read_b128 v[60:63], v5 offset:11264
s_waitcnt lgkmcnt(4)
v_smfmac_f32_16x16x64_bf16 v[96:99], v[116:119], v[64:71], v2
ds_read_b128 v[64:67], v1 offset:8192
ds_read_b128 v[68:71], v1 offset:9216
s_waitcnt lgkmcnt(5)
v_smfmac_f32_16x16x64_bf16 v[96:99], v[120:123], v[72:79], v2
ds_read_b128 v[72:75], v1 offset:10240
ds_read_b128 v[76:79], v1 offset:11264
s_waitcnt lgkmcnt(6)
v_smfmac_f32_16x16x64_bf16 v[96:99], v[124:127], v[80:87], v2
ds_read_b128 v[80:83], v5 offset:12288
v_smfmac_f32_16x16x64_bf16 v[100:103], v[112:115], v[32:39], v2
ds_read_b128 v[84:87], v5 offset:13312
v_smfmac_f32_16x16x64_bf16 v[100:103], v[116:119], v[40:47], v2
ds_read_b128 v[32:35], v5 offset:14336
v_cvt_pk_bf16_f32 v96, v96, v97
v_smfmac_f32_16x16x64_bf16 v[100:103], v[120:123], v[48:55], v2
ds_read_b128 v[36:39], v5 offset:15360
v_cvt_pk_bf16_f32 v97, v98, v99
v_smfmac_f32_16x16x64_bf16 v[100:103], v[124:127], v[88:95], v2
ds_read_b128 v[40:43], v1 offset:12288
v_smfmac_f32_16x16x64_bf16 v[104:107], v[112:115], v[24:31], v2
ds_read_b128 v[44:47], v1 offset:13312
ds_read_b128 v[48:51], v1 offset:14336
s_waitcnt lgkmcnt(11)
v_smfmac_f32_16x16x64_bf16 v[104:107], v[116:119], v[56:63], v2
ds_read_b128 v[52:55], v1 offset:15360
v_cvt_pk_bf16_f32 v98, v100, v101
s_waitcnt lgkmcnt(10)
v_smfmac_f32_16x16x64_bf16 v[104:107], v[120:123], v[64:71], v2
v_cvt_pk_bf16_f32 v99, v102, v103
v_bfi_b32 v96, 1, s50, v96
global_store_dwordx4 v9, v[96:99], s[16:17]
s_waitcnt lgkmcnt(8)
v_smfmac_f32_16x16x64_bf16 v[104:107], v[124:127], v[72:79], v2
s_waitcnt lgkmcnt(6)
v_smfmac_f32_16x16x64_bf16 v[108:111], v[112:115], v[80:87], v2
s_waitcnt lgkmcnt(4)
v_smfmac_f32_16x16x64_bf16 v[108:111], v[116:119], v[32:39], v2
v_cvt_pk_bf16_f32 v104, v104, v105
s_waitcnt lgkmcnt(2)
v_smfmac_f32_16x16x64_bf16 v[108:111], v[120:123], v[40:47], v2
v_cvt_pk_bf16_f32 v105, v106, v107
s_waitcnt lgkmcnt(0)
v_smfmac_f32_16x16x64_bf16 v[108:111], v[124:127], v[48:55], v2
s_nop 7
v_cvt_pk_bf16_f32 v106, v108, v109
v_cvt_pk_bf16_f32 v107, v110, v111
v_bfi_b32 v104, 1, s50, v104
global_store_dwordx4 v9, v[104:107], s[24:25]
s_mov_b32 s22, s16
s_mov_b32 s23, s17
s_mov_b32 s28, s54
s_mov_b32 s29, s55
s_mov_b32 s51, s50
s_add_u32 s12, s12, 1
v_mov_b64 v[88:89], 0
v_mov_b64 v[90:91], 0
v_mov_b64 v[92:93], 0
v_mov_b64 v[94:95], 0
v_mov_b64 v[96:97], 0
v_mov_b64 v[98:99], 0
v_mov_b64 v[100:101], 0
v_mov_b64 v[102:103], 0
v_mov_b32 v104, -1
s_mov_b32 s45, 0
s_nop 15
s_nop 15
global_load_dwordx4 v[56:59], v10, s[22:23] sc1
global_load_dwordx4 v[60:63], v10, s[22:23] offset:1024 sc1
s_nop 15
s_nop 15
global_load_dwordx4 v[64:67], v10, s[22:23] sc1
global_load_dwordx4 v[68:71], v10, s[22:23] offset:1024 sc1
s_waitcnt vmcnt(2)
v_xor_b32 v0, s51, v56
v_xor_b32 v13, s51, v60
v_mfma_f32_16x16x32_bf16 v[24:27], v[16:19], v[56:59], 0
v_or_b32 v0, v0, v13
v_and_b32 v0, 1, v0
v_mfma_f32_16x16x32_bf16 v[24:27], v[16:19], v[60:63], v[24:27]
v_cmp_ne_u32 vcc, 0, v0
s_cbranch_vccz L_rsok
global_load_dwordx4 v[56:59], v10, s[22:23] sc1
global_load_dwordx4 v[60:63], v10, s[22:23] offset:1024 sc1
s_add_u32 s61, s61, 1
s_waitcnt vmcnt(2)
v_xor_b32 v0, s51, v64
v_xor_b32 v13, s51, v68
v_mfma_f32_16x16x32_bf16 v[24:27], v[16:19], v[64:67], 0
v_or_b32 v0, v0, v13
v_and_b32 v0, 1, v0
v_mfma_f32_16x16x32_bf16 v[24:27], v[16:19], v[68:71], v[24:27]
v_cmp_ne_u32 vcc, 0, v0
s_cbranch_vccnz L_rsretry
L_rsok:
s_nop 5
v_add_f32_dpp v24, v24, v24 row_ror:4 row_mask:0xf bank_mask:0xf
v_add_f32_dpp v25, v25, v25 row_ror:4 row_mask:0xf bank_mask:0xf
v_add_f32_dpp v26, v26, v26 row_ror:4 row_mask:0xf bank_mask:0xf
v_add_f32_dpp v27, v27, v27 row_ror:4 row_mask:0xf bank_mask:0xf
v_add_f32_dpp v24, v24, v24 row_ror:8 row_mask:0xf bank_mask:0xf
v_add_f32_dpp v25, v25, v25 row_ror:8 row_mask:0xf bank_mask:0xf
v_add_f32_dpp v26, v26, v26 row_ror:8 row_mask:0xf bank_mask:0xf
v_add_f32_dpp v27, v27, v27 row_ror:8 row_mask:0xf bank_mask:0xf
v_cndmask_b32 v24, v24, v25, s[18:19]
v_cndmask_b32 v26, v26, v27, s[18:19]
v_cndmask_b32 v24, v24, v26, s[20:21]
s_nop 1
v_mov_b32_dpp v25, v24 quad_perm:[1,1,3,3] row_mask:0xf bank_mask:0xf
v_cvt_pk_bf16_f32 v24, v24, v25
s_mov_b64 exec, s[40:41]
v_min_u32 v24, -2, v24
global_store_dword v11, v24, s[28:29]
s_mov_b64 exec, -1
s_branch L_loop
L_fin:
s_waitcnt vmcnt(0) lgkmcnt(0)
s_barrier
s_add_u32 s62, s62, 128
s_addc_u32 s63, s63, 0
s_mov_b64 exec, s[46:47]
s_cbranch_execz XF_89
global_atomic_add v3, v2, s[62:63]
XF_89:
s_mov_b64 exec, -1
s_waitcnt vmcnt(0)
s_cmp_lg_u32 s11, 0
s_cbranch_scc1 WB_90
buffer_wbl2 sc1
s_waitcnt vmcnt(0)
WB_90:
s_branch L_chain_done
KVSLOW:
s_mov_b32 s35, 0
KVSLOW_l:
v_lshlrev_b32 v13, 3, v3
global_load_dword v0, v13, s[98:99] sc1
s_waitcnt vmcnt(0)
v_cmp_gt_u32 vcc, 32, v0
s_nop 3
s_ff1_i32_b64 s34, vcc
s_cmp_eq_u32 s34, -1
s_cselect_b32 s34, 64, s34
s_sub_u32 s13, s34, 1
s_cmp_eq_u32 s34, 64
s_cselect_b32 s13, 64, s13
s_cmp_lt_i32 s12, s13
s_cbranch_scc1 KVRET
s_sleep 4
s_add_u32 s35, s35, 1
s_cmp_lt_u32 s35, 200000
s_cbranch_scc1 KVSLOW_l
s_mov_b32 s13, 64
s_branch KVRET
SMSLOW:
v_max3_f32 v0, v104, v105, v106
v_max3_f32 v13, v107, v108, v109
v_max3_f32 v0, v0, v110, v111
v_max3_f32 v13, v13, v112, v113
v_max3_f32 v0, v0, v114, v115
v_max_f32 v0, v0, v13
v_mov_b32 v13, v0
s_nop 1
v_permlane16_swap_b32 v0, v13
v_max_f32 v0, v0, v13
v_mov_b32 v13, v0
s_nop 1
v_permlane32_swap_b32 v0, v13
v_max_f32 v0, v0, v13
v_sub_f32 v104, v104, v0
v_sub_f32 v105, v105, v0
v_sub_f32 v106, v106, v0
v_sub_f32 v107, v107, v0
v_sub_f32 v108, v108, v0
v_sub_f32 v109, v109, v0
v_sub_f32 v110, v110, v0
v_sub_f32 v111, v111, v0
v_sub_f32 v112, v112, v0
v_sub_f32 v113, v113, v0
v_sub_f32 v114, v114, v0
v_sub_f32 v115, v115, v0
s_nop 1
s_branch SMRET
L_agretry:
global_load_dwordx4 v[64:67], v4, s[28:29] sc1
global_load_dwordx4 v[68:71], v4, s[28:29] offset:1024 sc1
s_add_u32 s60, s60, 1
L_ag:
s_waitcnt vmcnt(2)
ds_write_b128 v4, v[56:59]
v_max3_u32 v0, v56, v57, v58
v_max3_u32 v13, v59, v60, v61
ds_write_b128 v4, v[60:63] offset:1024
v_max3_u32 v0, v0, v62, v63
v_max_u32 v0, v0, v13
v_cmp_eq_u32 vcc, -1, v0
s_cbranch_vccz L_agok
global_load_dwordx4 v[56:59], v4, s[28:29] sc1
global_load_dwordx4 v[60:63], v4, s[28:29] offset:1024 sc1
s_add_u32 s60, s60, 1
s_waitcnt vmcnt(2)
ds_write_b128 v4, v[64:67]
v_max3_u32 v0, v64, v65, v66
v_max3_u32 v13, v67, v68, v69
ds_write_b128 v4, v[68:71] offset:1024
v_max3_u32 v0, v0, v70, v71
v_max_u32 v0, v0, v13
v_cmp_eq_u32 vcc, -1, v0
s_cbranch_vccz L_agok
global_load_dwordx4 v[64:67], v4, s[28:29] sc1
global_load_dwordx4 v[68:71], v4, s[28:29] offset:1024 sc1
s_add_u32 s60, s60, 1
s_add_u32 s45, s45, 1
s_cmp_lt_u32 s45, 100000
s_cbranch_scc1 L_ag
s_mov_b32 s44, 1
s_waitcnt vmcnt(0)
s_branch L_agok
L_rsretry:
global_load_dwordx4 v[64:67], v10, s[22:23] sc1
global_load_dwordx4 v[68:71], v10, s[22:23] offset:1024 sc1
s_add_u32 s61, s61, 1
L_rs:
s_waitcnt vmcnt(2)
v_xor_b32 v0, s51, v56
v_xor_b32 v13, s51, v60
v_mfma_f32_16x16x32_bf16 v[24:27], v[16:19], v[56:59], 0
v_or_b32 v0, v0, v13
v_and_b32 v0, 1, v0
v_mfma_f32_16x16x32_bf16 v[24:27], v[16:19], v[60:63], v[24:27]
v_cmp_ne_u32 vcc, 0, v0
s_cbranch_vccz L_rsok
global_load_dwordx4 v[56:59], v10, s[22:23] sc1
global_load_dwordx4 v[60:63], v10, s[22:23] offset:1024 sc1
s_add_u32 s61, s61, 1
s_waitcnt vmcnt(2)
v_xor_b32 v0, s51, v64
v_xor_b32 v13, s51, v68
v_mfma_f32_16x16x32_bf16 v[24:27], v[16:19], v[64:67], 0
v_or_b32 v0, v0, v13
v_and_b32 v0, 1, v0
v_mfma_f32_16x16x32_bf16 v[24:27], v[16:19], v[68:71], v[24:27]
v_cmp_ne_u32 vcc, 0, v0
s_cbranch_vccz L_rsok
global_load_dwordx4 v[64:67], v10, s[22:23] sc1
global_load_dwordx4 v[68:71], v10, s[22:23] offset:1024 sc1
s_add_u32 s61, s61, 1
s_add_u32 s45, s45, 1
s_cmp_lt_u32 s45, 100000
s_cbranch_scc1 L_rs
s_mov_b32 s44, 2
s_branch L_rsok
L_safe_S:
s_mov_b64 exec, s[40:41]
global_store_dword v11, v126, s[26:27] sc1
s_mov_b64 exec, -1
L_loop_S:
s_mov_b32 s45, 0
s_nop 15
s_nop 15
global_load_dwordx4 v[56:59], v4, s[28:29] sc1
global_load_dwordx4 v[60:63], v4, s[28:29] offset:1024 sc1
s_nop 15
s_nop 15
global_load_dwordx4 v[64:67], v4, s[28:29] sc1
global_load_dwordx4 v[68:71], v4, s[28:29] offset:1024 sc1
s_mov_b64 exec, s[40:41]
global_store_dword v11, v104, s[52:53] sc1
s_mov_b64 exec, -1
s_waitcnt vmcnt(3)
ds_write_b128 v4, v[56:59]
v_max3_u32 v0, v56, v57, v58
v_max3_u32 v13, v59, v60, v61
ds_write_b128 v4, v[60:63] offset:1024
v_max3_u32 v0, v0, v62, v63
v_max_u32 v0, v0, v13
v_cmp_eq_u32 vcc, -1, v0
s_cbranch_vccz L_agok_S
global_load_dwordx4 v[56:59], v4, s[28:29] sc1
global_load_dwordx4 v[60:63], v4, s[28:29] offset:1024 sc1
s_add_u32 s60, s60, 1
s_waitcnt vmcnt(3)
ds_write_b128 v4, v[64:67]
v_max3_u32 v0, v64, v65, v66
v_max3_u32 v13, v67, v68, v69
ds_write_b128 v4, v[68:71] offset:1024
v_max3_u32 v0, v0, v70, v71
v_max_u32 v0, v0, v13
v_cmp_eq_u32 vcc, -1, v0
s_cbranch_vccnz L_agretry_S
L_agok_S:
s_waitcnt lgkmcnt(0)
s_barrier
ds_read_b128 v[24:27], v3 offset:0
ds_read_b128 v[28:31], v3 offset:1024
ds_read_b128 v[32:35], v3 offset:2048
s_waitcnt lgkmcnt(2)
v_smfmac_f32_16x16x64_bf16 v[88:91], v[24:27], a[0:7], v2
ds_read_b128 v[36:39], v3 offset:3072
v_smfmac_f32_16x16x64_bf16 v[92:95], v[24:27], a[64:71], v2
ds_read_b128 v[40:43], v3 offset:4096
s_waitcnt lgkmcnt(3)
v_smfmac_f32_16x16x64_bf16 v[88:91], v[28:31], a[8:15], v2
ds_read_b128 v[44:47], v3 offset:5120
v_smfmac_f32_16x16x64_bf16 v[92:95], v[28:31], a[72:79], v2
ds_read_b128 v[48:51], v3 offset:6144
s_waitcnt lgkmcnt(4)
v_smfmac_f32_16x16x64_bf16 v[88:91], v[32:35], a[16:23], v2
ds_read_b128 v[52:55], v3 offset:7168
v_smfmac_f32_16x16x64_bf16 v[92:95], v[32:35], a[80:87], v2
ds_read_b128 v[72:75], v3 offset:10752
s_waitcnt lgkmcnt(5)
v_smfmac_f32_16x16x64_bf16 v[88:91], v[36:39], a[24:31], v2
ds_read_b128 v[76:79], v3 offset:11776
v_smfmac_f32_16x16x64_bf16 v[92:95], v[36:39], a[88:95], v2
ds_read_b128 v[80:83], v3 offset:12800
s_waitcnt lgkmcnt(6)
v_smfmac_f32_16x16x64_bf16 v[88:91], v[40:43], a[32:39], v2
ds_read_b128 v[84:87], v3 offset:13824
v_smfmac_f32_16x16x64_bf16 v[92:95], v[40:43], a[96:103], v2
ds_read_b128 v[116:119], v3 offset:14848
s_waitcnt lgkmcnt(7)
v_smfmac_f32_16x16x64_bf16 v[88:91], v[44:47], a[40:47], v2
ds_read_b128 v[120:123], v3 offset:15872
v_smfmac_f32_16x16x64_bf16 v[92:95], v[44:47], a[104:111], v2
ds_read_b128 v[124:127], v3 offset:16896
s_waitcnt lgkmcnt(8)
v_smfmac_f32_16x16x64_bf16 v[88:91], v[48:51], a[48:55], v2
ds_read_b128 v[112:115], v3 offset:17920
v_smfmac_f32_16x16x64_bf16 v[92:95], v[48:51], a[112:119], v2
s_waitcnt lgkmcnt(8)
s_and_b32 s34, s12, 1
s_lshl_b32 s34, s34, 18
v_smfmac_f32_16x16x64_bf16 v[88:91], v[52:55], a[56:63], v2
s_add_u32 s34, s34, 1048576
s_add_u32 s16, s4, s34
s_addc_u32 s17, s5, 0
v_smfmac_f32_16x16x64_bf16 v[92:95], v[52:55], a[120:127], v2
s_add_u32 s24, s16, 32768
s_addc_u32 s25, s17, 0
v_smfmac_f32_16x16x64_bf16 v[96:99], v[24:27], a[128:135], v2
s_waitcnt lgkmcnt(0)
s_barrier
s_cmp_ge_u32 s12, s13
s_cbranch_scc1 KVSLOW_S
KVRET_S:
v_smfmac_f32_16x16x64_bf16 v[100:103], v[24:27], a[192:199], v2
v_permlane32_swap_b32 v88, v92
v_permlane32_swap_b32 v89, v93
v_permlane32_swap_b32 v90, v94
v_permlane32_swap_b32 v91, v95
v_pk_add_f32 v[88:89], v[88:89], v[92:93]
v_pk_add_f32 v[90:91], v[90:91], v[94:95]
v_cvt_pk_bf16_f32 v88, v88, v89
v_cvt_pk_bf16_f32 v89, v90, v91
ds_write_b64 v6, v[88:89] offset:8192
v_smfmac_f32_16x16x64_bf16 v[96:99], v[28:31], a[136:143], v2
s_bfe_u32 s50, s12, 0x10001
s_add_u32 s34, s12, 1
s_and_b32 s35, s34, 3
v_smfmac_f32_16x16x64_bf16 v[100:103], v[28:31], a[200:207], v2
s_lshl_b32 s35, s35, 13
s_add_u32 s54, s26, s35
s_addc_u32 s55, s27, 0
v_smfmac_f32_16x16x64_bf16 v[96:99], v[32:35], a[144:151], v2
s_xor_b32 s35, s35, 0x4000
s_add_u32 s52, s26, s35
s_addc_u32 s53, s27, 0
v_smfmac_f32_16x16x64_bf16 v[100:103], v[32:35], a[208:215], v2
s_lshl_b32 s34, s12, 5
s_add_u32 s34, s34, s10
s_lshl_b32 s35, s34, 11
v_smfmac_f32_16x16x64_bf16 v[96:99], v[36:39], a[152:159], v2
s_add_u32 s35, s35, 83886080
s_add_u32 s92, s4, s35
s_addc_u32 s93, s5, 0
v_smfmac_f32_16x16x64_bf16 v[100:103], v[36:39], a[216:223], v2
s_lshl_b32 s35, s34, 13
s_add_u32 s35, s35, 88080384
s_add_u32 s94, s4, s35
s_addc_u32 s95, s5, 0
v_smfmac_f32_16x16x64_bf16 v[96:99], v[40:43], a[160:167], v2
s_waitcnt vmcnt(0)
s_lshl_b32 s34, s12, 7
s_add_u32 s35, s34, 24448
s_cmp_eq_u32 s12, 0
s_cselect_b32 s35, 73728, s35
v_smfmac_f32_16x16x64_bf16 v[100:103], v[40:43], a[224:231], v2
s_mov_b32 m0, s58
s_nop 0
global_load_lds_dwordx4 v4, s[30:31] sc1
v_mov_b64 v[88:89], 0
v_smfmac_f32_16x16x64_bf16 v[96:99], v[44:47], a[168:175], v2
s_add_u32 s62, s4, s35
s_addc_u32 s63, s5, 0
v_smfmac_f32_16x16x64_bf16 v[100:103], v[44:47], a[232:239], v2
v_mov_b64 v[90:91], 0
v_smfmac_f32_16x16x64_bf16 v[96:99], v[48:51], a[176:183], v2
v_smfmac_f32_16x16x64_bf16 v[100:103], v[48:51], a[240:247], v2
global_load_lds_dwordx4 v4, s[30:31] offset:1024 sc1
s_add_u32 s30, s30, 0x40000
s_addc_u32 s31, s31, 0
v_mov_b64 v[92:93], 0
v_smfmac_f32_16x16x64_bf16 v[96:99], v[52:55], a[184:191], v2
v_smfmac_f32_16x16x64_bf16 v[100:103], v[52:55], a[248:255], v2
v_mov_b64 v[94:95], 0
v_smfmac_f32_16x16x64_bf16 v[88:91], v[24:27], v[128:135], v2
v_smfmac_f32_16x16x64_bf16 v[92:95], v[24:27], v[192:199], v2
v_permlane32_swap_b32 v96, v100
v_permlane32_swap_b32 v97, v101
v_permlane32_swap_b32 v98, v102
v_permlane32_swap_b32 v99, v103
v_pk_add_f32 v[96:97], v[96:97], v[100:101]
v_pk_add_f32 v[98:99], v[98:99], v[102:103]
v_cvt_pk_bf16_f32 v96, v96, v97
v_cvt_pk_bf16_f32 v97, v98, v99
ds_write_b64 v6, v[96:97] offset:27136
v_smfmac_f32_16x16x64_bf16 v[88:91], v[28:31], v[136:143], v2
global_store_dwordx2 v6, v[96:97], s[92:93] sc1
v_smfmac_f32_16x16x64_bf16 v[92:95], v[28:31], v[200:207], v2
v_smfmac_f32_16x16x64_bf16 v[88:91], v[32:35], v[144:151], v2
v_smfmac_f32_16x16x64_bf16 v[92:95], v[32:35], v[208:215], v2
s_waitcnt lgkmcnt(0)
s_barrier
ds_read_b64_tr_b16 v[56:57], v7 offset:8192
ds_read_b64_tr_b16 v[58:59], v7 offset:8448
v_smfmac_f32_16x16x64_bf16 v[88:91], v[36:39], v[152:159], v2
s_mov_b64 exec, s[46:47]
s_cbranch_execz XF_88_S
global_atomic_add v3, v2, s[62:63]
XF_88_S:
s_mov_b64 exec, -1
ds_read_b64_tr_b16 v[60:61], v7 offset:8704
ds_read_b64_tr_b16 v[62:63], v7 offset:8960
v_smfmac_f32_16x16x64_bf16 v[92:95], v[36:39], v[216:223], v2
ds_read_b64_tr_b16 v[64:65], v7 offset:9216
ds_read_b64_tr_b16 v[66:67], v7 offset:9472
ds_read_b128 v[24:27], v4 offset:18944
v_smfmac_f32_16x16x64_bf16 v[88:91], v[40:43], v[160:167], v2
ds_read_b64_tr_b16 v[68:69], v7 offset:9728
ds_read_b64_tr_b16 v[70:71], v7 offset:9984
ds_read_b128 v[28:31], v4 offset:19968
v_smfmac_f32_16x16x64_bf16 v[92:95], v[40:43], v[224:231], v2
v_smfmac_f32_16x16x64_bf16 v[88:91], v[44:47], v[168:175], v2
v_smfmac_f32_16x16x64_bf16 v[92:95], v[44:47], v[232:239], v2
ds_read_b64_tr_b16 v[32:33], v7 offset:27136
ds_read_b64_tr_b16 v[34:35], v7 offset:27392
ds_read_b64_tr_b16 v[36:37], v7 offset:27648
ds_read_b64_tr_b16 v[38:39], v7 offset:27904
ds_read_b64_tr_b16 v[40:41], v7 offset:28160
ds_read_b64_tr_b16 v[42:43], v7 offset:28416
ds_read_b64_tr_b16 v[44:45], v7 offset:28672
ds_read_b64_tr_b16 v[46:47], v7 offset:28928
s_waitcnt lgkmcnt(8)
v_mfma_f32_16x16x32_bf16 v[104:107], v[72:75], v[56:59], 0
v_mfma_f32_16x16x32_bf16 v[108:111], v[116:119], v[56:59], 0
v_mfma_f32_16x16x32_bf16 v[104:107], v[76:79], v[60:63], v[104:107]
v_mfma_f32_16x16x32_bf16 v[108:111], v[120:123], v[60:63], v[108:111]
v_mfma_f32_16x16x32_bf16 v[104:107], v[80:83], v[64:67], v[104:107]
v_mfma_f32_16x16x32_bf16 v[108:111], v[124:127], v[64:67], v[108:111]
v_mfma_f32_16x16x32_bf16 v[104:107], v[84:87], v[68:71], v[104:107]
v_mfma_f32_16x16x32_bf16 v[108:111], v[112:115], v[68:71], v[108:111]
s_waitcnt lgkmcnt(0)
v_mfma_f32_16x16x32_bf16 v[112:115], v[32:35], v[56:59], 0
v_mfma_f32_16x16x32_bf16 v[112:115], v[36:39], v[60:63], v[112:115]
v_max3_f32 v0, |v104|, |v105|, |v106|
v_mfma_f32_16x16x32_bf16 v[112:115], v[40:43], v[64:67], v[112:115]
v_max3_f32 v13, |v108|, |v109|, |v110|
v_mfma_f32_16x16x32_bf16 v[112:115], v[44:47], v[68:71], v[112:115]
v_max3_f32 v0, v0, |v107|, |v111|
v_max_f32 v0, v0, v13
v_smfmac_f32_16x16x64_bf16 v[88:91], v[48:51], v[176:183], v2
s_mov_b32 m0, s59
ds_read_b128 v[56:59], v5 offset:0
global_load_lds_dwordx4 v4, s[32:33] sc1
v_smfmac_f32_16x16x64_bf16 v[92:95], v[48:51], v[240:247], v2
ds_read_b128 v[60:63], v5 offset:1024
v_smfmac_f32_16x16x64_bf16 v[88:91], v[52:55], v[184:191], v2
ds_read_b128 v[64:67], v5 offset:2048
v_smfmac_f32_16x16x64_bf16 v[92:95], v[52:55], v[248:255], v2
ds_read_b128 v[68:71], v5 offset:3072
v_max3_f32 v0, v0, |v112|, |v113|
v_max3_f32 v0, v0, |v114|, |v115|
v_cmp_lt_f32 vcc, s8, v0
v_pk_mul_f32 v[104:105], v[104:105], s[14:15]
v_pk_mul_f32 v[106:107], v[106:107], s[14:15]
v_pk_mul_f32 v[108:109], v[108:109], s[14:15]
v_pk_mul_f32 v[110:111], v[110:111], s[14:15]
v_pk_mul_f32 v[112:113], v[112:113], s[14:15]
v_pk_mul_f32 v[114:115], v[114:115], s[14:15]
global_load_lds_dwordx4 v4, s[32:33] offset:1024 sc1
s_add_u32 s32, s32, 0x40000
s_addc_u32 s33, s33, 0
s_cbranch_vccnz SMSLOW_S
SMRET_S:
v_cvt_pk_bf16_f32 v96, v88, v89
v_cvt_pk_bf16_f32 v97, v90, v91
v_cvt_pk_bf16_f32 v98, v92, v93
v_cvt_pk_bf16_f32 v99, v94, v95
global_store_dwordx4 v4, v[96:99], s[94:95] sc1
s_cmp_eq_u32 s12, 63
s_cbranch_scc1 L_fin_S
v_exp_f32 v104, v104
ds_read_b128 v[72:75], v1 offset:0
v_exp_f32 v105, v105
ds_read_b128 v[76:79], v1 offset:1024
v_exp_f32 v106, v106
ds_read_b128 v[80:83], v1 offset:2048
v_exp_f32 v107, v107
ds_read_b128 v[84:87], v1 offset:3072
v_exp_f32 v108, v108
ds_read_b128 v[32:35], v5 offset:4096
v_exp_f32 v109, v109
ds_read_b128 v[36:39], v5 offset:5120
v_exp_f32 v110, v110
ds_read_b128 v[40:43], v5 offset:6144
v_exp_f32 v111, v111
ds_read_b128 v[44:47], v5 offset:7168
v_cvt_pk_bf16_f32 v104, v104, v105
v_cvt_pk_bf16_f32 v105, v106, v107
v_cvt_pk_bf16_f32 v106, v108, v109
v_cvt_pk_bf16_f32 v107, v110, v111
ds_read_b128 v[48:51], v1 offset:4096
ds_read_b128 v[52:55], v1 offset:5120
s_waitcnt lgkmcnt(14)
v_mfma_f32_16x16x32_bf16 v[124:127], v[20:23], v[104:107], 0
v_exp_f32 v112, v112
v_mfma_f32_16x16x32_bf16 v[116:119], v[24:27], v[104:107], 0
v_exp_f32 v113, v113
v_mfma_f32_16x16x32_bf16 v[120:123], v[28:31], v[104:107], 0
v_exp_f32 v114, v114
v_exp_f32 v115, v115
v_cvt_pk_bf16_f32 v112, v112, v113
v_cvt_pk_bf16_f32 v113, v114, v115
s_nop 1
v_mfma_f32_16x16x16_bf16 v[124:127], v[14:15], v[112:113], v[124:127]
v_mfma_f32_16x16x16_bf16 v[116:119], v[96:97], v[112:113], v[116:119]
v_mfma_f32_16x16x16_bf16 v[120:123], v[98:99], v[112:113], v[120:123]
ds_read_b128 v[88:91], v1 offset:6144
ds_read_b128 v[92:95], v1 offset:7168
ds_read_b128 v[24:27], v5 offset:8192
ds_read_b128 v[28:31], v5 offset:9216
v_rcp_f32 v0, v124
s_nop 0
v_pk_mul_f32 v[116:117], v[116:117], v[0:1] op_sel_hi:[1,0]
v_pk_mul_f32 v[118:119], v[118:119], v[0:1] op_sel_hi:[1,0]
v_cvt_pk_bf16_f32 v116, v116, v117
v_cvt_pk_bf16_f32 v117, v118, v119
ds_write_b64 v8, v[116:117] offset:0
v_pk_mul_f32 v[120:121], v[120:121], v[0:1] op_sel_hi:[1,0]
v_pk_mul_f32 v[122:123], v[122:123], v[0:1] op_sel_hi:[1,0]
v_cvt_pk_bf16_f32 v120, v120, v121
v_cvt_pk_bf16_f32 v121, v122, v123
ds_write_b64 v8, v[120:121] offset:32
v_mov_b64 v[96:97], 0
v_mov_b64 v[98:99], 0
v_mov_b64 v[100:101], 0
v_mov_b64 v[102:103], 0
v_mov_b64 v[104:105], 0
v_mov_b64 v[106:107], 0
v_mov_b64 v[108:109], 0
v_mov_b64 v[110:111], 0
s_waitcnt lgkmcnt(0)
s_barrier
ds_read_b128 v[112:115], v12 offset:0
ds_read_b128 v[116:119], v12 offset:64
ds_read_b128 v[120:123], v12 offset:128
ds_read_b128 v[124:127], v12 offset:192
s_waitcnt lgkmcnt(3)
v_smfmac_f32_16x16x64_bf16 v[96:99], v[112:115], v[56:63], v2
ds_read_b128 v[56:59], v5 offset:10240
ds_read_b128 v[60:63], v5 offset:11264
s_waitcnt lgkmcnt(4)
v_smfmac_f32_16x16x64_bf16 v[96:99], v[116:119], v[64:71], v2
ds_read_b128 v[64:67], v1 offset:8192
ds_read_b128 v[68:71], v1 offset:9216
s_waitcnt lgkmcnt(5)
v_smfmac_f32_16x16x64_bf16 v[96:99], v[120:123], v[72:79], v2
ds_read_b128 v[72:75], v1 offset:10240
ds_read_b128 v[76:79], v1 offset:11264
s_waitcnt lgkmcnt(6)
v_smfmac_f32_16x16x64_bf16 v[96:99], v[124:127], v[80:87], v2
ds_read_b128 v[80:83], v5 offset:12288
v_smfmac_f32_16x16x64_bf16 v[100:103], v[112:115], v[32:39], v2
ds_read_b128 v[84:87], v5 offset:13312
v_smfmac_f32_16x16x64_bf16 v[100:103], v[116:119], v[40:47], v2
ds_read_b128 v[32:35], v5 offset:14336
v_cvt_pk_bf16_f32 v96, v96, v97
v_smfmac_f32_16x16x64_bf16 v[100:103], v[120:123], v[48:55], v2
ds_read_b128 v[36:39], v5 offset:15360
v_cvt_pk_bf16_f32 v97, v98, v99
v_smfmac_f32_16x16x64_bf16 v[100:103], v[124:127], v[88:95], v2
ds_read_b128 v[40:43], v1 offset:12288
v_smfmac_f32_16x16x64_bf16 v[104:107], v[112:115], v[24:31], v2
ds_read_b128 v[44:47], v1 offset:13312
ds_read_b128 v[48:51], v1 offset:14336
s_waitcnt lgkmcnt(11)
v_smfmac_f32_16x16x64_bf16 v[104:107], v[116:119], v[56:63], v2
ds_read_b128 v[52:55], v1 offset:15360
v_cvt_pk_bf16_f32 v98, v100, v101
s_waitcnt lgkmcnt(10)
v_smfmac_f32_16x16x64_bf16 v[104:107], v[120:123], v[64:71], v2
v_cvt_pk_bf16_f32 v99, v102, v103
v_bfi_b32 v96, 1, s50, v96
global_store_dwordx4 v9, v[96:99], s[16:17] sc1
s_waitcnt lgkmcnt(8)
v_smfmac_f32_16x16x64_bf16 v[104:107], v[124:127], v[72:79], v2
s_waitcnt lgkmcnt(6)
v_smfmac_f32_16x16x64_bf16 v[108:111], v[112:115], v[80:87], v2
s_waitcnt lgkmcnt(4)
v_smfmac_f32_16x16x64_bf16 v[108:111], v[116:119], v[32:39], v2
v_cvt_pk_bf16_f32 v104, v104, v105
s_waitcnt lgkmcnt(2)
v_smfmac_f32_16x16x64_bf16 v[108:111], v[120:123], v[40:47], v2
v_cvt_pk_bf16_f32 v105, v106, v107
s_waitcnt lgkmcnt(0)
v_smfmac_f32_16x16x64_bf16 v[108:111], v[124:127], v[48:55], v2
s_nop 7
v_cvt_pk_bf16_f32 v106, v108, v109
v_cvt_pk_bf16_f32 v107, v110, v111
v_bfi_b32 v104, 1, s50, v104
global_store_dwordx4 v9, v[104:107], s[24:25] sc1
s_mov_b32 s22, s16
s_mov_b32 s23, s17
s_mov_b32 s28, s54
s_mov_b32 s29, s55
s_mov_b32 s51, s50
s_add_u32 s12, s12, 1
v_mov_b64 v[88:89], 0
v_mov_b64 v[90:91], 0
v_mov_b64 v[92:93], 0
v_mov_b64 v[94:95], 0
v_mov_b64 v[96:97], 0
v_mov_b64 v[98:99], 0
v_mov_b64 v[100:101], 0
v_mov_b64 v[102:103], 0
v_mov_b32 v104, -1
s_mov_b32 s45, 0
s_nop 15
s_nop 15
global_load_dwordx4 v[56:59], v10, s[22:23] sc1
global_load_dwordx4 v[60:63], v10, s[22:23] offset:1024 sc1
s_nop 15
s_nop 15
global_load_dwordx4 v[64:67], v10, s[22:23] sc1
global_load_dwordx4 v[68:71], v10, s[22:23] offset:1024 sc1
s_waitcnt vmcnt(2)
v_xor_b32 v0, s51, v56
v_xor_b32 v13, s51, v60
v_mfma_f32_16x16x32_bf16 v[24:27], v[16:19], v[56:59], 0
v_or_b32 v0, v0, v13
v_and_b32 v0, 1, v0
v_mfma_f32_16x16x32_bf16 v[24:27], v[16:19], v[60:63], v[24:27]
v_cmp_ne_u32 vcc, 0, v0
s_cbranch_vccz L_rsok_S
global_load_dwordx4 v[56:59], v10, s[22:23] sc1
global_load_dwordx4 v[60:63], v10, s[22:23] offset:1024 sc1
s_add_u32 s61, s61, 1
s_waitcnt vmcnt(2)
v_xor_b32 v0, s51, v64
v_xor_b32 v13, s51, v68
v_mfma_f32_16x16x32_bf16 v[24:27], v[16:19], v[64:67], 0
v_or_b32 v0, v0, v13
v_and_b32 v0, 1, v0
v_mfma_f32_16x16x32_bf16 v[24:27], v[16:19], v[68:71], v[24:27]
v_cmp_ne_u32 vcc, 0, v0
s_cbranch_vccnz L_rsretry_S
L_rsok_S:
s_nop 5
v_add_f32_dpp v24, v24, v24 row_ror:4 row_mask:0xf bank_mask:0xf
v_add_f32_dpp v25, v25, v25 row_ror:4 row_mask:0xf bank_mask:0xf
v_add_f32_dpp v26, v26, v26 row_ror:4 row_mask:0xf bank_mask:0xf
v_add_f32_dpp v27, v27, v27 row_ror:4 row_mask:0xf bank_mask:0xf
v_add_f32_dpp v24, v24, v24 row_ror:8 row_mask:0xf bank_mask:0xf
v_add_f32_dpp v25, v25, v25 row_ror:8 row_mask:0xf bank_mask:0xf
v_add_f32_dpp v26, v26, v26 row_ror:8 row_mask:0xf bank_mask:0xf
v_add_f32_dpp v27, v27, v27 row_ror:8 row_mask:0xf bank_mask:0xf
v_cndmask_b32 v24, v24, v25, s[18:19]
v_cndmask_b32 v26, v26, v27, s[18:19]
v_cndmask_b32 v24, v24, v26, s[20:21]
s_nop 1
v_mov_b32_dpp v25, v24 quad_perm:[1,1,3,3] row_mask:0xf bank_mask:0xf
v_cvt_pk_bf16_f32 v24, v24, v25
s_mov_b64 exec, s[40:41]
v_min_u32 v24, -2, v24
global_store_dword v11, v24, s[28:29] sc1
s_mov_b64 exec, -1
s_branch L_loop_S
L_fin_S:
s_waitcnt vmcnt(0) lgkmcnt(0)
s_barrier
s_add_u32 s62, s62, 128
s_addc_u32 s63, s63, 0
s_mov_b64 exec, s[46:47]
s_cbranch_execz XF_89_S
global_atomic_add v3, v2, s[62:63]
XF_89_S:
s_mov_b64 exec, -1
s_waitcnt vmcnt(0)
s_cmp_lg_u32 s11, 0
s_cbranch_scc1 WB_90_S
buffer_wbl2 sc1
s_waitcnt vmcnt(0)
WB_90_S:
s_branch L_chain_done
KVSLOW_S:
s_mov_b32 s35, 0
KVSLOW_l_S:
v_lshlrev_b32 v13, 3, v3
global_load_dword v0, v13, s[98:99] sc1
s_waitcnt vmcnt(0)
v_cmp_gt_u32 vcc, 32, v0
s_nop 3
s_ff1_i32_b64 s34, vcc
s_cmp_eq_u32 s34, -1
s_cselect_b32 s34, 64, s34
s_sub_u32 s13, s34, 1
s_cmp_eq_u32 s34, 64
s_cselect_b32 s13, 64, s13
s_cmp_lt_i32 s12, s13
s_cbranch_scc1 KVRET_S
s_sleep 4
s_add_u32 s35, s35, 1
s_cmp_lt_u32 s35, 200000
s_cbranch_scc1 KVSLOW_l_S
s_mov_b32 s13, 64
s_branch KVRET_S
SMSLOW_S:
v_max3_f32 v0, v104, v105, v106
v_max3_f32 v13, v107, v108, v109
v_max3_f32 v0, v0, v110, v111
v_max3_f32 v13, v13, v112, v113
v_max3_f32 v0, v0, v114, v115
v_max_f32 v0, v0, v13
v_mov_b32 v13, v0
s_nop 1
v_permlane16_swap_b32 v0, v13
v_max_f32 v0, v0, v13
v_mov_b32 v13, v0
s_nop 1
v_permlane32_swap_b32 v0, v13
v_max_f32 v0, v0, v13
v_sub_f32 v104, v104, v0
v_sub_f32 v105, v105, v0
v_sub_f32 v106, v106, v0
v_sub_f32 v107, v107, v0
v_sub_f32 v108, v108, v0
v_sub_f32 v109, v109, v0
v_sub_f32 v110, v110, v0
v_sub_f32 v111, v111, v0
v_sub_f32 v112, v112, v0
v_sub_f32 v113, v113, v0
v_sub_f32 v114, v114, v0
v_sub_f32 v115, v115, v0
s_nop 1
s_branch SMRET_S
L_agretry_S:
global_load_dwordx4 v[64:67], v4, s[28:29] sc1
global_load_dwordx4 v[68:71], v4, s[28:29] offset:1024 sc1
s_add_u32 s60, s60, 1
L_ag_S:
s_waitcnt vmcnt(2)
ds_write_b128 v4, v[56:59]
v_max3_u32 v0, v56, v57, v58
v_max3_u32 v13, v59, v60, v61
ds_write_b128 v4, v[60:63] offset:1024
v_max3_u32 v0, v0, v62, v63
v_max_u32 v0, v0, v13
v_cmp_eq_u32 vcc, -1, v0
s_cbranch_vccz L_agok_S
global_load_dwordx4 v[56:59], v4, s[28:29] sc1
global_load_dwordx4 v[60:63], v4, s[28:29] offset:1024 sc1
s_add_u32 s60, s60, 1
s_waitcnt vmcnt(2)
ds_write_b128 v4, v[64:67]
v_max3_u32 v0, v64, v65, v66
v_max3_u32 v13, v67, v68, v69
ds_write_b128 v4, v[68:71] offset:1024
v_max3_u32 v0, v0, v70, v71
v_max_u32 v0, v0, v13
v_cmp_eq_u32 vcc, -1, v0
s_cbranch_vccz L_agok_S
global_load_dwordx4 v[64:67], v4, s[28:29] sc1
global_load_dwordx4 v[68:71], v4, s[28:29] offset:1024 sc1
s_add_u32 s60, s60, 1
s_add_u32 s45, s45, 1
s_cmp_lt_u32 s45, 100000
s_cbranch_scc1 L_ag_S
s_mov_b32 s44, 1
s_waitcnt vmcnt(0)
s_branch L_agok_S
L_rsretry_S:
global_load_dwordx4 v[64:67], v10, s[22:23] sc1
global_load_dwordx4 v[68:71], v10, s[22:23] offset:1024 sc1
s_add_u32 s61, s61, 1
L_rs_S:
s_waitcnt vmcnt(2)
v_xor_b32 v0, s51, v56
v_xor_b32 v13, s51, v60
v_mfma_f32_16x16x32_bf16 v[24:27], v[16:19], v[56:59], 0
v_or_b32 v0, v0, v13
v_and_b32 v0, 1, v0
v_mfma_f32_16x16x32_bf16 v[24:27], v[16:19], v[60:63], v[24:27]
v_cmp_ne_u32 vcc, 0, v0
s_cbranch_vccz L_rsok_S
global_load_dwordx4 v[56:59], v10, s[22:23] sc1
global_load_dwordx4 v[60:63], v10, s[22:23] offset:1024 sc1
s_add_u32 s61, s61, 1
s_waitcnt vmcnt(2)
v_xor_b32 v0, s51, v64
v_xor_b32 v13, s51, v68
v_mfma_f32_16x16x32_bf16 v[24:27], v[16:19], v[64:67], 0
v_or_b32 v0, v0, v13
v_and_b32 v0, 1, v0
v_mfma_f32_16x16x32_bf16 v[24:27], v[16:19], v[68:71], v[24:27]
v_cmp_ne_u32 vcc, 0, v0
s_cbranch_vccz L_rsok_S
global_load_dwordx4 v[64:67], v10, s[22:23] sc1
global_load_dwordx4 v[68:71], v10, s[22:23] offset:1024 sc1
s_add_u32 s61, s61, 1
s_add_u32 s45, s45, 1
s_cmp_lt_u32 s45, 100000
s_cbranch_scc1 L_rs_S
s_mov_b32 s44, 2
s_branch L_rsok_S
L_chain_done:
L_end:
s_endpgm
.section .rodata,"a"
.p2align 6
.amdhsa_kernel adaLN_cond__memory_aug_recurrent_mem_tr__dense_activation_gelu__prompt_kernel
  .amdhsa_next_free_vgpr 512
  .amdhsa_next_free_sgpr 102
  .amdhsa_accum_offset 256
  .amdhsa_group_segment_fixed_size 0
  .amdhsa_kernarg_size 136
  .amdhsa_user_sgpr_count 2
  .amdhsa_user_sgpr_kernarg_segment_ptr 1
  .amdhsa_system_sgpr_workgroup_id_x 1
.end_amdhsa_kernel
```
